```python
import torch

def _softmax(x, axis=-1):
    return torch.softmax(x, dim=axis)
def _gelu(x):
    return torch.nn.functional.gelu(x, approximate="tanh")
def _silu(x):
    return torch.nn.functional.silu(x)
def _sigmoid(x):
    return torch.sigmoid(x)
def _layernorm(x, axis=-1, eps=1e-5):
    m = x.mean(dim=axis, keepdim=True)
    v = x.var(dim=axis, keepdim=True, unbiased=False)
    return (x - m) / torch.sqrt(v + eps)
def _scatter_add(tgt, idx, src, axis=0):
    return tgt.clone().index_add_(axis, idx, src)
def _segment_sum(src, seg, n):
    out = torch.zeros((n,) + src.shape[1:], dtype=src.dtype)
    return out.index_add_(0, seg, src)
def _pad(x, pw):
    flat = tuple(v for pair in reversed(pw) for v in pair)
    return torch.nn.functional.pad(x, flat)

kernel_name = 'recurrent_scan__linear_kernel_hedgehog__glu_gated_bilinear__prompt'

def setup_inputs():

    _w = (lambda a: (lambda t: t.to(torch.bfloat16) if t.is_floating_point() else t)(torch.as_tensor(a)))
    def _A_setup():
        B, S, D, H = 1, 2048, 1024, 32
        Dh = D // H
        return {
            "x": _w((lambda *s: torch.randn(*s, dtype=torch.bfloat16) * 0.05)(B, S, D)),
            "wqkv": _w((lambda *s: torch.randn(*s, dtype=torch.bfloat16) * 0.8)(D, 3 * D)),
            "w_phi": _w((lambda *s: torch.randn(*s, dtype=torch.bfloat16) * 0.8)(H, Dh, Dh) * (Dh ** -0.5)),
            "wo": _w((lambda *s: torch.randn(*s, dtype=torch.bfloat16) * 0.8)(D, D)),
        }
    _A_in = _A_setup()

    def _B_setup():
        B, S, D, F = 1, 2048, 1024, 3584
        return {
            "x": _w((lambda *s: torch.randn(*s, dtype=torch.bfloat16) * 0.05)(B, S, D)),
            "w_gate": _w((lambda *s: torch.randn(*s, dtype=torch.bfloat16) * 0.2)(D, F) * (D ** -0.5)),
            "w_up": _w((lambda *s: torch.randn(*s, dtype=torch.bfloat16) * 0.2)(D, F) * (D ** -0.5)),
            "w_down": _w((lambda *s: torch.randn(*s, dtype=torch.bfloat16) * 0.2)(F, D) * (F ** -0.5)),
        }
    _B_in = _B_setup()

    return {
        "A_x": _A_in["x"],
        "A_wqkv": _A_in["wqkv"],
        "A_w_phi": _A_in["w_phi"],
        "A_wo": _A_in["wo"],
        "B_x": _B_in["x"],
        "B_w_gate": _B_in["w_gate"],
        "B_w_up": _B_in["w_up"],
        "B_w_down": _B_in["w_down"],
    }

def reference(A_x, A_wqkv, A_w_phi, A_wo, B_x, B_w_gate, B_w_up, B_w_down):
    def _A_ref(x, wqkv, w_phi, wo):
        B, S, D = x.shape
        H = 32; Dh = D // H
        qkv = (lambda x, *d: x.permute(*d))((x @ wqkv).reshape(B, S, 3, H, Dh), 2, 0, 3, 1, 4)
        q, k, v = qkv[0], qkv[1], qkv[2]
        pq = torch.einsum("bhsd,hdf->bhsf", q, w_phi)
        pk = torch.einsum("bhsd,hdf->bhsf", k, w_phi)
        phi_q = torch.concatenate([_softmax(pq, axis=-1), _softmax(-pq, axis=-1)], axis=-1)
        phi_k = torch.concatenate([_softmax(pk, axis=-1), _softmax(-pk, axis=-1)], axis=-1)
        kv = torch.einsum("bhsf,bhsd->bhfd", phi_k, v)
        z  = torch.einsum("bhsf->bhf", phi_k)
        num = torch.einsum("bhqf,bhfd->bhqd", phi_q, kv)
        den = torch.einsum("bhqf,bhf->bhq", phi_q, z)[..., None] + 1e-6
        o = num / den
        return (lambda x, *d: x.permute(*d))(o, 0, 2, 1, 3).reshape(B, S, D) @ wo

    def _B_ref(x, w_gate, w_up, w_down):
        g = torch.einsum("bsd,df->bsf", x, w_gate)
        u = torch.einsum("bsd,df->bsf", x, w_up)
        h = g * u
        return torch.einsum("bsf,fd->bsd", h, w_down)

    x = A_x
    xn = _layernorm(x, axis=-1)
    s = _A_ref(xn, A_wqkv, A_w_phi, A_wo)
    g = _silu(_B_ref(xn, B_w_gate, B_w_up, B_w_down))
    return x + s * g
```

```asm
; @launch grid=(256,1,1) block=(256,1,1) lds=159744
.amdgcn_target "amdgcn-amd-amdhsa--gfx950"
.text
.globl recurrent_scan__linear_kernel_hedgehog__glu_gated_bilinear__prompt_kernel
.p2align 8
.type recurrent_scan__linear_kernel_hedgehog__glu_gated_bilinear__prompt_kernel,@function
recurrent_scan__linear_kernel_hedgehog__glu_gated_bilinear__prompt_kernel:
  s_cmp_ge_u32 s2, 256
  s_cbranch_scc1 L_gb_end
  s_load_dwordx2 s[72:73], s[0:1], 0
  s_load_dwordx4 s[40:43], s[0:1], 8
  s_load_dwordx4 s[44:47], s[0:1], 40
  s_load_dwordx2 s[48:49], s[0:1], 80
  s_load_dwordx2 s[74:75], s[0:1], 72
  s_load_dwordx2 s[50:51], s[0:1], 24
  s_load_dwordx2 s[52:53], s[0:1], 56
  s_memrealtime s[4:5]
  s_getpc_b64 s[60:61]
L_ga_pc:
  s_and_b32 s61, s61, 0xffff
  s_mov_b32 s62, L_code_end-L_ga_pc
  s_mov_b32 s63, 0x20000
  s_lshr_b32 s56, s2, 3
  s_lshl_b32 s56, s56, 7
  v_lshlrev_b32 v11, 12, v0
  buffer_load_dword a255, v11, s[60:63], s56 offen
  v_lshrrev_b32 v10, 6, v0
  v_and_b32 v1, 63, v0
  v_readfirstlane_b32 s32, v10
  s_and_b32 s54, s2, 7
  s_lshl_b32 s33, s54, 2
  s_lshr_b32 s55, s2, 3
  s_and_b32 s35, s55, 3
  s_add_u32 s33, s33, s35
  s_lshr_b32 s34, s2, 5
  v_lshrrev_b32 v32, 5, v0
  v_and_b32 v33, 31, v0
  v_lshlrev_b32 v34, 11, v32
  v_lshl_add_u32 v34, v33, 4, v34
  s_lshl_b32 s36, s34, 5
  s_add_u32 s36, s36, s33
  s_lshl_b32 s37, s36, 14
  v_mov_b32 v20, 0x40000000
  v_mov_b32 v35, 0
  s_waitcnt lgkmcnt(0)
  s_mov_b32 s60, s72
  s_and_b32 s61, s73, 0xffff
  s_mov_b32 s62, 0x400000
  s_mov_b32 s63, 0x20000
  s_mov_b32 s68, s72
  s_and_b32 s69, s73, 0xffff
  buffer_load_dwordx4 v[64:67], v34, s[60:63], s37 offen offset:0 nt
  buffer_load_dwordx4 v[68:71], v34, s[60:63], s37 offen offset:512 nt
  buffer_load_dwordx4 v[72:75], v34, s[60:63], s37 offen offset:1024 nt
  buffer_load_dwordx4 v[76:79], v34, s[60:63], s37 offen offset:1536 nt
  s_or_b32 s6, s2, s32
  s_cmp_lg_u32 s6, 0
  s_cbranch_scc1 L_ga_notag
  s_lshl_b64 s[4:5], s[4:5], 4
  s_or_b32 s4, s4, 1
  v_mov_b32 v36, s4
  v_mov_b32 v37, s5
  global_store_dwordx2 v35, v[36:37], s[74:75] sc1
L_ga_notag:
  s_cmp_eq_u32 s32, 1
  s_cselect_b32 s28, s44, s40
  s_cselect_b32 s29, s45, s41
  s_cselect_b32 s57, 7, 6
  s_cmp_eq_u32 s32, 2
  s_cselect_b32 s28, s46, s28
  s_cselect_b32 s29, s47, s29
  s_cselect_b32 s57, 7, s57
  s_lshl_b32 s56, s57, 10
  s_and_b32 s29, s29, 0xffff
  s_lshl_b32 s30, s56, 10
  s_mov_b32 s31, 0x20000
  s_cmp_gt_u32 s32, 3
  s_cselect_b32 s30, 0, s30
  v_and_b32 v11, 7, v1
  s_mul_i32 s58, s54, 896
  v_lshlrev_b32 v22, 7, v11
  v_add_u32 v22, s58, v22
  v_lshrrev_b32 v12, 1, v11
  v_lshlrev_b32 v12, 11, v12
  v_and_b32 v13, 1, v11
  v_lshl_add_u32 v12, v13, 7, v12
  s_lshl_b32 s58, s54, 8
  v_add_u32 v12, s58, v12
  s_cmp_eq_u32 s57, 6
  s_cselect_b64 vcc, -1, 0
  v_cndmask_b32 v22, v22, v12, vcc
  s_lshl_b32 s58, s55, 1
  s_mov_b32 s59, 8
  s_add_u32 s60, s58, 832
  s_cmp_eq_u32 s32, 3
  s_cselect_b32 s58, s60, s58
  s_cselect_b32 s59, 6, s59
  v_lshrrev_b32 v12, 3, v1
  v_and_b32 v13, 6, v12
  v_mul_u32_u24 v13, 31, v13
  v_add3_u32 v13, v13, v12, s58
  v_mul_lo_u32 v13, v13, s56
  v_add_u32 v22, v22, v13
  v_mov_b32 v13, 0x40000000
  v_cmp_gt_u32 vcc, s57, v11
  s_nop 1
  v_cndmask_b32 v22, v13, v22, vcc
  v_cmp_gt_u32 vcc, s59, v12
  s_nop 1
  v_cndmask_b32 v22, v13, v22, vcc
  s_cmp_eq_u32 s32, 3
  s_cselect_b32 s65, 64, 16
  v_cmp_gt_u32 vcc, s65, v1
  s_nop 1
  v_cndmask_b32 v11, v20, v22, vcc
  v_cndmask_b32 v22, v22, v20, vcc
  v_mov_b32 v43, v11
  s_mov_b32 s24, s48
  s_and_b32 s25, s49, 0xffff
  s_mov_b32 s26, 0x3300000
  s_mov_b32 s27, 0x20000
  v_mov_b64 v[28:29], 0
  v_mov_b64 v[30:31], 0
  v_and_b32 v38, 7, v33
  v_xor_b32 v38, v38, v32
  v_lshlrev_b32 v38, 4, v38
  v_lshl_add_u32 v38, v33, 7, v38
  v_add_u32 v38, 135168, v38
  v_lshrrev_b32 v41, 3, v0
  v_and_b32 v42, 7, v0
  v_and_b32 v39, 7, v41
  v_xor_b32 v39, v39, v42
  v_lshlrev_b32 v39, 4, v39
  v_lshl_add_u32 v39, v41, 7, v39
  v_add_u32 v39, 135168, v39
  v_lshrrev_b32 v40, 2, v41
  v_lshlrev_b32 v40, 17, v40
  v_and_b32 v41, 3, v41
  v_lshl_add_u32 v40, v41, 8, v40
  v_lshl_add_u32 v40, v42, 4, v40
  s_lshr_b32 s6, s36, 1
  s_lshl_b32 s6, s6, 10
  s_and_b32 s7, s36, 1
  s_lshl_b32 s7, s7, 7
  s_add_u32 s6, s6, s7
  s_lshl_b32 s7, s36, 7
  s_add_u32 s7, s7, 0x1890000
  s_lshl_b32 s3, s34, 12
  s_lshl_b32 s65, s32, 10
  s_add_u32 s3, s3, s65
  s_add_u32 s3, s3, 0x1890000
  v_and_b32 v41, 7, v1
  v_lshlrev_b32 v41, 7, v41
  v_lshrrev_b32 v11, 1, v1
  v_and_b32 v13, 2, v10
  v_lshlrev_b32 v13, 1, v13
  v_sub_u32 v17, v11, v13
  v_and_b32 v12, 1, v1
  v_lshlrev_b32 v12, 4, v12
  v_and_b32 v18, 31, v17
  v_mul_u32_u24 v14, 37, v18
  v_lshrrev_b32 v14, 8, v14
  v_mul_u32_u24 v15, 7, v14
  v_sub_u32 v15, v18, v15
  v_lshl_add_u32 v14, v10, 2, v14
  s_mul_i32 s36, s33, 224
  v_mul_u32_u24 v16, 0x1c00, v14
  v_lshl_add_u32 v16, v15, 5, v16
  v_add3_u32 v16, v16, v12, s36
  v_cmp_gt_u32 vcc, 28, v17
  s_nop 1
  v_cndmask_b32 v3, v20, v16, vcc
  v_mul_u32_u24 v16, 0x1800, v14
  v_lshrrev_b32 v19, 1, v15
  v_lshl_add_u32 v16, v19, 11, v16
  v_and_b32 v19, 1, v15
  v_lshl_add_u32 v16, v19, 5, v16
  s_lshl_b32 s36, s33, 6
  v_add3_u32 v16, v16, v12, s36
  v_cndmask_b32 v2, v20, v16, vcc
  v_cmp_gt_u32 vcc, 6, v15
  s_nop 1
  v_cndmask_b32 v2, v20, v2, vcc
  v_lshlrev_b32 v21, 4, v1
  s_lshl_b32 s36, s34, 14
  v_lshl_add_u32 v4, v10, 12, v21
  v_add_u32 v4, s36, v4
  s_lshl_b32 s38, s32, 10
  s_mov_b32 s35, 5111808
  s_mov_b32 s39, 3407872
  s_mov_b32 s36, 0
  s_mov_b32 s37, 0
  s_mov_b32 s8, s40
  s_and_b32 s9, s41, 0xffff
  s_mov_b32 s10, 0x600000
  s_mov_b32 s11, 0x20000
  s_mov_b32 s20, s48
  s_and_b32 s21, s49, 0xffff
  s_mov_b32 s22, 0x400000
  s_mov_b32 s23, 0x20000
  s_mov_b32 s12, s44
  s_and_b32 s13, s45, 0xffff
  s_mov_b32 s14, 0x700000
  s_mov_b32 s15, 0x20000
  s_mov_b32 s16, s46
  s_and_b32 s17, s47, 0xffff
  s_mov_b32 s18, 0x700000
  s_mov_b32 s19, 0x20000
  v_lshrrev_b32 v11, 4, v1
  v_bfe_u32 v13, v1, 2, 2
  v_and_b32 v14, 3, v1
  v_and_b32 v12, 1, v11
  v_lshlrev_b32 v6, 11, v11
  v_lshl_add_u32 v6, v12, 7, v6
  v_mul_u32_u24 v13, 224, v13
  v_lshl_add_u32 v13, v14, 3, v13
  v_add_u32 v6, v6, v13
  v_add_u32 v7, 49152, v6
  v_cmp_eq_u32 vcc, 0, v0
  s_nop 1
  v_cndmask_b32 v42, v20, v0, vcc
  s_mov_b32 s56, 0x3a800000
  v_mfma_f32_32x32x16_bf16 v[128:143], v[28:31], v[28:31], 0
  v_mfma_f32_32x32x16_bf16 v[144:159], v[28:31], v[28:31], 0
  v_mfma_f32_32x32x16_bf16 v[160:175], v[28:31], v[28:31], 0
  v_mfma_f32_32x32x16_bf16 v[176:191], v[28:31], v[28:31], 0
  v_mfma_f32_32x32x16_bf16 v[192:207], v[28:31], v[28:31], 0
  v_mfma_f32_32x32x16_bf16 v[208:223], v[28:31], v[28:31], 0
  v_mfma_f32_32x32x16_bf16 v[224:239], v[28:31], v[28:31], 0
  v_mfma_f32_32x32x16_bf16 v[240:255], v[28:31], v[28:31], 0
  v_mfma_f32_32x32x16_bf16 a[64:79], v[28:31], v[28:31], 0
  v_mfma_f32_32x32x16_bf16 a[80:95], v[28:31], v[28:31], 0
  s_waitcnt vmcnt(0)
  global_load_dwordx2 v[36:37], v35, s[74:75] sc1
  buffer_load_dword a255, v43, s[28:31], 0 offen
  v_subrev_u32 v48, 0x4000, v38
  v_subrev_u32 v49, 0x4000, v39
  ds_write_b128 v48, v[64:67] offset:0
  ds_write_b128 v48, v[68:71] offset:4096
  ds_write_b128 v48, v[72:75] offset:8192
  ds_write_b128 v48, v[76:79] offset:12288
  v_lshlrev_b32 v80, 16, v64
  v_and_b32 v81, 0xffff0000, v64
  v_lshlrev_b32 v82, 16, v65
  v_and_b32 v83, 0xffff0000, v65
  v_lshlrev_b32 v84, 16, v66
  v_and_b32 v85, 0xffff0000, v66
  v_lshlrev_b32 v86, 16, v67
  v_and_b32 v87, 0xffff0000, v67
  v_lshlrev_b32 v88, 16, v68
  v_and_b32 v89, 0xffff0000, v68
  v_lshlrev_b32 v90, 16, v69
  v_and_b32 v91, 0xffff0000, v69
  v_lshlrev_b32 v92, 16, v70
  v_and_b32 v93, 0xffff0000, v70
  v_lshlrev_b32 v94, 16, v71
  v_and_b32 v95, 0xffff0000, v71
  v_lshlrev_b32 v96, 16, v72
  v_and_b32 v97, 0xffff0000, v72
  v_lshlrev_b32 v98, 16, v73
  v_and_b32 v99, 0xffff0000, v73
  v_lshlrev_b32 v100, 16, v74
  v_and_b32 v101, 0xffff0000, v74
  v_lshlrev_b32 v102, 16, v75
  v_and_b32 v103, 0xffff0000, v75
  v_lshlrev_b32 v104, 16, v76
  v_and_b32 v105, 0xffff0000, v76
  v_lshlrev_b32 v106, 16, v77
  v_and_b32 v107, 0xffff0000, v77
  v_lshlrev_b32 v108, 16, v78
  v_and_b32 v109, 0xffff0000, v78
  v_lshlrev_b32 v110, 16, v79
  v_and_b32 v111, 0xffff0000, v79
  v_pk_add_f32 v[64:65], v[80:81], v[96:97]
  v_pk_add_f32 v[66:67], v[82:83], v[98:99]
  v_pk_add_f32 v[68:69], v[84:85], v[100:101]
  v_pk_add_f32 v[70:71], v[86:87], v[102:103]
  v_pk_add_f32 v[72:73], v[88:89], v[104:105]
  v_pk_add_f32 v[74:75], v[90:91], v[106:107]
  v_pk_add_f32 v[76:77], v[92:93], v[108:109]
  v_pk_add_f32 v[78:79], v[94:95], v[110:111]
  v_pk_add_f32 v[64:65], v[64:65], v[72:73]
  v_pk_add_f32 v[66:67], v[66:67], v[74:75]
  v_pk_add_f32 v[68:69], v[68:69], v[76:77]
  v_pk_add_f32 v[70:71], v[70:71], v[78:79]
  v_pk_add_f32 v[64:65], v[64:65], v[68:69]
  v_pk_add_f32 v[66:67], v[66:67], v[70:71]
  v_pk_add_f32 v[44:45], v[64:65], v[66:67]
  v_add_f32 v44, v44, v45
  s_nop 1
  v_add_f32_dpp v44, v44, v44 quad_perm:[1,0,3,2] row_mask:0xf bank_mask:0xf
  s_nop 1
  v_add_f32_dpp v44, v44, v44 quad_perm:[2,3,0,1] row_mask:0xf bank_mask:0xf
  s_nop 1
  v_add_f32_dpp v44, v44, v44 row_half_mirror row_mask:0xf bank_mask:0xf
  s_nop 1
  v_add_f32_dpp v44, v44, v44 row_mirror row_mask:0xf bank_mask:0xf
  v_mov_b32 v45, v44
  s_nop 1
  v_permlane16_swap_b32 v44, v45
  v_add_f32 v44, v44, v45
  v_mul_f32 v44, s56, v44
  v_pk_add_f32 v[64:65], v[80:81], v[44:45] op_sel_hi:[1,0] neg_lo:[0,1] neg_hi:[0,1]
  v_pk_add_f32 v[66:67], v[82:83], v[44:45] op_sel_hi:[1,0] neg_lo:[0,1] neg_hi:[0,1]
  v_pk_add_f32 v[68:69], v[84:85], v[44:45] op_sel_hi:[1,0] neg_lo:[0,1] neg_hi:[0,1]
  v_pk_add_f32 v[70:71], v[86:87], v[44:45] op_sel_hi:[1,0] neg_lo:[0,1] neg_hi:[0,1]
  v_pk_add_f32 v[72:73], v[88:89], v[44:45] op_sel_hi:[1,0] neg_lo:[0,1] neg_hi:[0,1]
  v_pk_add_f32 v[74:75], v[90:91], v[44:45] op_sel_hi:[1,0] neg_lo:[0,1] neg_hi:[0,1]
  v_pk_add_f32 v[76:77], v[92:93], v[44:45] op_sel_hi:[1,0] neg_lo:[0,1] neg_hi:[0,1]
  v_pk_add_f32 v[78:79], v[94:95], v[44:45] op_sel_hi:[1,0] neg_lo:[0,1] neg_hi:[0,1]
  v_pk_mul_f32 v[112:113], v[64:65], v[64:65]
  v_pk_mul_f32 v[114:115], v[66:67], v[66:67]
  v_pk_mul_f32 v[116:117], v[68:69], v[68:69]
  v_pk_mul_f32 v[118:119], v[70:71], v[70:71]
  v_pk_fma_f32 v[112:113], v[72:73], v[72:73], v[112:113]
  v_pk_fma_f32 v[114:115], v[74:75], v[74:75], v[114:115]
  v_pk_fma_f32 v[116:117], v[76:77], v[76:77], v[116:117]
  v_pk_fma_f32 v[118:119], v[78:79], v[78:79], v[118:119]
  v_pk_add_f32 v[64:65], v[96:97], v[44:45] op_sel_hi:[1,0] neg_lo:[0,1] neg_hi:[0,1]
  v_pk_add_f32 v[66:67], v[98:99], v[44:45] op_sel_hi:[1,0] neg_lo:[0,1] neg_hi:[0,1]
  v_pk_add_f32 v[68:69], v[100:101], v[44:45] op_sel_hi:[1,0] neg_lo:[0,1] neg_hi:[0,1]
  v_pk_add_f32 v[70:71], v[102:103], v[44:45] op_sel_hi:[1,0] neg_lo:[0,1] neg_hi:[0,1]
  v_pk_add_f32 v[72:73], v[104:105], v[44:45] op_sel_hi:[1,0] neg_lo:[0,1] neg_hi:[0,1]
  v_pk_add_f32 v[74:75], v[106:107], v[44:45] op_sel_hi:[1,0] neg_lo:[0,1] neg_hi:[0,1]
  v_pk_add_f32 v[76:77], v[108:109], v[44:45] op_sel_hi:[1,0] neg_lo:[0,1] neg_hi:[0,1]
  v_pk_add_f32 v[78:79], v[110:111], v[44:45] op_sel_hi:[1,0] neg_lo:[0,1] neg_hi:[0,1]
  v_pk_fma_f32 v[112:113], v[64:65], v[64:65], v[112:113]
  v_pk_fma_f32 v[114:115], v[66:67], v[66:67], v[114:115]
  v_pk_fma_f32 v[116:117], v[68:69], v[68:69], v[116:117]
  v_pk_fma_f32 v[118:119], v[70:71], v[70:71], v[118:119]
  v_pk_fma_f32 v[112:113], v[72:73], v[72:73], v[112:113]
  v_pk_fma_f32 v[114:115], v[74:75], v[74:75], v[114:115]
  v_pk_fma_f32 v[116:117], v[76:77], v[76:77], v[116:117]
  v_pk_fma_f32 v[118:119], v[78:79], v[78:79], v[118:119]
  v_pk_add_f32 v[112:113], v[112:113], v[114:115]
  v_pk_add_f32 v[116:117], v[116:117], v[118:119]
  v_pk_add_f32 v[46:47], v[112:113], v[116:117]
  v_add_f32 v46, v46, v47
  v_cvt_pk_bf16_f32 v44, 0, v44
  s_nop 0
  v_add_f32_dpp v46, v46, v46 quad_perm:[1,0,3,2] row_mask:0xf bank_mask:0xf
  s_nop 1
  v_add_f32_dpp v46, v46, v46 quad_perm:[2,3,0,1] row_mask:0xf bank_mask:0xf
  s_nop 1
  v_add_f32_dpp v46, v46, v46 row_half_mirror row_mask:0xf bank_mask:0xf
  s_nop 1
  v_add_f32_dpp v46, v46, v46 row_mirror row_mask:0xf bank_mask:0xf
  v_mov_b32 v47, v46
  s_nop 1
  v_permlane16_swap_b32 v46, v47
  v_add_f32 v46, v46, v47
  v_mul_f32 v46, s56, v46
  v_cvt_pk_bf16_f32 v46, 0, v46
  v_add_f32 v46, 0x3727c5ac, v46
  v_cvt_pk_bf16_f32 v46, 0, v46
  v_sqrt_f32 v46, v46
  v_pk_add_f32 v[80:81], v[80:81], v[44:45] op_sel_hi:[1,0] neg_lo:[0,1] neg_hi:[0,1]
  v_pk_add_f32 v[82:83], v[82:83], v[44:45] op_sel_hi:[1,0] neg_lo:[0,1] neg_hi:[0,1]
  v_pk_add_f32 v[84:85], v[84:85], v[44:45] op_sel_hi:[1,0] neg_lo:[0,1] neg_hi:[0,1]
  v_pk_add_f32 v[86:87], v[86:87], v[44:45] op_sel_hi:[1,0] neg_lo:[0,1] neg_hi:[0,1]
  v_pk_add_f32 v[88:89], v[88:89], v[44:45] op_sel_hi:[1,0] neg_lo:[0,1] neg_hi:[0,1]
  v_pk_add_f32 v[90:91], v[90:91], v[44:45] op_sel_hi:[1,0] neg_lo:[0,1] neg_hi:[0,1]
  v_pk_add_f32 v[92:93], v[92:93], v[44:45] op_sel_hi:[1,0] neg_lo:[0,1] neg_hi:[0,1]
  v_pk_add_f32 v[94:95], v[94:95], v[44:45] op_sel_hi:[1,0] neg_lo:[0,1] neg_hi:[0,1]
  v_pk_add_f32 v[96:97], v[96:97], v[44:45] op_sel_hi:[1,0] neg_lo:[0,1] neg_hi:[0,1]
  v_pk_add_f32 v[98:99], v[98:99], v[44:45] op_sel_hi:[1,0] neg_lo:[0,1] neg_hi:[0,1]
  v_pk_add_f32 v[100:101], v[100:101], v[44:45] op_sel_hi:[1,0] neg_lo:[0,1] neg_hi:[0,1]
  v_pk_add_f32 v[102:103], v[102:103], v[44:45] op_sel_hi:[1,0] neg_lo:[0,1] neg_hi:[0,1]
  v_pk_add_f32 v[104:105], v[104:105], v[44:45] op_sel_hi:[1,0] neg_lo:[0,1] neg_hi:[0,1]
  v_pk_add_f32 v[106:107], v[106:107], v[44:45] op_sel_hi:[1,0] neg_lo:[0,1] neg_hi:[0,1]
  v_pk_add_f32 v[108:109], v[108:109], v[44:45] op_sel_hi:[1,0] neg_lo:[0,1] neg_hi:[0,1]
  v_pk_add_f32 v[110:111], v[110:111], v[44:45] op_sel_hi:[1,0] neg_lo:[0,1] neg_hi:[0,1]
  v_cvt_pk_bf16_f32 v46, 0, v46
  v_rcp_f32 v46, v46
  v_cvt_pk_bf16_f32 v80, 0, v80
  v_cvt_pk_bf16_f32 v81, 0, v81
  v_cvt_pk_bf16_f32 v82, 0, v82
  v_cvt_pk_bf16_f32 v83, 0, v83
  v_cvt_pk_bf16_f32 v84, 0, v84
  v_cvt_pk_bf16_f32 v85, 0, v85
  v_cvt_pk_bf16_f32 v86, 0, v86
  v_cvt_pk_bf16_f32 v87, 0, v87
  v_pk_mul_f32 v[80:81], v[80:81], v[46:47] op_sel_hi:[1,0]
  v_pk_mul_f32 v[82:83], v[82:83], v[46:47] op_sel_hi:[1,0]
  v_pk_mul_f32 v[84:85], v[84:85], v[46:47] op_sel_hi:[1,0]
  v_pk_mul_f32 v[86:87], v[86:87], v[46:47] op_sel_hi:[1,0]
  v_cvt_pk_bf16_f32 v64, v80, v81
  v_cvt_pk_bf16_f32 v65, v82, v83
  v_cvt_pk_bf16_f32 v66, v84, v85
  v_cvt_pk_bf16_f32 v67, v86, v87
  ds_write_b128 v38, v[64:67] offset:0
  v_cvt_pk_bf16_f32 v88, 0, v88
  v_cvt_pk_bf16_f32 v89, 0, v89
  v_cvt_pk_bf16_f32 v90, 0, v90
  v_cvt_pk_bf16_f32 v91, 0, v91
  v_cvt_pk_bf16_f32 v92, 0, v92
  v_cvt_pk_bf16_f32 v93, 0, v93
  v_cvt_pk_bf16_f32 v94, 0, v94
  v_cvt_pk_bf16_f32 v95, 0, v95
  v_pk_mul_f32 v[88:89], v[88:89], v[46:47] op_sel_hi:[1,0]
  v_pk_mul_f32 v[90:91], v[90:91], v[46:47] op_sel_hi:[1,0]
  v_pk_mul_f32 v[92:93], v[92:93], v[46:47] op_sel_hi:[1,0]
  v_pk_mul_f32 v[94:95], v[94:95], v[46:47] op_sel_hi:[1,0]
  v_cvt_pk_bf16_f32 v68, v88, v89
  v_cvt_pk_bf16_f32 v69, v90, v91
  v_cvt_pk_bf16_f32 v70, v92, v93
  v_cvt_pk_bf16_f32 v71, v94, v95
  ds_write_b128 v38, v[68:71] offset:4096
  v_cvt_pk_bf16_f32 v96, 0, v96
  v_cvt_pk_bf16_f32 v97, 0, v97
  v_cvt_pk_bf16_f32 v98, 0, v98
  v_cvt_pk_bf16_f32 v99, 0, v99
  v_cvt_pk_bf16_f32 v100, 0, v100
  v_cvt_pk_bf16_f32 v101, 0, v101
  v_cvt_pk_bf16_f32 v102, 0, v102
  v_cvt_pk_bf16_f32 v103, 0, v103
  v_pk_mul_f32 v[96:97], v[96:97], v[46:47] op_sel_hi:[1,0]
  v_pk_mul_f32 v[98:99], v[98:99], v[46:47] op_sel_hi:[1,0]
  v_pk_mul_f32 v[100:101], v[100:101], v[46:47] op_sel_hi:[1,0]
  v_pk_mul_f32 v[102:103], v[102:103], v[46:47] op_sel_hi:[1,0]
  v_cvt_pk_bf16_f32 v72, v96, v97
  v_cvt_pk_bf16_f32 v73, v98, v99
  v_cvt_pk_bf16_f32 v74, v100, v101
  v_cvt_pk_bf16_f32 v75, v102, v103
  ds_write_b128 v38, v[72:75] offset:8192
  v_cvt_pk_bf16_f32 v104, 0, v104
  v_cvt_pk_bf16_f32 v105, 0, v105
  v_cvt_pk_bf16_f32 v106, 0, v106
  v_cvt_pk_bf16_f32 v107, 0, v107
  v_cvt_pk_bf16_f32 v108, 0, v108
  v_cvt_pk_bf16_f32 v109, 0, v109
  v_cvt_pk_bf16_f32 v110, 0, v110
  v_cvt_pk_bf16_f32 v111, 0, v111
  v_pk_mul_f32 v[104:105], v[104:105], v[46:47] op_sel_hi:[1,0]
  v_pk_mul_f32 v[106:107], v[106:107], v[46:47] op_sel_hi:[1,0]
  v_pk_mul_f32 v[108:109], v[108:109], v[46:47] op_sel_hi:[1,0]
  v_pk_mul_f32 v[110:111], v[110:111], v[46:47] op_sel_hi:[1,0]
  v_cvt_pk_bf16_f32 v76, v104, v105
  v_cvt_pk_bf16_f32 v77, v106, v107
  v_cvt_pk_bf16_f32 v78, v108, v109
  v_cvt_pk_bf16_f32 v79, v110, v111
  ds_write_b128 v38, v[76:79] offset:12288
  s_waitcnt lgkmcnt(0)
  s_barrier
  ds_read_b128 v[80:83], v39 offset:0
  ds_read_b128 v[84:87], v39 offset:4096
  ds_read_b128 v[88:91], v39 offset:8192
  ds_read_b128 v[92:95], v39 offset:12288
  s_waitcnt lgkmcnt(3)
  buffer_store_dwordx4 v[80:83], v40, s[24:27], s6 offen sc1
  s_add_u32 s6, s6, 1048576
  s_waitcnt lgkmcnt(2)
  buffer_store_dwordx4 v[84:87], v40, s[24:27], s6 offen sc1
  s_add_u32 s6, s6, 1048576
  s_waitcnt lgkmcnt(1)
  buffer_store_dwordx4 v[88:91], v40, s[24:27], s6 offen sc1
  s_add_u32 s6, s6, 1048576
  s_waitcnt lgkmcnt(0)
  buffer_store_dwordx4 v[92:95], v40, s[24:27], s6 offen sc1
  ds_read_b128 a[208:211], v49 offset:0
  ds_read_b128 a[212:215], v49 offset:4096
  ds_read_b128 a[216:219], v49 offset:8192
  ds_read_b128 a[220:223], v49 offset:12288
  v_mov_b32 v0, v40
  s_add_u32 s49, s6, 0x2f00000
  s_waitcnt vmcnt(0)
  s_mov_b32 s65, 0
L_ga_tag:
  v_readfirstlane_b32 s72, v36
  v_readfirstlane_b32 s73, v37
  s_add_u32 s65, s65, 1
  s_cmp_lg_u32 s72, 0
  s_cbranch_scc1 L_ga_tagok
  s_sleep 2
  global_load_dwordx2 v[36:37], v35, s[74:75] sc1
  s_waitcnt vmcnt(0)
  s_cmp_lt_u32 s65, 0x200000
  s_cbranch_scc1 L_ga_tag
L_ga_tagok:
  s_waitcnt lgkmcnt(0)
  s_barrier
  buffer_store_dwordx2 v[36:37], v42, s[24:27], s7 offen sc1
  s_add_u32 m0, s38, 49152
  s_nop 0
  buffer_load_dwordx4 v2, s[8:11], s35 offen lds
  s_add_u32 s35, s35, 98304
  s_add_u32 m0, s38, 53248
  s_nop 0
  buffer_load_dwordx4 v2, s[8:11], s35 offen lds
  s_add_u32 s35, s35, 98304
  s_add_u32 m0, s38, 57344
  s_nop 0
  buffer_load_dwordx4 v2, s[8:11], s35 offen lds
  s_add_u32 s35, s35, 98304
  s_add_u32 m0, s38, 61440
  s_nop 0
  buffer_load_dwordx4 v2, s[8:11], s35 offen lds
  s_add_u32 s35, s35, 98304
  s_add_u32 m0, s38, 65536
  s_nop 0
  buffer_load_dwordx4 v2, s[8:11], s35 offen lds
  s_add_u32 s35, s35, 98304
  s_add_u32 m0, s38, 69632
  s_nop 0
  buffer_load_dwordx4 v2, s[8:11], s35 offen lds
  s_add_u32 s35, s35, 98304
  s_add_u32 m0, s38, 73728
  s_nop 0
  buffer_load_dwordx4 v2, s[8:11], s35 offen lds
  s_add_u32 s35, s35, 98304
  s_add_u32 m0, s38, 77824
  s_nop 0
  buffer_load_dwordx4 v2, s[8:11], s35 offen lds
  s_add_u32 s35, s35, 98304
  s_add_u32 m0, s38, 81920
  s_nop 0
  buffer_load_dwordx4 v2, s[8:11], s35 offen lds
  s_add_u32 s35, s35, 98304
  s_add_u32 m0, s38, 86016
  s_nop 0
  buffer_load_dwordx4 v2, s[8:11], s35 offen lds
  s_add_u32 s35, s35, 98304
  s_add_u32 m0, s38, 90112
  s_nop 0
  buffer_load_dwordx4 v2, s[8:11], s35 offen lds
  s_add_u32 s35, s35, 98304
  s_add_u32 m0, s38, 94208
  s_nop 0
  buffer_load_dwordx4 v2, s[8:11], s35 offen lds
  s_add_u32 s35, s35, 98304
  s_mov_b32 s35, 0
  s_mov_b32 s10, 5111808
  s_mov_b32 s60, s42
  s_and_b32 s61, s43, 0xffff
  s_mov_b32 s62, 0x10000
  s_mov_b32 s63, 0x20000
  s_and_b32 s56, s32, 1
  s_lshl_b32 s56, s56, 10
  s_add_u32 m0, s56, 98304
  s_lshl_b32 s57, s33, 11
  s_add_u32 s56, s56, s57
  buffer_load_dwordx4 v21, s[60:63], s56 offen lds
  s_add_u32 m0, s38, 0
  s_nop 0
  buffer_load_dwordx4 v2, s[8:11], s35 offen lds
  s_add_u32 s35, s35, 98304
  s_add_u32 m0, s38, 4096
  s_nop 0
  buffer_load_dwordx4 v2, s[8:11], s35 offen lds
  s_add_u32 s35, s35, 98304
  s_add_u32 m0, s38, 8192
  s_nop 0
  buffer_load_dwordx4 v2, s[8:11], s35 offen lds
  s_add_u32 s35, s35, 98304
  s_add_u32 m0, s38, 12288
  s_nop 0
  buffer_load_dwordx4 v2, s[8:11], s35 offen lds
  s_add_u32 s35, s35, 98304
  s_mov_b32 s65, 0
L_ga_lnp:
  buffer_load_dwordx2 v[44:45], v41, s[24:27], s3 offen sc1
  s_waitcnt vmcnt(0)
  v_cmp_ne_u64 vcc, v[44:45], v[36:37]
  s_add_u32 s65, s65, 1
  s_cmp_eq_u64 vcc, 0
  s_cbranch_scc1 L_ga_lnok
  s_sleep 4
  s_cmp_lt_u32 s65, 0x200000
  s_cbranch_scc1 L_ga_lnp
L_ga_lnok:
  buffer_load_dwordx4 a[32:35], v4, s[20:23], s39 offen offset:0 sc1
  buffer_load_dwordx4 a[36:39], v4, s[20:23], s39 offen offset:1024 sc1
  buffer_load_dwordx4 a[40:43], v4, s[20:23], s39 offen offset:2048 sc1
  buffer_load_dwordx4 a[44:47], v4, s[20:23], s39 offen offset:3072 sc1
  s_add_u32 s39, s39, 0x20000
  buffer_load_dwordx4 a[48:51], v4, s[20:23], s39 offen offset:0 sc1
  buffer_load_dwordx4 a[52:55], v4, s[20:23], s39 offen offset:1024 sc1
  buffer_load_dwordx4 a[56:59], v4, s[20:23], s39 offen offset:2048 sc1
  buffer_load_dwordx4 a[60:63], v4, s[20:23], s39 offen offset:3072 sc1
  s_add_u32 s39, s39, 0x20000
  s_barrier
  ds_read_b64_tr_b16 a[160:161], v7 offset:0
  ds_read_b64_tr_b16 a[162:163], v7 offset:1024
  ds_read_b64_tr_b16 a[164:165], v7 offset:8192
  ds_read_b64_tr_b16 a[166:167], v7 offset:9216
  ds_read_b64_tr_b16 a[168:169], v7 offset:32
  ds_read_b64_tr_b16 a[170:171], v7 offset:1056
  ds_read_b64_tr_b16 a[172:173], v7 offset:8224
  ds_read_b64_tr_b16 a[174:175], v7 offset:9248
  buffer_load_dwordx4 a[0:3], v4, s[20:23], s39 offen offset:0 sc1
  buffer_load_dwordx4 a[4:7], v4, s[20:23], s39 offen offset:1024 sc1
  buffer_load_dwordx4 a[8:11], v4, s[20:23], s39 offen offset:2048 sc1
  buffer_load_dwordx4 a[12:15], v4, s[20:23], s39 offen offset:3072 sc1
  s_add_u32 s39, s39, 0x20000
  buffer_load_dwordx4 a[16:19], v4, s[20:23], s39 offen offset:0 sc1
  buffer_load_dwordx4 a[20:23], v4, s[20:23], s39 offen offset:1024 sc1
  buffer_load_dwordx4 a[24:27], v4, s[20:23], s39 offen offset:2048 sc1
  buffer_load_dwordx4 a[28:31], v4, s[20:23], s39 offen offset:3072 sc1
  s_add_u32 s39, s39, 0x20000
  buffer_load_dword a255, v22, s[28:31], 0 offen
  s_waitcnt vmcnt(9)
  s_waitcnt lgkmcnt(4)
  v_mfma_f32_16x16x32_bf16 v[32:35], a[160:163], a[32:35], 0
  ds_read_b64_tr_b16 a[176:177], v7 offset:64
  v_bfe_u32 v8, v1, 4, 1
  v_mfma_f32_16x16x32_bf16 v[32:35], a[164:167], a[48:51], v[32:35]
  buffer_load_dwordx4 a[128:131], v4, s[20:23], s39 offen offset:0 sc1
  v_lshlrev_b32 v8, 10, v8
  v_mfma_f32_16x16x32_bf16 v[36:39], a[160:163], a[36:39], 0
  ds_read_b64_tr_b16 a[178:179], v7 offset:1088
  v_lshrrev_b32 v9, 5, v1
  v_mfma_f32_16x16x32_bf16 v[36:39], a[164:167], a[52:55], v[36:39]
  v_lshl_add_u32 v8, v9, 8, v8
  v_and_b32 v9, 15, v1
  v_mfma_f32_16x16x32_bf16 v[40:43], a[160:163], a[40:43], 0
  ds_read_b64_tr_b16 a[180:181], v7 offset:8256
  v_lshl_add_u32 v8, v9, 4, v8
  v_mfma_f32_16x16x32_bf16 v[40:43], a[164:167], a[56:59], v[40:43]
  buffer_load_dwordx4 a[132:135], v4, s[20:23], s39 offen offset:1024 sc1
  s_lshl_b32 s56, s34, 14
  v_mfma_f32_16x16x32_bf16 v[44:47], a[160:163], a[44:47], 0
  ds_read_b64_tr_b16 a[182:183], v7 offset:9280
  v_lshl_add_u32 v9, v10, 12, v8
  v_mfma_f32_16x16x32_bf16 v[44:47], a[164:167], a[60:63], v[44:47]
  v_add_u32 v9, s56, v9
  s_waitcnt lgkmcnt(4)
  v_mfma_f32_16x16x32_bf16 v[48:51], a[168:171], a[32:35], 0
  ds_read_b64_tr_b16 a[184:185], v7 offset:96
  s_cmp_eq_u32 s32, 1
  s_cselect_b32 s28, s44, s40
  s_cselect_b32 s29, s45, s41
  s_cselect_b32 s57, 7, 6
  v_mfma_f32_16x16x32_bf16 v[48:51], a[172:175], a[48:51], v[48:51]
  buffer_load_dwordx4 a[136:139], v4, s[20:23], s39 offen offset:2048 sc1
  s_cmp_eq_u32 s32, 2
  s_cselect_b32 s28, s46, s28
  s_cselect_b32 s29, s47, s29
  s_cselect_b32 s57, 7, s57
  v_mfma_f32_16x16x32_bf16 v[52:55], a[168:171], a[36:39], 0
  ds_read_b64_tr_b16 a[186:187], v7 offset:1120
  s_lshl_b32 s56, s57, 10
  v_mfma_f32_16x16x32_bf16 v[52:55], a[172:175], a[52:55], v[52:55]
  s_and_b32 s29, s29, 0xffff
  s_lshl_b32 s30, s56, 10
  s_mov_b32 s31, 0x20000
  v_mfma_f32_16x16x32_bf16 v[56:59], a[168:171], a[40:43], 0
  ds_read_b64_tr_b16 a[188:189], v7 offset:8288
  s_cmp_gt_u32 s32, 2
  s_cselect_b32 s30, 0, s30
  v_mfma_f32_16x16x32_bf16 v[56:59], a[172:175], a[56:59], v[56:59]
  buffer_load_dwordx4 a[140:143], v4, s[20:23], s39 offen offset:3072 sc1
  s_add_u32 s39, s39, 0x20000
  v_mfma_f32_16x16x32_bf16 v[60:63], a[168:171], a[44:47], 0
  ds_read_b64_tr_b16 a[190:191], v7 offset:9312
  v_and_b32 v10, 7, v1
  v_mfma_f32_16x16x32_bf16 v[60:63], a[172:175], a[60:63], v[60:63]
  s_mul_i32 s58, s54, 896
  v_lshlrev_b32 v22, 7, v10
  v_add_u32 v22, s58, v22
  s_waitcnt lgkmcnt(4)
  v_mfma_f32_16x16x32_bf16 v[64:67], a[176:179], a[32:35], 0
  ds_read_b64_tr_b16 a[160:161], v7 offset:128
  v_lshrrev_b32 v11, 1, v10
  v_lshlrev_b32 v11, 11, v11
  v_and_b32 v12, 1, v10
  v_lshl_add_u32 v11, v12, 7, v11
  v_mfma_f32_16x16x32_bf16 v[64:67], a[180:183], a[48:51], v[64:67]
  buffer_load_dwordx4 a[144:147], v4, s[20:23], s39 offen offset:0 sc1
  s_lshl_b32 s58, s54, 8
  v_add_u32 v11, s58, v11
  v_mfma_f32_16x16x32_bf16 v[68:71], a[176:179], a[36:39], 0
  ds_read_b64_tr_b16 a[162:163], v7 offset:1152
  s_cmp_eq_u32 s57, 6
  s_cselect_b64 vcc, -1, 0
  v_mfma_f32_16x16x32_bf16 v[68:71], a[180:183], a[52:55], v[68:71]
  v_cndmask_b32 v22, v22, v11, vcc
  s_lshl_b32 s58, s55, 1
  s_mov_b32 s59, 2
  v_mfma_f32_16x16x32_bf16 v[72:75], a[176:179], a[40:43], 0
  ds_read_b64_tr_b16 a[164:165], v7 offset:8320
  v_lshrrev_b32 v11, 3, v1
  v_and_b32 v12, 6, v11
  v_mul_u32_u24 v12, 31, v12
  v_add3_u32 v12, v12, v11, s58
  v_mfma_f32_16x16x32_bf16 v[72:75], a[180:183], a[56:59], v[72:75]
  buffer_load_dwordx4 a[148:151], v4, s[20:23], s39 offen offset:1024 sc1
  v_mul_lo_u32 v12, v12, s56
  v_add_u32 v22, v22, v12
  v_mfma_f32_16x16x32_bf16 v[76:79], a[176:179], a[44:47], 0
  ds_read_b64_tr_b16 a[166:167], v7 offset:9344
  v_mov_b32 v12, 0x40000000
  v_mfma_f32_16x16x32_bf16 v[76:79], a[180:183], a[60:63], v[76:79]
  v_cmp_gt_u32 vcc, s57, v10
  s_nop 1
  v_cndmask_b32 v22, v12, v22, vcc
  s_waitcnt lgkmcnt(4)
  v_mfma_f32_16x16x32_bf16 v[80:83], a[184:187], a[32:35], 0
  ds_read_b64_tr_b16 a[168:169], v7 offset:160
  v_cmp_gt_u32 vcc, s59, v11
  s_nop 1
  v_cndmask_b32 v22, v12, v22, vcc
  v_mfma_f32_16x16x32_bf16 v[80:83], a[188:191], a[48:51], v[80:83]
  buffer_load_dwordx4 a[152:155], v4, s[20:23], s39 offen offset:2048 sc1
  s_lshl_b32 s57, s56, 6
  v_mfma_f32_16x16x32_bf16 v[84:87], a[184:187], a[36:39], 0
  ds_read_b64_tr_b16 a[170:171], v7 offset:1184
  s_mul_i32 s56, s57, 4
  v_mfma_f32_16x16x32_bf16 v[84:87], a[188:191], a[52:55], v[84:87]
  s_mov_b32 s60, s50
  s_and_b32 s61, s51, 0xffff
  v_mfma_f32_16x16x32_bf16 v[88:91], a[184:187], a[40:43], 0
  ds_read_b64_tr_b16 a[172:173], v7 offset:8352
  s_mov_b32 s62, 0x200000
  v_mfma_f32_16x16x32_bf16 v[88:91], a[188:191], a[56:59], v[88:91]
  buffer_load_dwordx4 a[156:159], v4, s[20:23], s39 offen offset:3072 sc1
  s_mov_b32 s39, 0
  v_mfma_f32_16x16x32_bf16 v[92:95], a[184:187], a[44:47], 0
  ds_read_b64_tr_b16 a[174:175], v7 offset:9376
  s_mov_b32 s63, 0x20000
  v_mfma_f32_16x16x32_bf16 v[92:95], a[188:191], a[60:63], v[92:95]
  v_lshrrev_b32 v11, 3, v1
  s_waitcnt vmcnt(9)
  s_barrier
  s_waitcnt lgkmcnt(4)
  v_mfma_f32_16x16x32_bf16 v[96:99], a[32:35], a[160:163], 0
  ds_read_b64_tr_b16 a[176:177], v7 offset:16384
  v_bfe_u32 v12, v1, 1, 2
  v_mfma_f32_16x16x32_bf16 v[96:99], a[48:51], a[164:167], v[96:99]
  buffer_load_dwordx4 a[96:99], v4, s[20:23], s39 offen offset:0 sc1
  v_and_b32 v13, 2, v11
  v_mfma_f32_16x16x32_bf16 v[100:103], a[36:39], a[160:163], 0
  ds_read_b64_tr_b16 a[178:179], v7 offset:17408
  v_xor_b32 v12, v12, v13
  v_mfma_f32_16x16x32_bf16 v[100:103], a[52:55], a[164:167], v[100:103]
  v_lshlrev_b32 v23, 11, v11
  v_lshl_add_u32 v23, v12, 5, v23
  v_mfma_f32_16x16x32_bf16 v[104:107], a[40:43], a[160:163], 0
  ds_read_b64_tr_b16 a[180:181], v7 offset:24576
  v_and_b32 v13, 1, v1
  v_mfma_f32_16x16x32_bf16 v[104:107], a[56:59], a[164:167], v[104:107]
  buffer_load_dwordx4 a[100:103], v4, s[20:23], s39 offen offset:1024 sc1
  v_lshl_add_u32 v23, v13, 4, v23
  v_mfma_f32_16x16x32_bf16 v[108:111], a[44:47], a[160:163], 0
  ds_read_b64_tr_b16 a[182:183], v7 offset:25600
  v_add_u32 v24, 15360, v23
  v_mfma_f32_16x16x32_bf16 v[108:111], a[60:63], a[164:167], v[108:111]
  s_lshl_b32 s64, s2, 2
  s_waitcnt lgkmcnt(4)
  v_mfma_f32_16x16x32_bf16 v[112:115], a[32:35], a[168:171], 0
  ds_read_b64_tr_b16 a[184:185], v7 offset:16416
  s_add_u32 s64, s64, s32
  v_mfma_f32_16x16x32_bf16 v[112:115], a[48:51], a[172:175], v[112:115]
  buffer_load_dwordx4 a[104:107], v4, s[20:23], s39 offen offset:2048 sc1
  s_lshr_b32 s58, s64, 4
  v_mfma_f32_16x16x32_bf16 v[116:119], a[36:39], a[168:171], 0
  ds_read_b64_tr_b16 a[186:187], v7 offset:17440
  s_lshl_b32 s58, s58, 15
  v_mfma_f32_16x16x32_bf16 v[116:119], a[52:55], a[172:175], v[116:119]
  s_and_b32 s65, s64, 15
  s_lshl_b32 s65, s65, 7
  v_mfma_f32_16x16x32_bf16 v[120:123], a[40:43], a[168:171], 0
  ds_read_b64_tr_b16 a[188:189], v7 offset:24608
  s_add_u32 s58, s58, s65
  v_mfma_f32_16x16x32_bf16 v[120:123], a[56:59], a[172:175], v[120:123]
  buffer_load_dwordx4 a[108:111], v4, s[20:23], s39 offen offset:3072 sc1
  s_add_u32 s39, s39, 0x20000
  v_mfma_f32_16x16x32_bf16 v[124:127], a[44:47], a[168:171], 0
  ds_read_b64_tr_b16 a[190:191], v7 offset:25632
  s_lshr_b32 s59, s64, 5
  v_mfma_f32_16x16x32_bf16 v[124:127], a[60:63], a[172:175], v[124:127]
  s_lshl_b32 s59, s59, 16
  s_waitcnt lgkmcnt(4)
  v_mfma_f32_16x16x32_bf16 v[32:35], a[176:179], a[0:3], v[32:35]
  ds_read_b64_tr_b16 a[160:161], v7 offset:16448
  s_lshl_b32 s65, s65, 5
  v_mfma_f32_16x16x32_bf16 v[32:35], a[180:183], a[16:19], v[32:35]
  buffer_load_dwordx4 a[112:115], v4, s[20:23], s39 offen offset:0 sc1
  s_add_u32 s59, s59, s65
  v_mfma_f32_16x16x32_bf16 v[36:39], a[176:179], a[4:7], v[36:39]
  ds_read_b64_tr_b16 a[162:163], v7 offset:17472
  s_and_b32 s65, s64, 16
  v_mfma_f32_16x16x32_bf16 v[36:39], a[180:183], a[20:23], v[36:39]
  s_lshl_b32 s65, s65, 5
  s_add_u32 s59, s59, s65
  v_mfma_f32_16x16x32_bf16 v[40:43], a[176:179], a[8:11], v[40:43]
  ds_read_b64_tr_b16 a[164:165], v7 offset:24640
  s_add_u32 s59, s59, 0x2600000
  v_mfma_f32_16x16x32_bf16 v[40:43], a[180:183], a[24:27], v[40:43]
  buffer_load_dwordx4 a[116:119], v4, s[20:23], s39 offen offset:1024 sc1
  s_and_b32 s54, s64, 15
  v_mfma_f32_16x16x32_bf16 v[44:47], a[176:179], a[12:15], v[44:47]
  ds_read_b64_tr_b16 a[166:167], v7 offset:25664
  s_lshl_b32 s54, s54, 12
  v_mfma_f32_16x16x32_bf16 v[44:47], a[180:183], a[28:31], v[44:47]
  s_add_u32 s54, s54, 0x2800000
  s_waitcnt lgkmcnt(4)
  v_mfma_f32_16x16x32_bf16 v[48:51], a[184:187], a[0:3], v[48:51]
  ds_read_b64_tr_b16 a[168:169], v7 offset:16480
  s_lshl_b32 s64, s32, 11
  v_mfma_f32_16x16x32_bf16 v[48:51], a[188:191], a[16:19], v[48:51]
  buffer_load_dwordx4 a[120:123], v4, s[20:23], s39 offen offset:2048 sc1
  s_add_u32 s64, s64, 151552
  v_mfma_f32_16x16x32_bf16 v[52:55], a[184:187], a[4:7], v[52:55]
  ds_read_b64_tr_b16 a[170:171], v7 offset:17504
  v_lshrrev_b32 v11, 5, v1
  v_mfma_f32_16x16x32_bf16 v[52:55], a[188:191], a[20:23], v[52:55]
  v_bfe_u32 v12, v1, 2, 2
  v_lshl_add_u32 v11, v11, 3, v12
  v_mfma_f32_16x16x32_bf16 v[56:59], a[184:187], a[8:11], v[56:59]
  ds_read_b64_tr_b16 a[172:173], v7 offset:24672
  v_bfe_u32 v13, v1, 4, 1
  v_mfma_f32_16x16x32_bf16 v[56:59], a[188:191], a[24:27], v[56:59]
  buffer_load_dwordx4 a[124:127], v4, s[20:23], s39 offen offset:3072 sc1
  s_add_u32 s39, s39, 0x20000
  v_mfma_f32_16x16x32_bf16 v[60:63], a[184:187], a[12:15], v[60:63]
  ds_read_b64_tr_b16 a[174:175], v7 offset:25696
  v_and_b32 v14, 3, v1
  v_mfma_f32_16x16x32_bf16 v[60:63], a[188:191], a[28:31], v[60:63]
  v_lshlrev_b32 v5, 6, v11
  s_waitcnt lgkmcnt(4)
  v_mfma_f32_16x16x32_bf16 v[64:67], a[160:163], a[0:3], v[64:67]
  ds_read_b64_tr_b16 a[176:177], v7 offset:16512
  v_lshl_add_u32 v5, v13, 5, v5
  v_mfma_f32_16x16x32_bf16 v[64:67], a[164:167], a[16:19], v[64:67]
  s_add_u32 m0, s38, 16384
  v_lshl_add_u32 v5, v14, 3, v5
  v_mfma_f32_16x16x32_bf16 v[68:71], a[160:163], a[4:7], v[68:71]
  ds_read_b64_tr_b16 a[178:179], v7 offset:17536
  buffer_load_dwordx4 v3, s[12:15], s36 offen lds
  v_mfma_f32_16x16x32_bf16 v[68:71], a[164:167], a[20:23], v[68:71]
  s_add_u32 s36, s36, 114688
  v_add_u32 v5, 98304, v5
  v_mfma_f32_16x16x32_bf16 v[72:75], a[160:163], a[8:11], v[72:75]
  ds_read_b64_tr_b16 a[180:181], v7 offset:24704
  v_and_b32 v12, 2, v12
  v_mfma_f32_16x16x32_bf16 v[72:75], a[164:167], a[24:27], v[72:75]
  s_add_u32 m0, s38, 20480
  v_xor_b32 v13, v13, v12
  v_mfma_f32_16x16x32_bf16 v[76:79], a[160:163], a[12:15], v[76:79]
  ds_read_b64_tr_b16 a[182:183], v7 offset:25728
  buffer_load_dwordx4 v3, s[12:15], s36 offen lds
  v_mfma_f32_16x16x32_bf16 v[76:79], a[164:167], a[28:31], v[76:79]
  s_add_u32 s36, s36, 114688
  s_waitcnt lgkmcnt(4)
  v_mfma_f32_16x16x32_bf16 v[80:83], a[168:171], a[0:3], v[80:83]
  ds_read_b64_tr_b16 a[184:185], v7 offset:16544
  v_lshlrev_b32 v25, 7, v11
  v_mfma_f32_16x16x32_bf16 v[80:83], a[172:175], a[16:19], v[80:83]
  s_add_u32 m0, s38, 24576
  v_lshl_add_u32 v25, v14, 3, v25
  v_mfma_f32_16x16x32_bf16 v[84:87], a[168:171], a[4:7], v[84:87]
  ds_read_b64_tr_b16 a[186:187], v7 offset:17568
  buffer_load_dwordx4 v3, s[12:15], s36 offen lds
  v_mfma_f32_16x16x32_bf16 v[84:87], a[172:175], a[20:23], v[84:87]
  s_add_u32 s36, s36, 114688
  v_add_u32 v25, s64, v25
  v_mfma_f32_16x16x32_bf16 v[88:91], a[168:171], a[8:11], v[88:91]
  ds_read_b64_tr_b16 a[188:189], v7 offset:24736
  v_xor_b32 v12, 2, v13
  v_mfma_f32_16x16x32_bf16 v[88:91], a[172:175], a[24:27], v[88:91]
  s_add_u32 m0, s38, 28672
  v_lshl_add_u32 v26, v12, 5, v25
  v_mfma_f32_16x16x32_bf16 v[92:95], a[168:171], a[12:15], v[92:95]
  ds_read_b64_tr_b16 a[190:191], v7 offset:25760
  buffer_load_dwordx4 v3, s[12:15], s36 offen lds
  v_mfma_f32_16x16x32_bf16 v[92:95], a[172:175], a[28:31], v[92:95]
  s_add_u32 s36, s36, 114688
  s_waitcnt vmcnt(12)
  s_barrier
  s_waitcnt lgkmcnt(4)
  v_mfma_f32_16x16x32_bf16 v[96:99], a[0:3], a[176:179], v[96:99]
  ds_read_b64_tr_b16 a[160:161], v7 offset:32768
  v_lshl_add_u32 v25, v13, 5, v25
  v_mfma_f32_16x16x32_bf16 v[96:99], a[16:19], a[180:183], v[96:99]
  s_add_u32 m0, s38, 32768
  v_and_b32 v10, 31, v1
  v_mfma_f32_16x16x32_bf16 v[100:103], a[4:7], a[176:179], v[100:103]
  ds_read_b64_tr_b16 a[162:163], v7 offset:33792
  buffer_load_dwordx4 v3, s[16:19], s37 offen lds
  v_mfma_f32_16x16x32_bf16 v[100:103], a[20:23], a[180:183], v[100:103]
  s_add_u32 s37, s37, 114688
  v_mul_u32_u24 v10, 136, v10
  v_mfma_f32_16x16x32_bf16 v[104:107], a[8:11], a[176:179], v[104:107]
  ds_read_b64_tr_b16 a[164:165], v7 offset:40960
  v_lshrrev_b32 v11, 5, v1
  v_mfma_f32_16x16x32_bf16 v[104:107], a[24:27], a[180:183], v[104:107]
  s_add_u32 m0, s38, 36864
  v_lshl_add_u32 v10, v11, 3, v10
  v_mfma_f32_16x16x32_bf16 v[108:111], a[12:15], a[176:179], v[108:111]
  ds_read_b64_tr_b16 a[166:167], v7 offset:41984
  buffer_load_dwordx4 v3, s[16:19], s37 offen lds
  v_mfma_f32_16x16x32_bf16 v[108:111], a[28:31], a[180:183], v[108:111]
  s_add_u32 s37, s37, 114688
  s_waitcnt lgkmcnt(4)
  v_mfma_f32_16x16x32_bf16 v[112:115], a[0:3], a[184:187], v[112:115]
  ds_read_b64_tr_b16 a[168:169], v7 offset:32800
  s_mul_i32 s65, s32, 8704
  v_mfma_f32_16x16x32_bf16 v[112:115], a[16:19], a[188:191], v[112:115]
  s_add_u32 m0, s38, 40960
  s_add_u32 s65, s65, 100352
  v_mfma_f32_16x16x32_bf16 v[116:119], a[4:7], a[184:187], v[116:119]
  ds_read_b64_tr_b16 a[170:171], v7 offset:33824
  buffer_load_dwordx4 v3, s[16:19], s37 offen lds
  v_mfma_f32_16x16x32_bf16 v[116:119], a[20:23], a[188:191], v[116:119]
  s_add_u32 s37, s37, 114688
  v_add_u32 v10, s65, v10
  v_mfma_f32_16x16x32_bf16 v[120:123], a[8:11], a[184:187], v[120:123]
  ds_read_b64_tr_b16 a[172:173], v7 offset:40992
  v_lshlrev_b32 v19, 3, v11
  v_mfma_f32_16x16x32_bf16 v[120:123], a[24:27], a[188:191], v[120:123]
  s_add_u32 m0, s38, 45056
  v_add_u32 v19, 152576, v19
  v_mfma_f32_16x16x32_bf16 v[124:127], a[12:15], a[184:187], v[124:127]
  ds_read_b64_tr_b16 a[174:175], v7 offset:42016
  buffer_load_dwordx4 v3, s[16:19], s37 offen lds
  v_mfma_f32_16x16x32_bf16 v[124:127], a[28:31], a[188:191], v[124:127]
  s_add_u32 s37, s37, 114688
  s_waitcnt lgkmcnt(4)
  v_mfma_f32_16x16x32_bf16 v[32:35], a[160:163], a[128:131], v[32:35]
  ds_read_b64_tr_b16 a[176:177], v7 offset:32832
  s_lshl_b32 s65, s32, 12
  v_mfma_f32_16x16x32_bf16 v[32:35], a[164:167], a[144:147], v[32:35]
  buffer_store_dwordx4 a[220:223], v0, s[24:27], s49 offen sc1
  s_sub_u32 s49, s49, 1048576
  v_mfma_f32_16x16x32_bf16 v[36:39], a[160:163], a[132:135], v[36:39]
  ds_read_b64_tr_b16 a[178:179], v7 offset:33856
  s_add_u32 s65, s65, 135168
  v_mfma_f32_16x16x32_bf16 v[36:39], a[164:167], a[148:151], v[36:39]
  v_add_u32 v11, s65, v21
  v_lshrrev_b32 v12, 2, v1
  v_mfma_f32_16x16x32_bf16 v[40:43], a[160:163], a[136:139], v[40:43]
  ds_read_b64_tr_b16 a[180:181], v7 offset:41024
  v_mul_u32_u24 v12, 136, v12
  v_mfma_f32_16x16x32_bf16 v[40:43], a[164:167], a[152:155], v[40:43]
  buffer_store_dwordx4 a[216:219], v0, s[24:27], s49 offen sc1
  s_sub_u32 s49, s49, 1048576
  v_mfma_f32_16x16x32_bf16 v[44:47], a[160:163], a[140:143], v[44:47]
  ds_read_b64_tr_b16 a[182:183], v7 offset:42048
  v_lshl_add_u32 v12, v14, 3, v12
  v_mfma_f32_16x16x32_bf16 v[44:47], a[164:167], a[156:159], v[44:47]
  s_lshl_b32 s65, s32, 5
  s_waitcnt lgkmcnt(4)
  v_mfma_f32_16x16x32_bf16 v[48:51], a[168:171], a[128:131], v[48:51]
  ds_read_b64_tr_b16 a[184:185], v7 offset:32864
  s_add_u32 s65, s65, 100352
  v_mfma_f32_16x16x32_bf16 v[48:51], a[172:175], a[144:147], v[48:51]
  buffer_store_dwordx4 a[212:215], v0, s[24:27], s49 offen sc1
  s_sub_u32 s49, s49, 1048576
  v_mfma_f32_16x16x32_bf16 v[52:55], a[168:171], a[132:135], v[52:55]
  ds_read_b64_tr_b16 a[186:187], v7 offset:33888
  v_add_u32 v12, s65, v12
  v_mfma_f32_16x16x32_bf16 v[52:55], a[172:175], a[148:151], v[52:55]
  v_add_u32 v13, 135168, v21
  v_lshlrev_b32 v18, 3, v14
  v_mfma_f32_16x16x32_bf16 v[56:59], a[168:171], a[136:139], v[56:59]
  ds_read_b64_tr_b16 a[188:189], v7 offset:41056
  v_add_u32 v18, s64, v18
  v_mfma_f32_16x16x32_bf16 v[56:59], a[172:175], a[152:155], v[56:59]
  buffer_store_dwordx4 a[208:211], v0, s[24:27], s49 offen sc1
  s_sub_u32 s49, s49, 1048576
  v_mfma_f32_16x16x32_bf16 v[60:63], a[168:171], a[140:143], v[60:63]
  ds_read_b64_tr_b16 a[190:191], v7 offset:42080
  v_add_u32 v18, 1024, v18
  v_mfma_f32_16x16x32_bf16 v[60:63], a[172:175], a[156:159], v[60:63]
  v_bfe_u32 v16, v1, 2, 3
  s_waitcnt lgkmcnt(4)
  v_mfma_f32_16x16x32_bf16 v[64:67], a[176:179], a[128:131], v[64:67]
  ds_read_b64_tr_b16 a[160:161], v7 offset:32896
  v_lshlrev_b32 v16, 11, v16
  v_mfma_f32_16x16x32_bf16 v[64:67], a[180:183], a[144:147], v[64:67]
  s_add_u32 m0, s38, 49152
  v_lshl_add_u32 v16, v14, 4, v16
  v_mfma_f32_16x16x32_bf16 v[68:71], a[176:179], a[132:135], v[68:71]
  ds_read_b64_tr_b16 a[162:163], v7 offset:33920
  buffer_load_dwordx4 v2, s[8:11], s35 offen lds
  v_mfma_f32_16x16x32_bf16 v[68:71], a[180:183], a[148:151], v[68:71]
  s_add_u32 s35, s35, 98304
  v_lshrrev_b32 v17, 4, v1
  v_mfma_f32_16x16x32_bf16 v[72:75], a[176:179], a[136:139], v[72:75]
  ds_read_b64_tr_b16 a[164:165], v7 offset:41088
  v_and_b32 v27, 15, v1
  v_mfma_f32_16x16x32_bf16 v[72:75], a[180:183], a[152:155], v[72:75]
  s_add_u32 m0, s38, 53248
  v_lshlrev_b32 v14, 9, v17
  v_mfma_f32_16x16x32_bf16 v[76:79], a[176:179], a[140:143], v[76:79]
  ds_read_b64_tr_b16 a[166:167], v7 offset:42112
  buffer_load_dwordx4 v2, s[8:11], s35 offen lds
  v_mfma_f32_16x16x32_bf16 v[76:79], a[180:183], a[156:159], v[76:79]
  s_add_u32 s35, s35, 98304
  s_waitcnt lgkmcnt(4)
  v_mfma_f32_16x16x32_bf16 v[80:83], a[184:187], a[128:131], v[80:83]
  ds_read_b64_tr_b16 a[168:169], v7 offset:32928
  v_lshl_add_u32 v14, v27, 4, v14
  v_mfma_f32_16x16x32_bf16 v[80:83], a[188:191], a[144:147], v[80:83]
  s_add_u32 m0, s38, 57344
  v_lshlrev_b32 v15, 4, v17
  v_mfma_f32_16x16x32_bf16 v[84:87], a[184:187], a[132:135], v[84:87]
  ds_read_b64_tr_b16 a[170:171], v7 offset:33952
  buffer_load_dwordx4 v2, s[8:11], s35 offen lds
  v_mfma_f32_16x16x32_bf16 v[84:87], a[188:191], a[148:151], v[84:87]
  s_add_u32 s35, s35, 98304
  v_cmp_eq_u32 vcc, 0, v27
  v_mfma_f32_16x16x32_bf16 v[88:91], a[184:187], a[136:139], v[88:91]
  ds_read_b64_tr_b16 a[172:173], v7 offset:41120
  v_cndmask_b32 v15, v20, v15, vcc
  v_mfma_f32_16x16x32_bf16 v[88:91], a[188:191], a[152:155], v[88:91]
  s_add_u32 m0, s38, 61440
  s_lshl_b32 s65, s33, 14
  v_mfma_f32_16x16x32_bf16 v[92:95], a[184:187], a[140:143], v[92:95]
  ds_read_b64_tr_b16 a[174:175], v7 offset:42144
  buffer_load_dwordx4 v2, s[8:11], s35 offen lds
  v_mfma_f32_16x16x32_bf16 v[92:95], a[188:191], a[156:159], v[92:95]
  s_add_u32 s35, s35, 98304
  s_waitcnt vmcnt(8)
  s_barrier
  s_waitcnt lgkmcnt(4)
  v_mfma_f32_16x16x32_bf16 v[96:99], a[128:131], a[160:163], v[96:99]
  ds_read_b64_tr_b16 a[176:177], v6 offset:0
  s_lshl_b32 s67, s32, 9
  v_mfma_f32_16x16x32_bf16 v[96:99], a[144:147], a[164:167], v[96:99]
  s_add_u32 m0, s38, 65536
  s_add_u32 s70, s65, s67
  v_mfma_f32_16x16x32_bf16 v[100:103], a[132:135], a[160:163], v[100:103]
  ds_read_b64_tr_b16 a[178:179], v6 offset:1024
  buffer_load_dwordx4 v3, s[12:15], s36 offen lds
  v_mfma_f32_16x16x32_bf16 v[100:103], a[148:151], a[164:167], v[100:103]
  s_add_u32 s36, s36, 114688
  s_add_u32 s70, s70, 0x1980000
  v_mfma_f32_16x16x32_bf16 v[104:107], a[136:139], a[160:163], v[104:107]
  ds_read_b64_tr_b16 a[180:181], v6 offset:8192
  s_lshl_b32 s65, s34, 11
  v_mfma_f32_16x16x32_bf16 v[104:107], a[152:155], a[164:167], v[104:107]
  s_add_u32 m0, s38, 69632
  s_add_u32 s55, s70, s65
  v_mfma_f32_16x16x32_bf16 v[108:111], a[140:143], a[160:163], v[108:111]
  ds_read_b64_tr_b16 a[182:183], v6 offset:9216
  buffer_load_dwordx4 v3, s[12:15], s36 offen lds
  v_mfma_f32_16x16x32_bf16 v[108:111], a[156:159], a[164:167], v[108:111]
  s_add_u32 s36, s36, 114688
  s_waitcnt lgkmcnt(4)
  v_mfma_f32_16x16x32_bf16 v[112:115], a[128:131], a[168:171], v[112:115]
  ds_read_b64_tr_b16 a[184:185], v6 offset:32
  v_cmp_gt_u32 vcc, 32, v1
  v_mfma_f32_16x16x32_bf16 v[112:115], a[144:147], a[172:175], v[112:115]
  s_nop 0
  v_cndmask_b32 v27, v20, v21, vcc
  buffer_store_dwordx4 v[28:31], v27, s[24:27], s55 offen sc1
  v_mfma_f32_16x16x32_bf16 v[116:119], a[132:135], a[168:171], v[116:119]
  ds_read_b64_tr_b16 a[186:187], v6 offset:1056
  s_mul_i32 s65, s2, 1536
  v_mfma_f32_16x16x32_bf16 v[116:119], a[148:151], a[172:175], v[116:119]
  s_mul_i32 s67, s32, 384
  s_add_u32 s65, s65, s67
  v_mfma_f32_16x16x32_bf16 v[120:123], a[136:139], a[168:171], v[120:123]
  ds_read_b64_tr_b16 a[188:189], v6 offset:8224
  s_add_u32 s65, s65, 0x1820000
  v_mfma_f32_16x16x32_bf16 v[120:123], a[152:155], a[172:175], v[120:123]
  v_cmp_gt_u32 vcc, 24, v1
  s_nop 1
  v_cndmask_b32 v27, v20, v21, vcc
  v_mfma_f32_16x16x32_bf16 v[124:127], a[140:143], a[168:171], v[124:127]
  ds_read_b64_tr_b16 a[190:191], v6 offset:9248
  buffer_store_dwordx4 v[28:31], v27, s[24:27], s65 offen sc1
  v_mfma_f32_16x16x32_bf16 v[124:127], a[156:159], a[172:175], v[124:127]
  v_cmp_eq_u32 vcc, 0, v1
  s_nop 1
  v_cndmask_b32 v20, v20, v1, vcc
  v_and_b32 v17, 7, v1
  v_lshlrev_b32 v17, 11, v17
  s_getpc_b64 s[4:5]
L_ga_pc2:
  s_add_u32 s4, s4, L_ga_loop-L_ga_pc2
  s_addc_u32 s5, s5, 0
  s_and_b32 s5, s5, 0xffff
  s_mov_b32 s6, L_code_end-L_ga_loop
  s_mov_b32 s7, 0x20000
  s_lshr_b32 s3, s2, 3
  s_lshl_b32 s3, s3, 11
  s_lshl_b32 s65, s32, 9
  s_add_u32 s3, s3, s65
  v_lshlrev_b32 v0, 7, v1
  v_mov_b32 v27, 0x40000000
  v_cmp_gt_u32 vcc, 4, v1
  s_nop 1
  v_cndmask_b32 v0, v27, v0, vcc
  s_mov_b32 s50, 0x3fb8aa3b
  s_mov_b32 s51, 0x3fb8aa3b
  s_mov_b32 s66, 0
  s_mov_b32 s71, 0x40000000
  s_and_b32 s48, s2, 7
  s_lshl_b32 s48, s48, 7
  s_add_u32 s48, s48, 0x18a1000
  s_lshr_b32 s67, s2, 3
  s_xor_b32 s67, s67, 16
  s_or_b32 s67, s67, s32
  s_cselect_b32 s67, 99, 4
  v_mfma_f32_32x32x16_bf16 a[0:15], v[28:31], v[28:31], 0
  v_mfma_f32_32x32x16_bf16 a[16:31], v[28:31], v[28:31], 0
  v_mfma_f32_32x32x16_bf16 a[32:47], v[28:31], v[28:31], 0
  v_mfma_f32_32x32x16_bf16 a[48:63], v[28:31], v[28:31], 0
.p2align 6
L_ga_loop:
  s_waitcnt lgkmcnt(4)
  v_mfma_f32_16x16x32_bf16 v[32:35], a[176:179], a[96:99], v[32:35]
  ds_read_b64_tr_b16 a[160:161], v6 offset:64
  v_mfma_f32_16x16x32_bf16 v[32:35], a[180:183], a[112:115], v[32:35]
  buffer_load_dwordx4 a[128:131], v4, s[20:23], s39 offen offset:0 sc1
  v_mfma_f32_16x16x32_bf16 v[36:39], a[176:179], a[100:103], v[36:39]
  ds_read_b64_tr_b16 a[162:163], v6 offset:1088
  v_mfma_f32_16x16x32_bf16 v[36:39], a[180:183], a[116:119], v[36:39]
  s_add_u32 m0, s38, 73728
  v_mfma_f32_16x16x32_bf16 v[40:43], a[176:179], a[104:107], v[40:43]
  ds_read_b64_tr_b16 a[164:165], v6 offset:8256
  v_mfma_f32_16x16x32_bf16 v[40:43], a[180:183], a[120:123], v[40:43]
  buffer_load_dwordx4 v3, s[12:15], s36 offen lds
  v_mfma_f32_16x16x32_bf16 v[44:47], a[176:179], a[108:111], v[44:47]
  ds_read_b64_tr_b16 a[166:167], v6 offset:9280
  v_mfma_f32_16x16x32_bf16 v[44:47], a[180:183], a[124:127], v[44:47]
  s_add_u32 s36, s36, 114688
  s_waitcnt lgkmcnt(4)
  v_mfma_f32_16x16x32_bf16 v[48:51], a[184:187], a[96:99], v[48:51]
  ds_read_b64_tr_b16 a[168:169], v6 offset:96
  v_mfma_f32_16x16x32_bf16 v[48:51], a[188:191], a[112:115], v[48:51]
  buffer_load_dwordx4 a[132:135], v4, s[20:23], s39 offen offset:1024 sc1
  v_mfma_f32_16x16x32_bf16 v[52:55], a[184:187], a[100:103], v[52:55]
  ds_read_b64_tr_b16 a[170:171], v6 offset:1120
  v_mfma_f32_16x16x32_bf16 v[52:55], a[188:191], a[116:119], v[52:55]
  s_add_u32 m0, s38, 77824
  v_mfma_f32_16x16x32_bf16 v[56:59], a[184:187], a[104:107], v[56:59]
  ds_read_b64_tr_b16 a[172:173], v6 offset:8288
  v_mfma_f32_16x16x32_bf16 v[56:59], a[188:191], a[120:123], v[56:59]
  buffer_load_dwordx4 v3, s[12:15], s36 offen lds
  v_mfma_f32_16x16x32_bf16 v[60:63], a[184:187], a[108:111], v[60:63]
  ds_read_b64_tr_b16 a[174:175], v6 offset:9312
  v_mfma_f32_16x16x32_bf16 v[60:63], a[188:191], a[124:127], v[60:63]
  s_add_u32 s36, s36, 114688
  s_waitcnt lgkmcnt(4)
  v_mfma_f32_16x16x32_bf16 v[64:67], a[160:163], a[96:99], v[64:67]
  ds_read_b64_tr_b16 a[176:177], v6 offset:128
  v_mfma_f32_16x16x32_bf16 v[64:67], a[164:167], a[112:115], v[64:67]
  buffer_load_dwordx4 a[136:139], v4, s[20:23], s39 offen offset:2048 sc1
  v_mfma_f32_16x16x32_bf16 v[68:71], a[160:163], a[100:103], v[68:71]
  ds_read_b64_tr_b16 a[178:179], v6 offset:1152
  v_mfma_f32_16x16x32_bf16 v[68:71], a[164:167], a[116:119], v[68:71]
  ds_read_b64_tr_b16 a[192:193], v25 offset:0
  v_mfma_f32_16x16x32_bf16 v[72:75], a[160:163], a[104:107], v[72:75]
  ds_read_b64_tr_b16 a[180:181], v6 offset:8320
  v_mfma_f32_16x16x32_bf16 v[72:75], a[164:167], a[120:123], v[72:75]
  ds_read_b64_tr_b16 a[194:195], v25 offset:512
  v_mfma_f32_16x16x32_bf16 v[76:79], a[160:163], a[108:111], v[76:79]
  ds_read_b64_tr_b16 a[182:183], v6 offset:9344
  v_mfma_f32_16x16x32_bf16 v[76:79], a[164:167], a[124:127], v[76:79]
  s_waitcnt lgkmcnt(6)
  v_mfma_f32_16x16x32_bf16 v[80:83], a[168:171], a[96:99], v[80:83]
  ds_read_b64_tr_b16 a[184:185], v6 offset:160
  v_mfma_f32_16x16x32_bf16 v[80:83], a[172:175], a[112:115], v[80:83]
  buffer_load_dwordx4 a[140:143], v4, s[20:23], s39 offen offset:3072 sc1
  s_add_u32 s39, s39, 0x20000
  v_mfma_f32_16x16x32_bf16 v[84:87], a[168:171], a[100:103], v[84:87]
  ds_read_b64_tr_b16 a[186:187], v6 offset:1184
  v_mfma_f32_16x16x32_bf16 v[84:87], a[172:175], a[116:119], v[84:87]
  ds_read_b64_tr_b16 a[196:197], v26 offset:0
  v_mfma_f32_16x16x32_bf16 v[88:91], a[168:171], a[104:107], v[88:91]
  ds_read_b64_tr_b16 a[188:189], v6 offset:8352
  v_mfma_f32_16x16x32_bf16 v[88:91], a[172:175], a[120:123], v[88:91]
  ds_read_b64_tr_b16 a[198:199], v26 offset:512
  v_mfma_f32_16x16x32_bf16 v[92:95], a[168:171], a[108:111], v[92:95]
  ds_read_b64_tr_b16 a[190:191], v6 offset:9376
  v_mfma_f32_16x16x32_bf16 v[92:95], a[172:175], a[124:127], v[92:95]
  s_barrier
  s_waitcnt lgkmcnt(6)
  v_mfma_f32_16x16x32_bf16 v[96:99], a[96:99], a[176:179], v[96:99]
  ds_read_b64_tr_b16 a[160:161], v6 offset:16384
  v_mfma_f32_16x16x32_bf16 v[96:99], a[112:115], a[180:183], v[96:99]
  buffer_load_dwordx4 a[144:147], v4, s[20:23], s39 offen offset:0 sc1
  v_mfma_f32_16x16x32_bf16 v[100:103], a[100:103], a[176:179], v[100:103]
  ds_read_b64_tr_b16 a[162:163], v6 offset:17408
  v_mfma_f32_16x16x32_bf16 v[100:103], a[116:119], a[180:183], v[100:103]
  s_add_u32 m0, s38, 81920
  v_mfma_f32_16x16x32_bf16 v[104:107], a[104:107], a[176:179], v[104:107]
  ds_read_b64_tr_b16 a[164:165], v6 offset:24576
  v_mfma_f32_16x16x32_bf16 v[104:107], a[120:123], a[180:183], v[104:107]
  buffer_load_dwordx4 v3, s[16:19], s37 offen lds
  v_mfma_f32_16x16x32_bf16 v[108:111], a[108:111], a[176:179], v[108:111]
  ds_read_b64_tr_b16 a[166:167], v6 offset:25600
  v_mfma_f32_16x16x32_bf16 v[108:111], a[124:127], a[180:183], v[108:111]
  s_add_u32 s37, s37, 114688
  s_waitcnt lgkmcnt(4)
  v_mfma_f32_16x16x32_bf16 v[112:115], a[96:99], a[184:187], v[112:115]
  ds_read_b64_tr_b16 a[168:169], v6 offset:16416
  v_mfma_f32_16x16x32_bf16 v[112:115], a[112:115], a[188:191], v[112:115]
  buffer_load_dwordx4 a[148:151], v4, s[20:23], s39 offen offset:1024 sc1
  v_mfma_f32_16x16x32_bf16 v[116:119], a[100:103], a[184:187], v[116:119]
  ds_read_b64_tr_b16 a[170:171], v6 offset:17440
  v_mfma_f32_16x16x32_bf16 v[116:119], a[116:119], a[188:191], v[116:119]
  s_add_u32 m0, s38, 86016
  v_mfma_f32_16x16x32_bf16 v[120:123], a[104:107], a[184:187], v[120:123]
  ds_read_b64_tr_b16 a[172:173], v6 offset:24608
  v_mfma_f32_16x16x32_bf16 v[120:123], a[120:123], a[188:191], v[120:123]
  buffer_load_dwordx4 v3, s[16:19], s37 offen lds
  v_mfma_f32_16x16x32_bf16 v[124:127], a[108:111], a[184:187], v[124:127]
  ds_read_b64_tr_b16 a[174:175], v6 offset:25632
  v_mfma_f32_16x16x32_bf16 v[124:127], a[124:127], a[188:191], v[124:127]
  s_add_u32 s37, s37, 114688
  s_waitcnt lgkmcnt(4)
  v_mfma_f32_16x16x32_bf16 v[128:131], a[160:163], a[96:99], v[128:131]
  ds_read_b64_tr_b16 a[176:177], v6 offset:16448
  v_mfma_f32_16x16x32_bf16 v[128:131], a[164:167], a[112:115], v[128:131]
  buffer_load_dwordx4 a[152:155], v4, s[20:23], s39 offen offset:2048 sc1
  v_mfma_f32_16x16x32_bf16 v[132:135], a[160:163], a[100:103], v[132:135]
  ds_read_b64_tr_b16 a[178:179], v6 offset:17472
  v_mfma_f32_16x16x32_bf16 v[132:135], a[164:167], a[116:119], v[132:135]
  s_add_u32 m0, s38, 90112
  v_mfma_f32_16x16x32_bf16 v[144:147], a[160:163], a[104:107], v[144:147]
  ds_read_b64_tr_b16 a[180:181], v6 offset:24640
  v_mfma_f32_16x16x32_bf16 v[144:147], a[164:167], a[120:123], v[144:147]
  buffer_load_dwordx4 v3, s[16:19], s37 offen lds
  v_mfma_f32_16x16x32_bf16 v[148:151], a[160:163], a[108:111], v[148:151]
  ds_read_b64_tr_b16 a[182:183], v6 offset:25664
  v_mfma_f32_16x16x32_bf16 v[148:151], a[164:167], a[124:127], v[148:151]
  s_add_u32 s37, s37, 114688
  s_waitcnt lgkmcnt(4)
  v_mfma_f32_16x16x32_bf16 v[160:163], a[168:171], a[96:99], v[160:163]
  ds_read_b64_tr_b16 a[184:185], v6 offset:16480
  v_mfma_f32_16x16x32_bf16 v[160:163], a[172:175], a[112:115], v[160:163]
  buffer_load_dwordx4 a[156:159], v4, s[20:23], s39 offen offset:3072 sc1
  s_add_u32 s39, s39, 0x20000
  v_mfma_f32_16x16x32_bf16 v[164:167], a[168:171], a[100:103], v[164:167]
  ds_read_b64_tr_b16 a[186:187], v6 offset:17504
  v_mfma_f32_16x16x32_bf16 v[164:167], a[172:175], a[116:119], v[164:167]
  s_add_u32 m0, s38, 94208
  v_mfma_f32_16x16x32_bf16 v[176:179], a[168:171], a[104:107], v[176:179]
  ds_read_b64_tr_b16 a[188:189], v6 offset:24672
  v_mfma_f32_16x16x32_bf16 v[176:179], a[172:175], a[120:123], v[176:179]
  buffer_load_dwordx4 v3, s[16:19], s37 offen lds
  v_mfma_f32_16x16x32_bf16 v[180:183], a[168:171], a[108:111], v[180:183]
  ds_read_b64_tr_b16 a[190:191], v6 offset:25696
  v_mfma_f32_16x16x32_bf16 v[180:183], a[172:175], a[124:127], v[180:183]
  s_add_u32 s37, s37, 114688
  s_waitcnt lgkmcnt(4)
  v_mfma_f32_16x16x32_bf16 a[0:3], a[176:179], a[96:99], a[0:3]
  ds_read_b64_tr_b16 a[160:161], v6 offset:16512
  v_mfma_f32_16x16x32_bf16 a[0:3], a[180:183], a[112:115], a[0:3]
  buffer_load_dword a255, v22, s[28:31], s56 offen
  s_add_u32 s56, s56, s57
  v_mfma_f32_16x16x32_bf16 a[4:7], a[176:179], a[100:103], a[4:7]
  ds_read_b64_tr_b16 a[162:163], v6 offset:17536
  v_mfma_f32_16x16x32_bf16 a[4:7], a[180:183], a[116:119], a[4:7]
  s_mov_b32 m0, s64
  v_mfma_f32_16x16x32_bf16 a[16:19], a[176:179], a[104:107], a[16:19]
  ds_read_b64_tr_b16 a[164:165], v6 offset:24704
  v_mfma_f32_16x16x32_bf16 a[16:19], a[180:183], a[120:123], a[16:19]
  buffer_load_dwordx4 v23, s[60:63], s58 offen offset:0 nt lds
  v_mfma_f32_16x16x32_bf16 a[20:23], a[176:179], a[108:111], a[20:23]
  ds_read_b64_tr_b16 a[166:167], v6 offset:25728
  v_mfma_f32_16x16x32_bf16 a[20:23], a[180:183], a[124:127], a[20:23]
  s_waitcnt lgkmcnt(4)
  v_mfma_f32_16x16x32_bf16 a[32:35], a[184:187], a[96:99], a[32:35]
  ds_read_b64_tr_b16 a[168:169], v6 offset:16544
  v_mfma_f32_16x16x32_bf16 a[32:35], a[188:191], a[112:115], a[32:35]
  v_mfma_f32_16x16x32_bf16 a[36:39], a[184:187], a[100:103], a[36:39]
  ds_read_b64_tr_b16 a[170:171], v6 offset:17568
  v_mfma_f32_16x16x32_bf16 a[36:39], a[188:191], a[116:119], a[36:39]
  v_mfma_f32_16x16x32_bf16 a[48:51], a[184:187], a[104:107], a[48:51]
  ds_read_b64_tr_b16 a[172:173], v6 offset:24736
  v_mfma_f32_16x16x32_bf16 a[48:51], a[188:191], a[120:123], a[48:51]
  buffer_load_dwordx4 v24, s[60:63], s58 offen offset:1024 nt lds
  v_mfma_f32_16x16x32_bf16 a[52:55], a[184:187], a[108:111], a[52:55]
  ds_read_b64_tr_b16 a[174:175], v6 offset:25760
  v_mfma_f32_16x16x32_bf16 a[52:55], a[188:191], a[124:127], a[52:55]
  s_waitcnt lgkmcnt(4)
  v_mfma_f32_16x16x32_bf16 a[64:67], a[160:163], a[96:99], a[64:67]
  ds_read_b64_tr_b16 a[176:177], v6 offset:16576
  v_mfma_f32_16x16x32_bf16 a[64:67], a[164:167], a[112:115], a[64:67]
  buffer_store_dwordx4 a[192:195], v8, s[24:27], s71 offen offset:0 sc1
  v_mfma_f32_16x16x32_bf16 a[68:71], a[160:163], a[100:103], a[68:71]
  ds_read_b64_tr_b16 a[178:179], v6 offset:17600
  v_mfma_f32_16x16x32_bf16 a[68:71], a[164:167], a[116:119], a[68:71]
  v_mfma_f32_16x16x32_bf16 a[80:83], a[160:163], a[104:107], a[80:83]
  ds_read_b64_tr_b16 a[180:181], v6 offset:24768
  v_mfma_f32_16x16x32_bf16 a[80:83], a[164:167], a[120:123], a[80:83]
  buffer_store_dwordx4 a[196:199], v8, s[24:27], s71 offen offset:2048 sc1
  v_mfma_f32_16x16x32_bf16 a[84:87], a[160:163], a[108:111], a[84:87]
  ds_read_b64_tr_b16 a[182:183], v6 offset:25792
  v_mfma_f32_16x16x32_bf16 a[84:87], a[164:167], a[124:127], a[84:87]
  s_waitcnt vmcnt(27)
  s_barrier
  s_waitcnt lgkmcnt(4)
  v_mfma_f32_16x16x32_bf16 v[192:195], a[168:171], a[96:99], v[192:195]
  ds_read_b64_tr_b16 a[184:185], v6 offset:32768
  v_mfma_f32_16x16x32_bf16 v[192:195], a[172:175], a[112:115], v[192:195]
  s_add_u32 m0, s38, 0
  v_mfma_f32_16x16x32_bf16 v[196:199], a[168:171], a[100:103], v[196:199]
  ds_read_b64_tr_b16 a[186:187], v6 offset:33792
  v_mfma_f32_16x16x32_bf16 v[196:199], a[172:175], a[116:119], v[196:199]
  buffer_load_dwordx4 v2, s[8:11], s35 offen lds
  v_mfma_f32_16x16x32_bf16 v[208:211], a[168:171], a[104:107], v[208:211]
  ds_read_b64_tr_b16 a[188:189], v6 offset:40960
  v_mfma_f32_16x16x32_bf16 v[208:211], a[172:175], a[120:123], v[208:211]
  s_add_u32 s35, s35, 98304
  v_mfma_f32_16x16x32_bf16 v[212:215], a[168:171], a[108:111], v[212:215]
  ds_read_b64_tr_b16 a[190:191], v6 offset:41984
  v_mfma_f32_16x16x32_bf16 v[212:215], a[172:175], a[124:127], v[212:215]
  s_waitcnt lgkmcnt(4)
  v_mfma_f32_16x16x32_bf16 v[224:227], a[176:179], a[96:99], v[224:227]
  ds_read_b64_tr_b16 a[160:161], v6 offset:32800
  v_mfma_f32_16x16x32_bf16 v[224:227], a[180:183], a[112:115], v[224:227]
  v_mfma_f32_16x16x32_bf16 v[228:231], a[176:179], a[100:103], v[228:231]
  ds_read_b64_tr_b16 a[162:163], v6 offset:33824
  v_mfma_f32_16x16x32_bf16 v[228:231], a[180:183], a[116:119], v[228:231]
  v_mfma_f32_16x16x32_bf16 v[240:243], a[176:179], a[104:107], v[240:243]
  ds_read_b64_tr_b16 a[164:165], v6 offset:40992
  v_mfma_f32_16x16x32_bf16 v[240:243], a[180:183], a[120:123], v[240:243]
  v_mfma_f32_16x16x32_bf16 v[244:247], a[176:179], a[108:111], v[244:247]
  ds_read_b64_tr_b16 a[166:167], v6 offset:42016
  v_mfma_f32_16x16x32_bf16 v[244:247], a[180:183], a[124:127], v[244:247]
  s_waitcnt lgkmcnt(4)
  v_mfma_f32_16x16x32_bf16 v[136:139], a[184:187], a[96:99], v[136:139]
  ds_read_b64_tr_b16 a[168:169], v6 offset:32832
  v_mfma_f32_16x16x32_bf16 v[136:139], a[188:191], a[112:115], v[136:139]
  s_add_u32 m0, s38, 4096
  v_mfma_f32_16x16x32_bf16 v[140:143], a[184:187], a[100:103], v[140:143]
  ds_read_b64_tr_b16 a[170:171], v6 offset:33856
  v_mfma_f32_16x16x32_bf16 v[140:143], a[188:191], a[116:119], v[140:143]
  buffer_load_dwordx4 v2, s[8:11], s35 offen lds
  v_mfma_f32_16x16x32_bf16 v[152:155], a[184:187], a[104:107], v[152:155]
  ds_read_b64_tr_b16 a[172:173], v6 offset:41024
  v_mfma_f32_16x16x32_bf16 v[152:155], a[188:191], a[120:123], v[152:155]
  s_add_u32 s35, s35, 98304
  v_mfma_f32_16x16x32_bf16 v[156:159], a[184:187], a[108:111], v[156:159]
  ds_read_b64_tr_b16 a[174:175], v6 offset:42048
  v_mfma_f32_16x16x32_bf16 v[156:159], a[188:191], a[124:127], v[156:159]
  s_waitcnt lgkmcnt(4)
  v_mfma_f32_16x16x32_bf16 v[168:171], a[160:163], a[96:99], v[168:171]
  ds_read_b64_tr_b16 a[176:177], v6 offset:32864
  v_mfma_f32_16x16x32_bf16 v[168:171], a[164:167], a[112:115], v[168:171]
  v_mfma_f32_16x16x32_bf16 v[172:175], a[160:163], a[100:103], v[172:175]
  ds_read_b64_tr_b16 a[178:179], v6 offset:33888
  v_mfma_f32_16x16x32_bf16 v[172:175], a[164:167], a[116:119], v[172:175]
  v_mfma_f32_16x16x32_bf16 v[184:187], a[160:163], a[104:107], v[184:187]
  ds_read_b64_tr_b16 a[180:181], v6 offset:41056
  v_mfma_f32_16x16x32_bf16 v[184:187], a[164:167], a[120:123], v[184:187]
  v_mfma_f32_16x16x32_bf16 v[188:191], a[160:163], a[108:111], v[188:191]
  ds_read_b64_tr_b16 a[182:183], v6 offset:42080
  v_mfma_f32_16x16x32_bf16 v[188:191], a[164:167], a[124:127], v[188:191]
  s_waitcnt lgkmcnt(4)
  v_mfma_f32_16x16x32_bf16 a[8:11], a[168:171], a[96:99], a[8:11]
  ds_read_b64_tr_b16 a[184:185], v6 offset:32896
  v_mfma_f32_16x16x32_bf16 a[8:11], a[172:175], a[112:115], a[8:11]
  s_add_u32 m0, s38, 8192
  v_mfma_f32_16x16x32_bf16 a[12:15], a[168:171], a[100:103], a[12:15]
  ds_read_b64_tr_b16 a[186:187], v6 offset:33920
  v_mfma_f32_16x16x32_bf16 a[12:15], a[172:175], a[116:119], a[12:15]
  buffer_load_dwordx4 v2, s[8:11], s35 offen lds
  v_mfma_f32_16x16x32_bf16 a[24:27], a[168:171], a[104:107], a[24:27]
  ds_read_b64_tr_b16 a[188:189], v6 offset:41088
  v_mfma_f32_16x16x32_bf16 a[24:27], a[172:175], a[120:123], a[24:27]
  s_add_u32 s35, s35, 98304
  v_mfma_f32_16x16x32_bf16 a[28:31], a[168:171], a[108:111], a[28:31]
  ds_read_b64_tr_b16 a[190:191], v6 offset:42112
  v_mfma_f32_16x16x32_bf16 a[28:31], a[172:175], a[124:127], a[28:31]
  s_waitcnt lgkmcnt(4)
  v_mfma_f32_16x16x32_bf16 a[40:43], a[176:179], a[96:99], a[40:43]
  ds_read_b64_tr_b16 a[160:161], v6 offset:32928
  v_mfma_f32_16x16x32_bf16 a[40:43], a[180:183], a[112:115], a[40:43]
  v_mfma_f32_16x16x32_bf16 a[44:47], a[176:179], a[100:103], a[44:47]
  ds_read_b64_tr_b16 a[162:163], v6 offset:33952
  v_mfma_f32_16x16x32_bf16 a[44:47], a[180:183], a[116:119], a[44:47]
  v_mfma_f32_16x16x32_bf16 a[56:59], a[176:179], a[104:107], a[56:59]
  ds_read_b64_tr_b16 a[164:165], v6 offset:41120
  v_mfma_f32_16x16x32_bf16 a[56:59], a[180:183], a[120:123], a[56:59]
  v_mfma_f32_16x16x32_bf16 a[60:63], a[176:179], a[108:111], a[60:63]
  ds_read_b64_tr_b16 a[166:167], v6 offset:42144
  v_mfma_f32_16x16x32_bf16 a[60:63], a[180:183], a[124:127], a[60:63]
  s_waitcnt lgkmcnt(4)
  v_mfma_f32_16x16x32_bf16 a[72:75], a[184:187], a[96:99], a[72:75]
  ds_read_b64_tr_b16 a[168:169], v6 offset:32960
  v_mfma_f32_16x16x32_bf16 a[72:75], a[188:191], a[112:115], a[72:75]
  s_add_u32 m0, s38, 12288
  v_mfma_f32_16x16x32_bf16 a[76:79], a[184:187], a[100:103], a[76:79]
  ds_read_b64_tr_b16 a[170:171], v6 offset:33984
  v_mfma_f32_16x16x32_bf16 a[76:79], a[188:191], a[116:119], a[76:79]
  buffer_load_dwordx4 v2, s[8:11], s35 offen lds
  v_mfma_f32_16x16x32_bf16 a[88:91], a[184:187], a[104:107], a[88:91]
  ds_read_b64_tr_b16 a[172:173], v6 offset:41152
  v_mfma_f32_16x16x32_bf16 a[88:91], a[188:191], a[120:123], a[88:91]
  s_add_u32 s35, s35, 98304
  v_mfma_f32_16x16x32_bf16 a[92:95], a[184:187], a[108:111], a[92:95]
  ds_read_b64_tr_b16 a[174:175], v6 offset:42176
  v_mfma_f32_16x16x32_bf16 a[92:95], a[188:191], a[124:127], a[92:95]
  s_waitcnt vmcnt(10)
  s_barrier
  s_waitcnt lgkmcnt(4)
  v_mfma_f32_16x16x32_bf16 v[200:203], a[160:163], a[96:99], v[200:203]
  ds_read_b64_tr_b16 a[176:177], v7 offset:0
  v_mfma_f32_16x16x32_bf16 v[200:203], a[164:167], a[112:115], v[200:203]
  s_add_u32 m0, s38, 16384
  v_mfma_f32_16x16x32_bf16 v[204:207], a[160:163], a[100:103], v[204:207]
  ds_read_b64_tr_b16 a[178:179], v7 offset:1024
  v_mfma_f32_16x16x32_bf16 v[204:207], a[164:167], a[116:119], v[204:207]
  buffer_load_dwordx4 v3, s[12:15], s36 offen lds
  v_mfma_f32_16x16x32_bf16 v[216:219], a[160:163], a[104:107], v[216:219]
  ds_read_b64_tr_b16 a[180:181], v7 offset:8192
  v_mfma_f32_16x16x32_bf16 v[216:219], a[164:167], a[120:123], v[216:219]
  s_add_u32 s36, s36, 114688
  v_mfma_f32_16x16x32_bf16 v[220:223], a[160:163], a[108:111], v[220:223]
  ds_read_b64_tr_b16 a[182:183], v7 offset:9216
  v_mfma_f32_16x16x32_bf16 v[220:223], a[164:167], a[124:127], v[220:223]
  s_waitcnt lgkmcnt(4)
  v_mfma_f32_16x16x32_bf16 v[232:235], a[168:171], a[96:99], v[232:235]
  ds_read_b64_tr_b16 a[184:185], v7 offset:32
  v_mfma_f32_16x16x32_bf16 v[232:235], a[172:175], a[112:115], v[232:235]
  s_add_u32 m0, s38, 20480
  v_mfma_f32_16x16x32_bf16 v[236:239], a[168:171], a[100:103], v[236:239]
  ds_read_b64_tr_b16 a[186:187], v7 offset:1056
  v_mfma_f32_16x16x32_bf16 v[236:239], a[172:175], a[116:119], v[236:239]
  buffer_load_dwordx4 v3, s[12:15], s36 offen lds
  v_mfma_f32_16x16x32_bf16 v[248:251], a[168:171], a[104:107], v[248:251]
  ds_read_b64_tr_b16 a[188:189], v7 offset:8224
  v_mfma_f32_16x16x32_bf16 v[248:251], a[172:175], a[120:123], v[248:251]
  s_add_u32 s36, s36, 114688
  v_mfma_f32_16x16x32_bf16 v[252:255], a[168:171], a[108:111], v[252:255]
  ds_read_b64_tr_b16 a[190:191], v7 offset:9248
  v_mfma_f32_16x16x32_bf16 v[252:255], a[172:175], a[124:127], v[252:255]
  s_waitcnt lgkmcnt(4)
  v_mfma_f32_16x16x32_bf16 v[32:35], a[176:179], a[128:131], v[32:35]
  ds_read_b64_tr_b16 a[160:161], v7 offset:64
  v_mfma_f32_16x16x32_bf16 v[32:35], a[180:183], a[144:147], v[32:35]
  buffer_load_dwordx4 a[96:99], v4, s[20:23], s39 offen offset:0 sc1
  v_mfma_f32_16x16x32_bf16 v[36:39], a[176:179], a[132:135], v[36:39]
  ds_read_b64_tr_b16 a[162:163], v7 offset:1088
  v_mfma_f32_16x16x32_bf16 v[36:39], a[180:183], a[148:151], v[36:39]
  s_add_u32 m0, s38, 24576
  v_mfma_f32_16x16x32_bf16 v[40:43], a[176:179], a[136:139], v[40:43]
  ds_read_b64_tr_b16 a[164:165], v7 offset:8256
  v_mfma_f32_16x16x32_bf16 v[40:43], a[180:183], a[152:155], v[40:43]
  buffer_load_dwordx4 v3, s[12:15], s36 offen lds
  v_mfma_f32_16x16x32_bf16 v[44:47], a[176:179], a[140:143], v[44:47]
  ds_read_b64_tr_b16 a[166:167], v7 offset:9280
  v_mfma_f32_16x16x32_bf16 v[44:47], a[180:183], a[156:159], v[44:47]
  s_add_u32 s36, s36, 114688
  s_waitcnt lgkmcnt(4)
  v_mfma_f32_16x16x32_bf16 v[48:51], a[184:187], a[128:131], v[48:51]
  ds_read_b64_tr_b16 a[168:169], v7 offset:96
  v_mfma_f32_16x16x32_bf16 v[48:51], a[188:191], a[144:147], v[48:51]
  buffer_load_dwordx4 a[100:103], v4, s[20:23], s39 offen offset:1024 sc1
  v_mfma_f32_16x16x32_bf16 v[52:55], a[184:187], a[132:135], v[52:55]
  ds_read_b64_tr_b16 a[170:171], v7 offset:1120
  v_mfma_f32_16x16x32_bf16 v[52:55], a[188:191], a[148:151], v[52:55]
  s_add_u32 m0, s38, 28672
  v_mfma_f32_16x16x32_bf16 v[56:59], a[184:187], a[136:139], v[56:59]
  ds_read_b64_tr_b16 a[172:173], v7 offset:8288
  v_mfma_f32_16x16x32_bf16 v[56:59], a[188:191], a[152:155], v[56:59]
  buffer_load_dwordx4 v3, s[12:15], s36 offen lds
  v_mfma_f32_16x16x32_bf16 v[60:63], a[184:187], a[140:143], v[60:63]
  ds_read_b64_tr_b16 a[174:175], v7 offset:9312
  v_mfma_f32_16x16x32_bf16 v[60:63], a[188:191], a[156:159], v[60:63]
  s_add_u32 s36, s36, 114688
  s_waitcnt lgkmcnt(4)
  v_mfma_f32_16x16x32_bf16 v[64:67], a[160:163], a[128:131], v[64:67]
  ds_read_b64_tr_b16 a[176:177], v7 offset:128
  v_mfma_f32_16x16x32_bf16 v[64:67], a[164:167], a[144:147], v[64:67]
  buffer_load_dwordx4 a[104:107], v4, s[20:23], s39 offen offset:2048 sc1
  v_mfma_f32_16x16x32_bf16 v[68:71], a[160:163], a[132:135], v[68:71]
  ds_read_b64_tr_b16 a[178:179], v7 offset:1152
  v_mfma_f32_16x16x32_bf16 v[68:71], a[164:167], a[148:151], v[68:71]
  v_mfma_f32_16x16x32_bf16 v[72:75], a[160:163], a[136:139], v[72:75]
  ds_read_b64_tr_b16 a[180:181], v7 offset:8320
  v_mfma_f32_16x16x32_bf16 v[72:75], a[164:167], a[152:155], v[72:75]
  v_mfma_f32_16x16x32_bf16 v[76:79], a[160:163], a[140:143], v[76:79]
  ds_read_b64_tr_b16 a[182:183], v7 offset:9344
  v_mfma_f32_16x16x32_bf16 v[76:79], a[164:167], a[156:159], v[76:79]
  s_waitcnt lgkmcnt(4)
  v_mfma_f32_16x16x32_bf16 v[80:83], a[168:171], a[128:131], v[80:83]
  ds_read_b64_tr_b16 a[184:185], v7 offset:160
  v_mfma_f32_16x16x32_bf16 v[80:83], a[172:175], a[144:147], v[80:83]
  buffer_load_dwordx4 a[108:111], v4, s[20:23], s39 offen offset:3072 sc1
  s_add_u32 s39, s39, 0x20000
  v_mfma_f32_16x16x32_bf16 v[84:87], a[168:171], a[132:135], v[84:87]
  ds_read_b64_tr_b16 a[186:187], v7 offset:1184
  v_mfma_f32_16x16x32_bf16 v[84:87], a[172:175], a[148:151], v[84:87]
  v_mfma_f32_16x16x32_bf16 v[88:91], a[168:171], a[136:139], v[88:91]
  ds_read_b64_tr_b16 a[188:189], v7 offset:8352
  v_mfma_f32_16x16x32_bf16 v[88:91], a[172:175], a[152:155], v[88:91]
  buffer_load_dwordx2 a[252:253], v20, s[24:27], s48 offen sc1
  v_mfma_f32_16x16x32_bf16 v[92:95], a[168:171], a[140:143], v[92:95]
  ds_read_b64_tr_b16 a[190:191], v7 offset:9376
  v_mfma_f32_16x16x32_bf16 v[92:95], a[172:175], a[156:159], v[92:95]
  s_barrier
  s_waitcnt lgkmcnt(4)
  v_mfma_f32_16x16x32_bf16 v[96:99], a[128:131], a[176:179], v[96:99]
  ds_read_b64_tr_b16 a[160:161], v7 offset:16384
  v_mfma_f32_16x16x32_bf16 v[96:99], a[144:147], a[180:183], v[96:99]
  buffer_load_dwordx4 a[112:115], v4, s[20:23], s39 offen offset:0 sc1
  v_mfma_f32_16x16x32_bf16 v[100:103], a[132:135], a[176:179], v[100:103]
  ds_read_b64_tr_b16 a[162:163], v7 offset:17408
  v_mfma_f32_16x16x32_bf16 v[100:103], a[148:151], a[180:183], v[100:103]
  s_add_u32 m0, s38, 32768
  v_mfma_f32_16x16x32_bf16 v[104:107], a[136:139], a[176:179], v[104:107]
  ds_read_b64_tr_b16 a[164:165], v7 offset:24576
  v_mfma_f32_16x16x32_bf16 v[104:107], a[152:155], a[180:183], v[104:107]
  buffer_load_dwordx4 v3, s[16:19], s37 offen lds
  v_mfma_f32_16x16x32_bf16 v[108:111], a[140:143], a[176:179], v[108:111]
  ds_read_b64_tr_b16 a[166:167], v7 offset:25600
  v_mfma_f32_16x16x32_bf16 v[108:111], a[156:159], a[180:183], v[108:111]
  s_add_u32 s37, s37, 114688
  s_waitcnt lgkmcnt(4)
  v_mfma_f32_16x16x32_bf16 v[112:115], a[128:131], a[184:187], v[112:115]
  ds_read_b64_tr_b16 a[168:169], v7 offset:16416
  v_mfma_f32_16x16x32_bf16 v[112:115], a[144:147], a[188:191], v[112:115]
  buffer_load_dwordx4 a[116:119], v4, s[20:23], s39 offen offset:1024 sc1
  v_mfma_f32_16x16x32_bf16 v[116:119], a[132:135], a[184:187], v[116:119]
  ds_read_b64_tr_b16 a[170:171], v7 offset:17440
  v_mfma_f32_16x16x32_bf16 v[116:119], a[148:151], a[188:191], v[116:119]
  s_add_u32 m0, s38, 36864
  v_mfma_f32_16x16x32_bf16 v[120:123], a[136:139], a[184:187], v[120:123]
  ds_read_b64_tr_b16 a[172:173], v7 offset:24608
  v_mfma_f32_16x16x32_bf16 v[120:123], a[152:155], a[188:191], v[120:123]
  buffer_load_dwordx4 v3, s[16:19], s37 offen lds
  v_mfma_f32_16x16x32_bf16 v[124:127], a[140:143], a[184:187], v[124:127]
  ds_read_b64_tr_b16 a[174:175], v7 offset:25632
  v_mfma_f32_16x16x32_bf16 v[124:127], a[156:159], a[188:191], v[124:127]
  s_add_u32 s37, s37, 114688
  s_waitcnt lgkmcnt(4)
  v_mfma_f32_16x16x32_bf16 v[128:131], a[160:163], a[128:131], v[128:131]
  ds_read_b64_tr_b16 a[176:177], v7 offset:16448
  v_mfma_f32_16x16x32_bf16 v[128:131], a[164:167], a[144:147], v[128:131]
  buffer_load_dwordx4 a[120:123], v4, s[20:23], s39 offen offset:2048 sc1
  v_mfma_f32_16x16x32_bf16 v[132:135], a[160:163], a[132:135], v[132:135]
  ds_read_b64_tr_b16 a[178:179], v7 offset:17472
  v_mfma_f32_16x16x32_bf16 v[132:135], a[164:167], a[148:151], v[132:135]
  s_add_u32 m0, s38, 40960
  v_mfma_f32_16x16x32_bf16 v[144:147], a[160:163], a[136:139], v[144:147]
  ds_read_b64_tr_b16 a[180:181], v7 offset:24640
  v_mfma_f32_16x16x32_bf16 v[144:147], a[164:167], a[152:155], v[144:147]
  buffer_load_dwordx4 v3, s[16:19], s37 offen lds
  v_mfma_f32_16x16x32_bf16 v[148:151], a[160:163], a[140:143], v[148:151]
  ds_read_b64_tr_b16 a[182:183], v7 offset:25664
  v_mfma_f32_16x16x32_bf16 v[148:151], a[164:167], a[156:159], v[148:151]
  s_add_u32 s37, s37, 114688
  s_waitcnt lgkmcnt(4)
  v_mfma_f32_16x16x32_bf16 v[160:163], a[168:171], a[128:131], v[160:163]
  ds_read_b64_tr_b16 a[184:185], v7 offset:16480
  v_mfma_f32_16x16x32_bf16 v[160:163], a[172:175], a[144:147], v[160:163]
  buffer_load_dwordx4 a[124:127], v4, s[20:23], s39 offen offset:3072 sc1
  s_add_u32 s39, s39, 0x20000
  v_mfma_f32_16x16x32_bf16 v[164:167], a[168:171], a[132:135], v[164:167]
  ds_read_b64_tr_b16 a[186:187], v7 offset:17504
  v_mfma_f32_16x16x32_bf16 v[164:167], a[172:175], a[148:151], v[164:167]
  s_add_u32 m0, s38, 45056
  v_mfma_f32_16x16x32_bf16 v[176:179], a[168:171], a[136:139], v[176:179]
  ds_read_b64_tr_b16 a[188:189], v7 offset:24672
  v_mfma_f32_16x16x32_bf16 v[176:179], a[172:175], a[152:155], v[176:179]
  buffer_load_dwordx4 v3, s[16:19], s37 offen lds
  v_mfma_f32_16x16x32_bf16 v[180:183], a[168:171], a[140:143], v[180:183]
  ds_read_b64_tr_b16 a[190:191], v7 offset:25696
  v_mfma_f32_16x16x32_bf16 v[180:183], a[172:175], a[156:159], v[180:183]
  s_add_u32 s37, s37, 114688
  s_waitcnt lgkmcnt(4)
  v_mfma_f32_16x16x32_bf16 a[0:3], a[176:179], a[128:131], a[0:3]
  ds_read_b64_tr_b16 a[160:161], v7 offset:16512
  v_mfma_f32_16x16x32_bf16 a[0:3], a[180:183], a[144:147], a[0:3]
  buffer_load_dword a255, v22, s[28:31], s56 offen
  s_add_u32 s56, s56, s57
  v_mfma_f32_16x16x32_bf16 a[4:7], a[176:179], a[132:135], a[4:7]
  ds_read_b64_tr_b16 a[162:163], v7 offset:17536
  v_mfma_f32_16x16x32_bf16 a[4:7], a[180:183], a[148:151], a[4:7]
  v_mfma_f32_16x16x32_bf16 a[16:19], a[176:179], a[136:139], a[16:19]
  ds_read_b64_tr_b16 a[164:165], v7 offset:24704
  v_mfma_f32_16x16x32_bf16 a[16:19], a[180:183], a[152:155], a[16:19]
  v_mfma_f32_16x16x32_bf16 a[20:23], a[176:179], a[140:143], a[20:23]
  ds_read_b64_tr_b16 a[166:167], v7 offset:25728
  v_mfma_f32_16x16x32_bf16 a[20:23], a[180:183], a[156:159], a[20:23]
  s_waitcnt lgkmcnt(4)
  v_mfma_f32_16x16x32_bf16 a[32:35], a[184:187], a[128:131], a[32:35]
  ds_read_b64_tr_b16 a[168:169], v7 offset:16544
  v_mfma_f32_16x16x32_bf16 a[32:35], a[188:191], a[144:147], a[32:35]
  buffer_load_dword a254, v0, s[4:7], s3 offen
  v_mfma_f32_16x16x32_bf16 a[36:39], a[184:187], a[132:135], a[36:39]
  ds_read_b64_tr_b16 a[170:171], v7 offset:17568
  v_mfma_f32_16x16x32_bf16 a[36:39], a[188:191], a[148:151], a[36:39]
  v_mfma_f32_16x16x32_bf16 a[48:51], a[184:187], a[136:139], a[48:51]
  ds_read_b64_tr_b16 a[172:173], v7 offset:24736
  v_mfma_f32_16x16x32_bf16 a[48:51], a[188:191], a[152:155], a[48:51]
  v_mfma_f32_16x16x32_bf16 a[52:55], a[184:187], a[140:143], a[52:55]
  ds_read_b64_tr_b16 a[174:175], v7 offset:25760
  v_mfma_f32_16x16x32_bf16 a[52:55], a[188:191], a[156:159], a[52:55]
  s_waitcnt lgkmcnt(4)
  v_mfma_f32_16x16x32_bf16 a[64:67], a[160:163], a[128:131], a[64:67]
  ds_read_b64_tr_b16 a[176:177], v7 offset:16576
  v_mfma_f32_16x16x32_bf16 a[64:67], a[164:167], a[144:147], a[64:67]
  s_mov_b32 s71, s59
  v_mfma_f32_16x16x32_bf16 a[68:71], a[160:163], a[132:135], a[68:71]
  ds_read_b64_tr_b16 a[178:179], v7 offset:17600
  v_mfma_f32_16x16x32_bf16 a[68:71], a[164:167], a[148:151], a[68:71]
  s_cmp_eq_u32 s66, 0
  s_cselect_b32 s65, 0, 0x200000
  v_mfma_f32_16x16x32_bf16 a[80:83], a[160:163], a[136:139], a[80:83]
  ds_read_b64_tr_b16 a[180:181], v7 offset:24768
  v_mfma_f32_16x16x32_bf16 a[80:83], a[164:167], a[152:155], a[80:83]
  s_add_u32 s58, s58, s65
  s_mov_b32 s60, s52
  v_mfma_f32_16x16x32_bf16 a[84:87], a[160:163], a[140:143], a[84:87]
  ds_read_b64_tr_b16 a[182:183], v7 offset:25792
  v_mfma_f32_16x16x32_bf16 a[84:87], a[164:167], a[156:159], a[84:87]
  s_and_b32 s61, s53, 0xffff
  s_mov_b32 s62, 7340032
  s_waitcnt vmcnt(28)
  s_barrier
  s_waitcnt lgkmcnt(4)
  v_mfma_f32_16x16x32_bf16 v[192:195], a[168:171], a[128:131], v[192:195]
  ds_read_b64_tr_b16 a[184:185], v7 offset:32768
  v_mfma_f32_16x16x32_bf16 v[192:195], a[172:175], a[144:147], v[192:195]
  s_add_u32 m0, s38, 49152
  v_mfma_f32_16x16x32_bf16 v[196:199], a[168:171], a[132:135], v[196:199]
  ds_read_b64_tr_b16 a[186:187], v7 offset:33792
  v_mfma_f32_16x16x32_bf16 v[196:199], a[172:175], a[148:151], v[196:199]
  buffer_load_dwordx4 v2, s[8:11], s35 offen lds
  v_mfma_f32_16x16x32_bf16 v[208:211], a[168:171], a[136:139], v[208:211]
  ds_read_b64_tr_b16 a[188:189], v7 offset:40960
  v_mfma_f32_16x16x32_bf16 v[208:211], a[172:175], a[152:155], v[208:211]
  s_add_u32 s35, s35, 98304
  v_mfma_f32_16x16x32_bf16 v[212:215], a[168:171], a[140:143], v[212:215]
  ds_read_b64_tr_b16 a[190:191], v7 offset:41984
  v_mfma_f32_16x16x32_bf16 v[212:215], a[172:175], a[156:159], v[212:215]
  s_waitcnt lgkmcnt(4)
  v_mfma_f32_16x16x32_bf16 v[224:227], a[176:179], a[128:131], v[224:227]
  ds_read_b64_tr_b16 a[160:161], v7 offset:32800
  v_mfma_f32_16x16x32_bf16 v[224:227], a[180:183], a[144:147], v[224:227]
  s_lshr_b32 s40, s58, 15
  s_mul_i32 s41, s40, 9363
  s_lshr_b32 s41, s41, 16
  v_mfma_f32_16x16x32_bf16 v[228:231], a[176:179], a[132:135], v[228:231]
  ds_read_b64_tr_b16 a[162:163], v7 offset:33824
  v_mfma_f32_16x16x32_bf16 v[228:231], a[180:183], a[148:151], v[228:231]
  s_mul_i32 s43, s41, 7
  s_sub_u32 s42, s40, s43
  s_lshl_b32 s44, s41, 1
  v_mfma_f32_16x16x32_bf16 v[240:243], a[176:179], a[136:139], v[240:243]
  ds_read_b64_tr_b16 a[164:165], v7 offset:40992
  v_mfma_f32_16x16x32_bf16 v[240:243], a[180:183], a[152:155], v[240:243]
  s_add_u32 s44, s44, s42
  s_cmp_ge_u32 s41, 12
  s_cselect_b32 s43, 52, 0
  v_mfma_f32_16x16x32_bf16 v[244:247], a[176:179], a[140:143], v[244:247]
  ds_read_b64_tr_b16 a[166:167], v7 offset:42016
  v_mfma_f32_16x16x32_bf16 v[244:247], a[180:183], a[156:159], v[244:247]
  s_cmp_ge_u32 s41, 10
  s_cselect_b32 s45, 74, 22
  s_waitcnt lgkmcnt(4)
  v_mfma_f32_16x16x32_bf16 v[136:139], a[184:187], a[128:131], v[136:139]
  ds_read_b64_tr_b16 a[168:169], v7 offset:32832
  v_mfma_f32_16x16x32_bf16 v[136:139], a[188:191], a[144:147], v[136:139]
  s_add_u32 m0, s38, 53248
  v_mfma_f32_16x16x32_bf16 v[140:143], a[184:187], a[132:135], v[140:143]
  ds_read_b64_tr_b16 a[170:171], v7 offset:33856
  v_mfma_f32_16x16x32_bf16 v[140:143], a[188:191], a[148:151], v[140:143]
  buffer_load_dwordx4 v2, s[8:11], s35 offen lds
  v_mfma_f32_16x16x32_bf16 v[152:155], a[184:187], a[136:139], v[152:155]
  ds_read_b64_tr_b16 a[172:173], v7 offset:41024
  v_mfma_f32_16x16x32_bf16 v[152:155], a[188:191], a[152:155], v[152:155]
  s_add_u32 s35, s35, 98304
  v_mfma_f32_16x16x32_bf16 v[156:159], a[184:187], a[140:143], v[156:159]
  ds_read_b64_tr_b16 a[174:175], v7 offset:42048
  v_mfma_f32_16x16x32_bf16 v[156:159], a[188:191], a[156:159], v[156:159]
  s_waitcnt lgkmcnt(4)
  v_mfma_f32_16x16x32_bf16 v[168:171], a[160:163], a[128:131], v[168:171]
  ds_read_b64_tr_b16 a[176:177], v7 offset:32864
  v_mfma_f32_16x16x32_bf16 v[168:171], a[164:167], a[144:147], v[168:171]
  s_cmp_ge_u32 s41, 22
  s_cselect_b32 s43, 108, s43
  s_cselect_b32 s45, 126, s45
  v_mfma_f32_16x16x32_bf16 v[172:175], a[160:163], a[132:135], v[172:175]
  ds_read_b64_tr_b16 a[178:179], v7 offset:33888
  v_mfma_f32_16x16x32_bf16 v[172:175], a[164:167], a[148:151], v[172:175]
  s_cmp_lt_u32 s42, 2
  s_cselect_b32 s43, s43, s45
  s_add_u32 s45, s44, s41
  v_mfma_f32_16x16x32_bf16 v[184:187], a[160:163], a[136:139], v[184:187]
  ds_read_b64_tr_b16 a[180:181], v7 offset:41056
  v_mfma_f32_16x16x32_bf16 v[184:187], a[164:167], a[152:155], v[184:187]
  s_add_u32 s44, s44, s43
  s_cmp_ge_u32 s45, 36
  s_cselect_b32 s43, 84, 40
  v_mfma_f32_16x16x32_bf16 v[188:191], a[160:163], a[140:143], v[188:191]
  ds_read_b64_tr_b16 a[182:183], v7 offset:42080
  v_mfma_f32_16x16x32_bf16 v[188:191], a[164:167], a[156:159], v[188:191]
  s_cmp_ge_u32 s45, 68
  s_cselect_b32 s43, 124, s43
  s_waitcnt lgkmcnt(4)
  v_mfma_f32_16x16x32_bf16 a[8:11], a[168:171], a[128:131], a[8:11]
  ds_read_b64_tr_b16 a[184:185], v7 offset:32896
  v_mfma_f32_16x16x32_bf16 a[8:11], a[172:175], a[144:147], a[8:11]
  s_add_u32 m0, s38, 57344
  v_mfma_f32_16x16x32_bf16 a[12:15], a[168:171], a[132:135], a[12:15]
  ds_read_b64_tr_b16 a[186:187], v7 offset:33920
  v_mfma_f32_16x16x32_bf16 a[12:15], a[172:175], a[148:151], a[12:15]
  buffer_load_dwordx4 v2, s[8:11], s35 offen lds
  v_mfma_f32_16x16x32_bf16 a[24:27], a[168:171], a[136:139], a[24:27]
  ds_read_b64_tr_b16 a[188:189], v7 offset:41088
  v_mfma_f32_16x16x32_bf16 a[24:27], a[172:175], a[152:155], a[24:27]
  s_add_u32 s35, s35, 98304
  v_mfma_f32_16x16x32_bf16 a[28:31], a[168:171], a[140:143], a[28:31]
  ds_read_b64_tr_b16 a[190:191], v7 offset:42112
  v_mfma_f32_16x16x32_bf16 a[28:31], a[172:175], a[156:159], a[28:31]
  s_waitcnt lgkmcnt(4)
  v_mfma_f32_16x16x32_bf16 a[40:43], a[176:179], a[128:131], a[40:43]
  ds_read_b64_tr_b16 a[160:161], v7 offset:32928
  v_mfma_f32_16x16x32_bf16 a[40:43], a[180:183], a[144:147], a[40:43]
  s_add_u32 s45, s45, s43
  s_cmp_lt_u32 s42, 4
  s_cselect_b32 s44, s44, s45
  v_mfma_f32_16x16x32_bf16 a[44:47], a[176:179], a[132:135], a[44:47]
  ds_read_b64_tr_b16 a[162:163], v7 offset:33952
  v_mfma_f32_16x16x32_bf16 a[44:47], a[180:183], a[148:151], a[44:47]
  s_lshr_b32 s43, s44, 1
  s_lshl_b32 s43, s43, 16
  s_and_b32 s44, s44, 1
  v_mfma_f32_16x16x32_bf16 a[56:59], a[176:179], a[136:139], a[56:59]
  ds_read_b64_tr_b16 a[164:165], v7 offset:41120
  v_mfma_f32_16x16x32_bf16 a[56:59], a[180:183], a[152:155], a[56:59]
  s_lshl_b32 s44, s44, 9
  s_add_u32 s43, s43, s44
  s_add_u32 s59, s43, s54
  v_mfma_f32_16x16x32_bf16 a[60:63], a[176:179], a[140:143], a[60:63]
  ds_read_b64_tr_b16 a[166:167], v7 offset:42144
  v_mfma_f32_16x16x32_bf16 a[60:63], a[180:183], a[156:159], a[60:63]
  s_cmp_ge_u32 s40, 224
  s_cselect_b32 s59, 0x40000000, s59
  s_waitcnt lgkmcnt(4)
  v_mfma_f32_16x16x32_bf16 a[72:75], a[184:187], a[128:131], a[72:75]
  ds_read_b64_tr_b16 a[168:169], v7 offset:32960
  v_mfma_f32_16x16x32_bf16 a[72:75], a[188:191], a[144:147], a[72:75]
  s_add_u32 m0, s38, 61440
  v_mfma_f32_16x16x32_bf16 a[76:79], a[184:187], a[132:135], a[76:79]
  ds_read_b64_tr_b16 a[170:171], v7 offset:33984
  v_mfma_f32_16x16x32_bf16 a[76:79], a[188:191], a[148:151], a[76:79]
  buffer_load_dwordx4 v2, s[8:11], s35 offen lds
  v_mfma_f32_16x16x32_bf16 a[88:91], a[184:187], a[136:139], a[88:91]
  ds_read_b64_tr_b16 a[172:173], v7 offset:41152
  v_mfma_f32_16x16x32_bf16 a[88:91], a[188:191], a[152:155], a[88:91]
  s_add_u32 s35, s35, 98304
  v_mfma_f32_16x16x32_bf16 a[92:95], a[184:187], a[140:143], a[92:95]
  ds_read_b64_tr_b16 a[174:175], v7 offset:42176
  v_mfma_f32_16x16x32_bf16 a[92:95], a[188:191], a[156:159], a[92:95]
  s_waitcnt vmcnt(7)
  s_barrier
  s_waitcnt lgkmcnt(4)
  v_mfma_f32_16x16x32_bf16 v[200:203], a[160:163], a[128:131], v[200:203]
  ds_read_b64_tr_b16 a[176:177], v6 offset:0
  v_mfma_f32_16x16x32_bf16 v[200:203], a[164:167], a[144:147], v[200:203]
  s_add_u32 m0, s38, 65536
  v_mfma_f32_16x16x32_bf16 v[204:207], a[160:163], a[132:135], v[204:207]
  ds_read_b64_tr_b16 a[178:179], v6 offset:1024
  v_mfma_f32_16x16x32_bf16 v[204:207], a[164:167], a[148:151], v[204:207]
  buffer_load_dwordx4 v3, s[12:15], s36 offen lds
  v_mfma_f32_16x16x32_bf16 v[216:219], a[160:163], a[136:139], v[216:219]
  ds_read_b64_tr_b16 a[180:181], v6 offset:8192
  v_mfma_f32_16x16x32_bf16 v[216:219], a[164:167], a[152:155], v[216:219]
  s_add_u32 s36, s36, 114688
  v_mfma_f32_16x16x32_bf16 v[220:223], a[160:163], a[140:143], v[220:223]
  ds_read_b64_tr_b16 a[182:183], v6 offset:9216
  v_mfma_f32_16x16x32_bf16 v[220:223], a[164:167], a[156:159], v[220:223]
  s_waitcnt lgkmcnt(4)
  v_mfma_f32_16x16x32_bf16 v[232:235], a[168:171], a[128:131], v[232:235]
  ds_read_b64_tr_b16 a[184:185], v6 offset:32
  v_mfma_f32_16x16x32_bf16 v[232:235], a[172:175], a[144:147], v[232:235]
  s_add_u32 m0, s38, 69632
  v_mfma_f32_16x16x32_bf16 v[236:239], a[168:171], a[132:135], v[236:239]
  ds_read_b64_tr_b16 a[186:187], v6 offset:1056
  v_mfma_f32_16x16x32_bf16 v[236:239], a[172:175], a[148:151], v[236:239]
  buffer_load_dwordx4 v3, s[12:15], s36 offen lds
  v_mfma_f32_16x16x32_bf16 v[248:251], a[168:171], a[136:139], v[248:251]
  ds_read_b64_tr_b16 a[188:189], v6 offset:8224
  v_mfma_f32_16x16x32_bf16 v[248:251], a[172:175], a[152:155], v[248:251]
  s_add_u32 s36, s36, 114688
  v_mfma_f32_16x16x32_bf16 v[252:255], a[168:171], a[140:143], v[252:255]
  ds_read_b64_tr_b16 a[190:191], v6 offset:9248
  v_mfma_f32_16x16x32_bf16 v[252:255], a[172:175], a[156:159], v[252:255]
  s_add_u32 s66, s66, 1
  s_cmp_ge_u32 s66, s67
  s_cbranch_scc1 L_ga_tk
L_ga_tkr:
  s_cmp_lt_u32 s66, 6
  s_cbranch_scc1 L_ga_loop
  s_waitcnt lgkmcnt(4)
  v_mfma_f32_16x16x32_bf16 v[32:35], a[176:179], a[96:99], v[32:35]
  ds_read_b64_tr_b16 a[160:161], v6 offset:64
  s_mov_b32 s66, s48
  v_mov_b32 v24, s72
  v_mov_b32 v25, s73
  v_mfma_f32_16x16x32_bf16 v[32:35], a[180:183], a[112:115], v[32:35]
  s_add_u32 m0, s38, 73728
  s_lshl_b32 s69, s2, 3
  s_add_u32 s69, s69, 0x18a0000
  s_cmp_eq_u32 s32, 0
  s_cselect_b32 s69, s69, 0x40000000
  v_mfma_f32_16x16x32_bf16 v[36:39], a[176:179], a[100:103], v[36:39]
  ds_read_b64_tr_b16 a[162:163], v6 offset:1088
  buffer_load_dwordx4 v3, s[12:15], s36 offen lds
  s_mov_b32 s48, s33
  s_lshl_b32 s65, s33, 13
  v_mfma_f32_16x16x32_bf16 v[36:39], a[180:183], a[116:119], v[36:39]
  s_add_u32 s36, s36, 114688
  s_lshl_b32 s67, s32, 11
  s_add_u32 s68, s65, s67
  s_add_u32 s68, s68, 0x1600000
  v_mfma_f32_16x16x32_bf16 v[40:43], a[176:179], a[104:107], v[40:43]
  ds_read_b64_tr_b16 a[164:165], v6 offset:8256
  s_lshl_b32 s65, s34, 18
  s_add_u32 s49, s68, s65
  v_mov_b32 v28, 0x3f803f80
  v_mfma_f32_16x16x32_bf16 v[40:43], a[180:183], a[120:123], v[40:43]
  s_add_u32 m0, s38, 77824
  v_mov_b32 v29, 0x3f803f80
  v_mov_b32 v30, 0x3f803f80
  v_mov_b32 v31, 0x3f803f80
  v_mfma_f32_16x16x32_bf16 v[44:47], a[176:179], a[108:111], v[44:47]
  ds_read_b64_tr_b16 a[166:167], v6 offset:9280
  buffer_load_dwordx4 v3, s[12:15], s36 offen lds
  v_add_u32 v22, s64, v21
  v_add_u32 v23, 151552, v21
  v_mfma_f32_16x16x32_bf16 v[44:47], a[180:183], a[124:127], v[44:47]
  s_add_u32 s36, s36, 114688
  ds_read_b64_tr_b16 a[200:201], v5 offset:0
  ds_read_b64_tr_b16 a[202:203], v5 offset:256
  s_waitcnt lgkmcnt(6)
  v_mfma_f32_16x16x32_bf16 v[48:51], a[184:187], a[96:99], v[48:51]
  ds_read_b64_tr_b16 a[168:169], v6 offset:96
  ds_read_b64_tr_b16 a[204:205], v5 offset:1024
  ds_read_b64_tr_b16 a[206:207], v5 offset:1280
  s_load_dwordx2 s[52:53], s[0:1], 64
  v_mfma_f32_16x16x32_bf16 v[48:51], a[188:191], a[112:115], v[48:51]
  buffer_load_dwordx4 a[128:131], v4, s[20:23], s39 offen offset:0 sc1
  v_accvgpr_read_b32 v26, a252
  v_accvgpr_read_b32 v27, a253
  s_mov_b32 s65, 0
L_gb_tk:
  v_readfirstlane_b32 s56, v26
  v_readfirstlane_b32 s57, v27
  s_add_u32 s65, s65, 1
  s_xor_b32 s56, s56, s72
  s_xor_b32 s57, s57, s73
  s_andn2_b32 s58, s56, 14
  s_or_b32 s58, s58, s57
  s_cbranch_scc0 L_gb_tkok
  s_sleep 2
  buffer_load_dwordx2 v[26:27], v20, s[24:27], s66 offen sc1
  s_waitcnt vmcnt(0)
  s_cmp_lt_u32 s65, 0x200000
  s_cbranch_scc1 L_gb_tk
L_gb_tkok:
  s_bfe_u32 s56, s56, 0x30001
  v_mfma_f32_16x16x32_bf16 v[52:55], a[184:187], a[100:103], v[52:55]
  ds_read_b64_tr_b16 a[170:171], v6 offset:1120
  s_lshr_b32 s66, s56, 1
  s_and_b32 s34, s56, 1
  s_lshl_b32 s34, s34, 2
  v_mfma_f32_16x16x32_bf16 v[52:55], a[188:191], a[116:119], v[52:55]
  s_bfe_u32 s57, s2, 0x20003
  s_add_u32 s34, s34, s57
  s_lshr_b32 s33, s2, 5
  s_mul_i32 s54, s66, 19
  v_mfma_f32_16x16x32_bf16 v[56:59], a[184:187], a[104:107], v[56:59]
  ds_read_b64_tr_b16 a[172:173], v6 offset:8288
  s_add_u32 s54, s54, 16
  s_cmp_eq_u32 s66, 3
  s_cselect_b32 s54, 0, s54
  s_cselect_b32 s67, 16, 19
  v_mfma_f32_16x16x32_bf16 v[56:59], a[188:191], a[120:123], v[56:59]
  buffer_load_dwordx4 a[132:135], v4, s[20:23], s39 offen offset:1024 sc1
  s_cmp_eq_u32 s66, 2
  s_cselect_b32 s67, 18, s67
  s_lshl_b32 s58, s54, 17
  v_mfma_f32_16x16x32_bf16 v[60:63], a[184:187], a[108:111], v[60:63]
  ds_read_b64_tr_b16 a[174:175], v6 offset:9312
  s_add_u32 s58, s58, 0x2600000
  s_lshl_b32 s57, s67, 17
  s_add_u32 s62, s58, s57
  v_mfma_f32_16x16x32_bf16 v[60:63], a[188:191], a[124:127], v[60:63]
  s_sub_u32 s58, s58, 2048
  s_mov_b32 s60, s24
  s_mov_b32 s61, s25
  s_waitcnt lgkmcnt(8)
  v_mfma_f32_16x16x32_bf16 v[64:67], a[160:163], a[96:99], v[64:67]
  ds_read_b64_tr_b16 a[176:177], v6 offset:128
  s_lshr_b32 s56, s32, 1
  s_lshl_b32 s56, s56, 16
  s_lshl_b32 s57, s33, 13
  v_mfma_f32_16x16x32_bf16 v[64:67], a[164:167], a[112:115], v[64:67]
  buffer_load_dwordx4 a[136:139], v4, s[20:23], s39 offen offset:2048 sc1
  s_add_u32 s56, s56, s57
  s_and_b32 s57, s32, 1
  s_lshl_b32 s57, s57, 1
  v_mfma_f32_16x16x32_bf16 v[68:71], a[160:163], a[100:103], v[68:71]
  ds_read_b64_tr_b16 a[178:179], v6 offset:1152
  s_add_u32 s57, s57, s66
  s_add_u32 s59, s57, 1
  s_and_b32 s59, s59, 3
  v_mfma_f32_16x16x32_bf16 v[68:71], a[164:167], a[116:119], v[68:71]
  s_lshl_b32 s59, s59, 11
  s_add_u32 s59, s59, s56
  s_add_u32 s59, s59, 2048
  v_add_u32 v2, s59, v21
  v_mfma_f32_16x16x32_bf16 v[72:75], a[160:163], a[104:107], v[72:75]
  ds_read_b64_tr_b16 a[180:181], v6 offset:8320
  s_add_u32 s59, s57, 2
  s_and_b32 s59, s59, 3
  s_lshl_b32 s59, s59, 11
  v_mfma_f32_16x16x32_bf16 v[72:75], a[164:167], a[120:123], v[72:75]
  buffer_load_dwordx4 a[140:143], v4, s[20:23], s39 offen offset:3072 sc1
  s_add_u32 s39, s39, 0x20000
  s_add_u32 s59, s59, s56
  v_and_b32 v5, 15, v1
  v_mfma_f32_16x16x32_bf16 v[76:79], a[160:163], a[108:111], v[76:79]
  ds_read_b64_tr_b16 a[182:183], v6 offset:9344
  v_lshlrev_b32 v5, 11, v5
  v_bfe_u32 v8, v1, 4, 1
  v_lshl_add_u32 v5, v8, 5, v5
  v_mfma_f32_16x16x32_bf16 v[76:79], a[164:167], a[124:127], v[76:79]
  v_lshrrev_b32 v8, 5, v1
  v_lshl_add_u32 v5, v8, 4, v5
  v_add_u32 v8, s59, v21
  s_waitcnt lgkmcnt(4)
  v_mfma_f32_16x16x32_bf16 v[80:83], a[168:171], a[96:99], v[80:83]
  ds_read_b64_tr_b16 a[184:185], v6 offset:160
  s_lshl_b32 s56, s34, 19
  s_lshl_b32 s57, s32, 17
  s_add_u32 s56, s56, s57
  v_mfma_f32_16x16x32_bf16 v[80:83], a[172:175], a[112:115], v[80:83]
  buffer_load_dwordx4 a[144:147], v4, s[20:23], s39 offen offset:0 sc1
  s_lshl_b32 s57, s33, 8
  s_add_u32 s56, s56, s57
  s_lshl_b32 s57, s66, 6
  v_mfma_f32_16x16x32_bf16 v[84:87], a[168:171], a[100:103], v[84:87]
  ds_read_b64_tr_b16 a[186:187], v6 offset:1184
  s_add_u32 s59, s56, s57
  s_lshl_b32 s56, s32, 12
  s_lshl_b32 s57, s32, 9
  v_mfma_f32_16x16x32_bf16 v[84:87], a[172:175], a[116:119], v[84:87]
  s_add_u32 s57, s57, 0x18a0000
  s_mov_b32 s71, s59
  v_cvt_pk_bf16_f32 v32, v32, v33
  v_cvt_pk_bf16_f32 v33, v34, v35
  v_mfma_f32_16x16x32_bf16 v[88:91], a[168:171], a[104:107], v[88:91]
  ds_read_b64_tr_b16 a[188:189], v6 offset:8352
  v_cvt_pk_bf16_f32 v34, v36, v37
  v_cvt_pk_bf16_f32 v35, v38, v39
  v_cvt_pk_bf16_f32 v36, v48, v49
  v_mfma_f32_16x16x32_bf16 v[88:91], a[172:175], a[120:123], v[88:91]
  buffer_load_dwordx4 a[148:151], v4, s[20:23], s39 offen offset:1024 sc1
  v_cvt_pk_bf16_f32 v37, v50, v51
  v_cvt_pk_bf16_f32 v38, v52, v53
  v_cvt_pk_bf16_f32 v39, v54, v55
  v_mfma_f32_16x16x32_bf16 v[92:95], a[168:171], a[108:111], v[92:95]
  ds_read_b64_tr_b16 a[190:191], v6 offset:9376
  v_cvt_pk_bf16_f32 v40, v40, v41
  v_cvt_pk_bf16_f32 v41, v42, v43
  v_cvt_pk_bf16_f32 v42, v44, v45
  v_mfma_f32_16x16x32_bf16 v[92:95], a[172:175], a[124:127], v[92:95]
  v_cvt_pk_bf16_f32 v43, v46, v47
  v_cvt_pk_bf16_f32 v44, v56, v57
  v_cvt_pk_bf16_f32 v45, v58, v59
  s_barrier
  buffer_store_dwordx2 v[24:25], v20, s[24:27], s69 offen sc1
  s_waitcnt lgkmcnt(4)
  v_mfma_f32_16x16x32_bf16 v[96:99], a[96:99], a[176:179], v[96:99]
  ds_read_b64_tr_b16 a[160:161], v6 offset:16384
  v_cvt_pk_bf16_f32 v46, v60, v61
  v_cvt_pk_bf16_f32 v47, v62, v63
  v_permlane16_swap_b32 v32, v34
  v_mfma_f32_16x16x32_bf16 v[96:99], a[112:115], a[180:183], v[96:99]
  buffer_load_dwordx4 a[152:155], v4, s[20:23], s39 offen offset:2048 sc1
  v_permlane16_swap_b32 v33, v35
  v_permlane16_swap_b32 v36, v38
  v_permlane16_swap_b32 v37, v39
  v_mfma_f32_16x16x32_bf16 v[100:103], a[100:103], a[176:179], v[100:103]
  ds_read_b64_tr_b16 a[162:163], v6 offset:17408
  v_permlane16_swap_b32 v40, v42
  v_permlane16_swap_b32 v41, v43
  v_permlane16_swap_b32 v44, v46
  v_mfma_f32_16x16x32_bf16 v[100:103], a[116:119], a[180:183], v[100:103]
  v_permlane16_swap_b32 v45, v47
  v_cvt_pk_bf16_f32 v48, v64, v65
  v_cvt_pk_bf16_f32 v49, v66, v67
  v_cvt_pk_bf16_f32 v50, v68, v69
  v_mfma_f32_16x16x32_bf16 v[104:107], a[104:107], a[176:179], v[104:107]
  ds_read_b64_tr_b16 a[164:165], v6 offset:24576
  v_cvt_pk_bf16_f32 v51, v70, v71
  v_cvt_pk_bf16_f32 v52, v80, v81
  v_cvt_pk_bf16_f32 v53, v82, v83
  v_mfma_f32_16x16x32_bf16 v[104:107], a[120:123], a[180:183], v[104:107]
  buffer_load_dwordx4 a[156:159], v4, s[20:23], s39 offen offset:3072 sc1
  s_add_u32 s39, s39, 0x20000
  v_cvt_pk_bf16_f32 v54, v84, v85
  v_cvt_pk_bf16_f32 v55, v86, v87
  v_mfma_f32_16x16x32_bf16 v[108:111], a[108:111], a[176:179], v[108:111]
  ds_read_b64_tr_b16 a[166:167], v6 offset:25600
  v_cvt_pk_bf16_f32 v56, v72, v73
  v_cvt_pk_bf16_f32 v57, v74, v75
  v_cvt_pk_bf16_f32 v58, v76, v77
  v_mfma_f32_16x16x32_bf16 v[108:111], a[124:127], a[180:183], v[108:111]
  v_cvt_pk_bf16_f32 v59, v78, v79
  v_cvt_pk_bf16_f32 v60, v88, v89
  v_cvt_pk_bf16_f32 v61, v90, v91
  s_waitcnt lgkmcnt(4)
  v_mfma_f32_16x16x32_bf16 v[112:115], a[96:99], a[184:187], v[112:115]
  ds_read_b64_tr_b16 a[168:169], v6 offset:16416
  v_cvt_pk_bf16_f32 v62, v92, v93
  v_cvt_pk_bf16_f32 v63, v94, v95
  v_permlane16_swap_b32 v48, v50
  v_mfma_f32_16x16x32_bf16 v[112:115], a[112:115], a[188:191], v[112:115]
  s_add_u32 m0, s38, 49152
  v_permlane16_swap_b32 v49, v51
  v_permlane16_swap_b32 v52, v54
  v_permlane16_swap_b32 v53, v55
  v_mfma_f32_16x16x32_bf16 v[116:119], a[100:103], a[184:187], v[116:119]
  ds_read_b64_tr_b16 a[170:171], v6 offset:17440
  buffer_load_dwordx4 v3, s[16:19], s37 offen lds
  v_permlane16_swap_b32 v56, v58
  v_permlane16_swap_b32 v57, v59
  v_mfma_f32_16x16x32_bf16 v[116:119], a[116:119], a[188:191], v[116:119]
  s_add_u32 s37, s37, 114688
  v_permlane16_swap_b32 v60, v62
  v_permlane16_swap_b32 v61, v63
  v_mfma_f32_32x32x16_bf16 v[64:79], a[200:203], v[48:51], 0
  v_mfma_f32_16x16x32_bf16 v[120:123], a[104:107], a[184:187], v[120:123]
  ds_read_b64_tr_b16 a[172:173], v6 offset:24608
  v_mfma_f32_32x32x16_bf16 v[80:95], a[200:203], v[56:59], 0
  v_mfma_f32_32x32x16_bf16 v[64:79], a[204:207], v[52:55], v[64:79]
  v_mfma_f32_16x16x32_bf16 v[120:123], a[120:123], a[188:191], v[120:123]
  s_add_u32 m0, s38, 53248
  v_mfma_f32_32x32x16_bf16 v[80:95], a[204:207], v[60:63], v[80:95]
  v_mfma_f32_16x16x32_bf16 v[124:127], a[108:111], a[184:187], v[124:127]
  ds_read_b64_tr_b16 a[174:175], v6 offset:25632
  buffer_load_dwordx4 v3, s[16:19], s37 offen lds
  v_mfma_f32_16x16x32_bf16 v[124:127], a[124:127], a[188:191], v[124:127]
  s_add_u32 s37, s37, 114688
  s_waitcnt lgkmcnt(4)
  v_mfma_f32_16x16x32_bf16 v[128:131], a[160:163], a[96:99], v[128:131]
  ds_read_b64_tr_b16 a[176:177], v6 offset:16448
  v_cvt_pk_bf16_f32 v96, v96, v97
  v_cvt_pk_bf16_f32 v97, v98, v99
  v_cvt_pk_bf16_f32 v98, v100, v101
  v_mfma_f32_16x16x32_bf16 v[128:131], a[164:167], a[112:115], v[128:131]
  s_add_u32 m0, s38, 57344
  v_cvt_pk_bf16_f32 v99, v102, v103
  v_cvt_pk_bf16_f32 v100, v112, v113
  v_cvt_pk_bf16_f32 v101, v114, v115
  v_mfma_f32_16x16x32_bf16 v[132:135], a[160:163], a[100:103], v[132:135]
  ds_read_b64_tr_b16 a[178:179], v6 offset:17472
  buffer_load_dwordx4 v3, s[16:19], s37 offen lds
  v_cvt_pk_bf16_f32 v102, v116, v117
  v_cvt_pk_bf16_f32 v103, v118, v119
  v_mfma_f32_16x16x32_bf16 v[132:135], a[164:167], a[116:119], v[132:135]
  s_add_u32 s37, s37, 114688
  v_cvt_pk_bf16_f32 v104, v104, v105
  v_cvt_pk_bf16_f32 v105, v106, v107
  v_cvt_pk_bf16_f32 v106, v108, v109
  v_mfma_f32_16x16x32_bf16 v[144:147], a[160:163], a[104:107], v[144:147]
  ds_read_b64_tr_b16 a[180:181], v6 offset:24640
  v_cvt_pk_bf16_f32 v107, v110, v111
  v_cvt_pk_bf16_f32 v108, v120, v121
  v_cvt_pk_bf16_f32 v109, v122, v123
  v_mfma_f32_16x16x32_bf16 v[144:147], a[164:167], a[120:123], v[144:147]
  s_add_u32 m0, s38, 61440
  v_cvt_pk_bf16_f32 v110, v124, v125
  v_cvt_pk_bf16_f32 v111, v126, v127
  ds_write_b128 v11, v[96:99] offset:0
  v_mfma_f32_16x16x32_bf16 v[148:151], a[160:163], a[108:111], v[148:151]
  ds_read_b64_tr_b16 a[182:183], v6 offset:25664
  buffer_load_dwordx4 v3, s[16:19], s37 offen lds
  ds_write_b128 v11, v[100:103] offset:1024
  ds_write_b128 v11, v[104:107] offset:2048
  v_mfma_f32_16x16x32_bf16 v[148:151], a[164:167], a[124:127], v[148:151]
  s_add_u32 s37, s37, 114688
  ds_write_b128 v11, v[108:111] offset:3072
  v_cvt_pk_bf16_f32 v64, 0, v64
  s_waitcnt lgkmcnt(8)
  v_mfma_f32_16x16x32_bf16 v[160:163], a[168:171], a[96:99], v[160:163]
  ds_read_b64_tr_b16 a[184:185], v6 offset:16480
  v_cvt_pk_bf16_f32 v80, 0, v80
  v_cvt_pk_bf16_f32 v65, 0, v65
  v_cvt_pk_bf16_f32 v81, 0, v81
  v_mfma_f32_16x16x32_bf16 v[160:163], a[172:175], a[112:115], v[160:163]
  s_add_u32 m0, s38, 81920
  v_cvt_pk_bf16_f32 v66, 0, v66
  v_cvt_pk_bf16_f32 v82, 0, v82
  v_cvt_pk_bf16_f32 v67, 0, v67
  v_mfma_f32_16x16x32_bf16 v[164:167], a[168:171], a[100:103], v[164:167]
  ds_read_b64_tr_b16 a[186:187], v6 offset:17504
  buffer_load_dwordx4 v3, s[12:15], s36 offen lds
  v_cvt_pk_bf16_f32 v83, 0, v83
  v_cvt_pk_bf16_f32 v68, 0, v68
  v_mfma_f32_16x16x32_bf16 v[164:167], a[172:175], a[116:119], v[164:167]
  s_add_u32 s36, s36, 114688
  v_cvt_pk_bf16_f32 v84, 0, v84
  v_cvt_pk_bf16_f32 v69, 0, v69
  v_cvt_pk_bf16_f32 v85, 0, v85
  v_mfma_f32_16x16x32_bf16 v[176:179], a[168:171], a[104:107], v[176:179]
  ds_read_b64_tr_b16 a[188:189], v6 offset:24672
  v_cvt_pk_bf16_f32 v70, 0, v70
  v_cvt_pk_bf16_f32 v86, 0, v86
  v_cvt_pk_bf16_f32 v71, 0, v71
  v_mfma_f32_16x16x32_bf16 v[176:179], a[172:175], a[120:123], v[176:179]
  s_add_u32 m0, s38, 86016
  v_cvt_pk_bf16_f32 v87, 0, v87
  v_cvt_pk_bf16_f32 v72, 0, v72
  v_cvt_pk_bf16_f32 v88, 0, v88
  v_mfma_f32_16x16x32_bf16 v[180:183], a[168:171], a[108:111], v[180:183]
  ds_read_b64_tr_b16 a[190:191], v6 offset:25696
  buffer_load_dwordx4 v3, s[12:15], s36 offen lds
  v_cvt_pk_bf16_f32 v73, 0, v73
  v_cvt_pk_bf16_f32 v89, 0, v89
  v_mfma_f32_16x16x32_bf16 v[180:183], a[172:175], a[124:127], v[180:183]
  s_add_u32 s36, s36, 114688
  v_cvt_pk_bf16_f32 v74, 0, v74
  v_cvt_pk_bf16_f32 v90, 0, v90
  s_waitcnt lgkmcnt(7)
  v_mfma_f32_16x16x32_bf16 a[0:3], a[176:179], a[96:99], a[0:3]
  ds_read_b64_tr_b16 a[160:161], v6 offset:16512
  v_cvt_pk_bf16_f32 v75, 0, v75
  v_cvt_pk_bf16_f32 v91, 0, v91
  v_cvt_pk_bf16_f32 v76, 0, v76
  v_mfma_f32_16x16x32_bf16 a[0:3], a[180:183], a[112:115], a[0:3]
  s_add_u32 m0, s38, 90112
  v_cvt_pk_bf16_f32 v92, 0, v92
  v_cvt_pk_bf16_f32 v77, 0, v77
  v_cvt_pk_bf16_f32 v93, 0, v93
  v_mfma_f32_16x16x32_bf16 a[4:7], a[176:179], a[100:103], a[4:7]
  ds_read_b64_tr_b16 a[162:163], v6 offset:17536
  buffer_load_dwordx4 v3, s[12:15], s36 offen lds
  v_cvt_pk_bf16_f32 v78, 0, v78
  v_cvt_pk_bf16_f32 v94, 0, v94
  v_mfma_f32_16x16x32_bf16 a[4:7], a[180:183], a[116:119], a[4:7]
  s_add_u32 s36, s36, 114688
  v_cvt_pk_bf16_f32 v79, 0, v79
  v_cvt_pk_bf16_f32 v95, 0, v95
  v_max3_f32 v48, v64, v65, v66
  v_mfma_f32_16x16x32_bf16 a[16:19], a[176:179], a[104:107], a[16:19]
  ds_read_b64_tr_b16 a[164:165], v6 offset:24704
  v_max3_f32 v56, v80, v81, v82
  v_min3_f32 v50, v64, v65, v66
  v_min3_f32 v58, v80, v81, v82
  v_mfma_f32_16x16x32_bf16 a[16:19], a[180:183], a[120:123], a[16:19]
  s_add_u32 m0, s38, 94208
  v_max3_f32 v48, v48, v67, v68
  v_max3_f32 v56, v56, v83, v84
  v_min3_f32 v50, v50, v67, v68
  v_mfma_f32_16x16x32_bf16 a[20:23], a[176:179], a[108:111], a[20:23]
  ds_read_b64_tr_b16 a[166:167], v6 offset:25728
  buffer_load_dwordx4 v3, s[12:15], s36 offen lds
  v_min3_f32 v58, v58, v83, v84
  v_max3_f32 v48, v48, v69, v70
  v_mfma_f32_16x16x32_bf16 a[20:23], a[180:183], a[124:127], a[20:23]
  s_add_u32 s36, s36, 114688
  v_max3_f32 v56, v56, v85, v86
  v_min3_f32 v50, v50, v69, v70
  s_waitcnt lgkmcnt(4)
  v_mfma_f32_16x16x32_bf16 a[32:35], a[184:187], a[96:99], a[32:35]
  ds_read_b64_tr_b16 a[168:169], v6 offset:16544
  v_min3_f32 v58, v58, v85, v86
  v_max3_f32 v48, v48, v71, v72
  v_max3_f32 v56, v56, v87, v88
  v_mfma_f32_16x16x32_bf16 a[32:35], a[188:191], a[112:115], a[32:35]
  v_min3_f32 v50, v50, v71, v72
  v_min3_f32 v58, v58, v87, v88
  v_max3_f32 v48, v48, v73, v74
  v_max3_f32 v56, v56, v89, v90
  v_mfma_f32_16x16x32_bf16 a[36:39], a[184:187], a[100:103], a[36:39]
  ds_read_b64_tr_b16 a[170:171], v6 offset:17568
  v_min3_f32 v50, v50, v73, v74
  v_min3_f32 v58, v58, v89, v90
  v_max3_f32 v48, v48, v75, v76
  v_mfma_f32_16x16x32_bf16 a[36:39], a[188:191], a[116:119], a[36:39]
  v_max3_f32 v56, v56, v91, v92
  v_min3_f32 v50, v50, v75, v76
  v_min3_f32 v58, v58, v91, v92
  v_max3_f32 v48, v48, v77, v78
  v_mfma_f32_16x16x32_bf16 a[48:51], a[184:187], a[104:107], a[48:51]
  ds_read_b64_tr_b16 a[172:173], v6 offset:24736
  v_max3_f32 v56, v56, v93, v94
  v_min3_f32 v50, v50, v77, v78
  v_min3_f32 v58, v58, v93, v94
  v_mfma_f32_16x16x32_bf16 a[48:51], a[188:191], a[120:123], a[48:51]
  v_max_f32 v48, v48, v79
  v_max_f32 v56, v56, v95
  v_min_f32 v50, v50, v79
  v_min_f32 v58, v58, v95
  v_mfma_f32_16x16x32_bf16 a[52:55], a[184:187], a[108:111], a[52:55]
  ds_read_b64_tr_b16 a[174:175], v6 offset:25760
  v_mov_b32 v52, v48
  v_mov_b32 v60, v56
  v_mov_b32 v53, v50
  v_mfma_f32_16x16x32_bf16 a[52:55], a[188:191], a[124:127], a[52:55]
  v_mov_b32 v61, v58
  v_permlane32_swap_b32 v48, v52
  v_permlane32_swap_b32 v56, v60
  s_waitcnt lgkmcnt(4)
  v_mfma_f32_16x16x32_bf16 a[64:67], a[160:163], a[96:99], a[64:67]
  ds_read_b64_tr_b16 a[176:177], v6 offset:16576
  v_permlane32_swap_b32 v50, v53
  v_permlane32_swap_b32 v58, v61
  v_max_f32 v48, v48, v52
  v_mfma_f32_16x16x32_bf16 a[64:67], a[164:167], a[112:115], a[64:67]
  v_max_f32 v56, v56, v60
  v_min_f32 v50, v50, v53
  v_min_f32 v58, v58, v61
  v_mul_f32 v48, s50, v48
  v_mfma_f32_16x16x32_bf16 a[68:71], a[160:163], a[100:103], a[68:71]
  ds_read_b64_tr_b16 a[178:179], v6 offset:17600
  v_mul_f32 v56, s50, v56
  v_mul_f32 v50, s50, v50
  v_mul_f32 v58, s50, v58
  v_mfma_f32_16x16x32_bf16 a[68:71], a[164:167], a[116:119], a[68:71]
  v_pk_fma_f32 v[96:97], v[64:65], s[50:51], v[50:51] op_sel_hi:[1,1,0] neg_lo:[1,0,0] neg_hi:[1,0,0]
  v_pk_fma_f32 v[112:113], v[80:81], s[50:51], v[58:59] op_sel_hi:[1,1,0] neg_lo:[1,0,0] neg_hi:[1,0,0]
  v_pk_fma_f32 v[64:65], v[64:65], s[50:51], v[48:49] op_sel_hi:[1,1,0] neg_lo:[0,0,1] neg_hi:[0,0,1]
  v_pk_fma_f32 v[80:81], v[80:81], s[50:51], v[56:57] op_sel_hi:[1,1,0] neg_lo:[0,0,1] neg_hi:[0,0,1]
  v_pk_fma_f32 v[98:99], v[66:67], s[50:51], v[50:51] op_sel_hi:[1,1,0] neg_lo:[1,0,0] neg_hi:[1,0,0]
  v_pk_fma_f32 v[114:115], v[82:83], s[50:51], v[58:59] op_sel_hi:[1,1,0] neg_lo:[1,0,0] neg_hi:[1,0,0]
  v_pk_fma_f32 v[66:67], v[66:67], s[50:51], v[48:49] op_sel_hi:[1,1,0] neg_lo:[0,0,1] neg_hi:[0,0,1]
  v_pk_fma_f32 v[82:83], v[82:83], s[50:51], v[56:57] op_sel_hi:[1,1,0] neg_lo:[0,0,1] neg_hi:[0,0,1]
  v_pk_fma_f32 v[100:101], v[68:69], s[50:51], v[50:51] op_sel_hi:[1,1,0] neg_lo:[1,0,0] neg_hi:[1,0,0]
  v_pk_fma_f32 v[116:117], v[84:85], s[50:51], v[58:59] op_sel_hi:[1,1,0] neg_lo:[1,0,0] neg_hi:[1,0,0]
  v_pk_fma_f32 v[68:69], v[68:69], s[50:51], v[48:49] op_sel_hi:[1,1,0] neg_lo:[0,0,1] neg_hi:[0,0,1]
  v_pk_fma_f32 v[84:85], v[84:85], s[50:51], v[56:57] op_sel_hi:[1,1,0] neg_lo:[0,0,1] neg_hi:[0,0,1]
  v_pk_fma_f32 v[102:103], v[70:71], s[50:51], v[50:51] op_sel_hi:[1,1,0] neg_lo:[1,0,0] neg_hi:[1,0,0]
  v_pk_fma_f32 v[118:119], v[86:87], s[50:51], v[58:59] op_sel_hi:[1,1,0] neg_lo:[1,0,0] neg_hi:[1,0,0]
  v_pk_fma_f32 v[70:71], v[70:71], s[50:51], v[48:49] op_sel_hi:[1,1,0] neg_lo:[0,0,1] neg_hi:[0,0,1]
  v_pk_fma_f32 v[86:87], v[86:87], s[50:51], v[56:57] op_sel_hi:[1,1,0] neg_lo:[0,0,1] neg_hi:[0,0,1]
  v_pk_fma_f32 v[104:105], v[72:73], s[50:51], v[50:51] op_sel_hi:[1,1,0] neg_lo:[1,0,0] neg_hi:[1,0,0]
  v_pk_fma_f32 v[120:121], v[88:89], s[50:51], v[58:59] op_sel_hi:[1,1,0] neg_lo:[1,0,0] neg_hi:[1,0,0]
  v_pk_fma_f32 v[72:73], v[72:73], s[50:51], v[48:49] op_sel_hi:[1,1,0] neg_lo:[0,0,1] neg_hi:[0,0,1]
  v_pk_fma_f32 v[88:89], v[88:89], s[50:51], v[56:57] op_sel_hi:[1,1,0] neg_lo:[0,0,1] neg_hi:[0,0,1]
  v_pk_fma_f32 v[106:107], v[74:75], s[50:51], v[50:51] op_sel_hi:[1,1,0] neg_lo:[1,0,0] neg_hi:[1,0,0]
  v_pk_fma_f32 v[122:123], v[90:91], s[50:51], v[58:59] op_sel_hi:[1,1,0] neg_lo:[1,0,0] neg_hi:[1,0,0]
  v_pk_fma_f32 v[74:75], v[74:75], s[50:51], v[48:49] op_sel_hi:[1,1,0] neg_lo:[0,0,1] neg_hi:[0,0,1]
  v_pk_fma_f32 v[90:91], v[90:91], s[50:51], v[56:57] op_sel_hi:[1,1,0] neg_lo:[0,0,1] neg_hi:[0,0,1]
  v_pk_fma_f32 v[108:109], v[76:77], s[50:51], v[50:51] op_sel_hi:[1,1,0] neg_lo:[1,0,0] neg_hi:[1,0,0]
  v_pk_fma_f32 v[124:125], v[92:93], s[50:51], v[58:59] op_sel_hi:[1,1,0] neg_lo:[1,0,0] neg_hi:[1,0,0]
  v_pk_fma_f32 v[76:77], v[76:77], s[50:51], v[48:49] op_sel_hi:[1,1,0] neg_lo:[0,0,1] neg_hi:[0,0,1]
  v_pk_fma_f32 v[92:93], v[92:93], s[50:51], v[56:57] op_sel_hi:[1,1,0] neg_lo:[0,0,1] neg_hi:[0,0,1]
  v_pk_fma_f32 v[110:111], v[78:79], s[50:51], v[50:51] op_sel_hi:[1,1,0] neg_lo:[1,0,0] neg_hi:[1,0,0]
  v_pk_fma_f32 v[126:127], v[94:95], s[50:51], v[58:59] op_sel_hi:[1,1,0] neg_lo:[1,0,0] neg_hi:[1,0,0]
  v_pk_fma_f32 v[78:79], v[78:79], s[50:51], v[48:49] op_sel_hi:[1,1,0] neg_lo:[0,0,1] neg_hi:[0,0,1]
  v_pk_fma_f32 v[94:95], v[94:95], s[50:51], v[56:57] op_sel_hi:[1,1,0] neg_lo:[0,0,1] neg_hi:[0,0,1]
  v_mfma_f32_16x16x32_bf16 a[80:83], a[160:163], a[104:107], a[80:83]
  ds_read_b64_tr_b16 a[180:181], v6 offset:24768
  v_exp_f32 v64, v64
  v_exp_f32 v80, v80
  v_mfma_f32_16x16x32_bf16 a[80:83], a[164:167], a[120:123], a[80:83]
  v_exp_f32 v96, v96
  v_exp_f32 v112, v112
  v_mfma_f32_16x16x32_bf16 a[84:87], a[160:163], a[108:111], a[84:87]
  ds_read_b64_tr_b16 a[182:183], v6 offset:25792
  v_exp_f32 v65, v65
  v_exp_f32 v81, v81
  v_mfma_f32_16x16x32_bf16 a[84:87], a[164:167], a[124:127], a[84:87]
  v_exp_f32 v97, v97
  v_exp_f32 v113, v113
  s_waitcnt vmcnt(27)
  s_barrier
  s_waitcnt lgkmcnt(4)
  v_mfma_f32_16x16x32_bf16 v[192:195], a[168:171], a[96:99], v[192:195]
  ds_read_b64_tr_b16 a[184:185], v6 offset:32768
  v_exp_f32 v66, v66
  v_exp_f32 v82, v82
  v_mfma_f32_16x16x32_bf16 v[192:195], a[172:175], a[112:115], v[192:195]
  s_add_u32 m0, s38, 0
  v_exp_f32 v98, v98
  v_exp_f32 v114, v114
  v_mfma_f32_16x16x32_bf16 v[196:199], a[168:171], a[100:103], v[196:199]
  ds_read_b64_tr_b16 a[186:187], v6 offset:33792
  buffer_load_dwordx4 v3, s[16:19], s37 offen lds
  v_exp_f32 v67, v67
  v_mfma_f32_16x16x32_bf16 v[196:199], a[172:175], a[116:119], v[196:199]
  s_add_u32 s37, s37, 114688
  v_exp_f32 v83, v83
  v_exp_f32 v99, v99
  v_mfma_f32_16x16x32_bf16 v[208:211], a[168:171], a[104:107], v[208:211]
  ds_read_b64_tr_b16 a[188:189], v6 offset:40960
  v_exp_f32 v115, v115
  v_exp_f32 v68, v68
  v_mfma_f32_16x16x32_bf16 v[208:211], a[172:175], a[120:123], v[208:211]
  s_add_u32 m0, s38, 4096
  v_exp_f32 v84, v84
  v_exp_f32 v100, v100
  v_mfma_f32_16x16x32_bf16 v[212:215], a[168:171], a[108:111], v[212:215]
  ds_read_b64_tr_b16 a[190:191], v6 offset:41984
  buffer_load_dwordx4 v3, s[16:19], s37 offen lds
  v_exp_f32 v116, v116
  v_mfma_f32_16x16x32_bf16 v[212:215], a[172:175], a[124:127], v[212:215]
  s_add_u32 s37, s37, 114688
  v_exp_f32 v69, v69
  s_waitcnt lgkmcnt(4)
  v_mfma_f32_16x16x32_bf16 v[224:227], a[176:179], a[96:99], v[224:227]
  ds_read_b64_tr_b16 a[160:161], v6 offset:32800
  v_exp_f32 v85, v85
  v_exp_f32 v101, v101
  v_mfma_f32_16x16x32_bf16 v[224:227], a[180:183], a[112:115], v[224:227]
  s_add_u32 m0, s38, 8192
  v_exp_f32 v117, v117
  v_exp_f32 v70, v70
  v_mfma_f32_16x16x32_bf16 v[228:231], a[176:179], a[100:103], v[228:231]
  ds_read_b64_tr_b16 a[162:163], v6 offset:33824
  buffer_load_dwordx4 v3, s[16:19], s37 offen lds
  v_exp_f32 v86, v86
  v_mfma_f32_16x16x32_bf16 v[228:231], a[180:183], a[116:119], v[228:231]
  s_add_u32 s37, s37, 114688
  v_exp_f32 v102, v102
  v_exp_f32 v118, v118
  v_mfma_f32_16x16x32_bf16 v[240:243], a[176:179], a[104:107], v[240:243]
  ds_read_b64_tr_b16 a[164:165], v6 offset:40992
  v_exp_f32 v71, v71
  v_exp_f32 v87, v87
  v_mfma_f32_16x16x32_bf16 v[240:243], a[180:183], a[120:123], v[240:243]
  s_add_u32 m0, s38, 12288
  v_exp_f32 v103, v103
  v_exp_f32 v119, v119
  v_mfma_f32_16x16x32_bf16 v[244:247], a[176:179], a[108:111], v[244:247]
  ds_read_b64_tr_b16 a[166:167], v6 offset:42016
  buffer_load_dwordx4 v3, s[16:19], s37 offen lds
  v_exp_f32 v72, v72
  v_mfma_f32_16x16x32_bf16 v[244:247], a[180:183], a[124:127], v[244:247]
  s_add_u32 s37, s37, 114688
  v_exp_f32 v88, v88
  s_waitcnt lgkmcnt(4)
  v_mfma_f32_16x16x32_bf16 v[136:139], a[184:187], a[96:99], v[136:139]
  ds_read_b64_tr_b16 a[168:169], v6 offset:32832
  v_exp_f32 v104, v104
  v_exp_f32 v120, v120
  v_mfma_f32_16x16x32_bf16 v[136:139], a[188:191], a[112:115], v[136:139]
  v_exp_f32 v73, v73
  v_exp_f32 v89, v89
  v_mfma_f32_16x16x32_bf16 v[140:143], a[184:187], a[100:103], v[140:143]
  ds_read_b64_tr_b16 a[170:171], v6 offset:33856
  v_exp_f32 v105, v105
  v_exp_f32 v121, v121
  v_mfma_f32_16x16x32_bf16 v[140:143], a[188:191], a[116:119], v[140:143]
  v_exp_f32 v74, v74
  v_exp_f32 v90, v90
  v_mfma_f32_16x16x32_bf16 v[152:155], a[184:187], a[104:107], v[152:155]
  ds_read_b64_tr_b16 a[172:173], v6 offset:41024
  v_exp_f32 v106, v106
  v_exp_f32 v122, v122
  v_mfma_f32_16x16x32_bf16 v[152:155], a[188:191], a[120:123], v[152:155]
  v_exp_f32 v75, v75
  v_exp_f32 v91, v91
  v_mfma_f32_16x16x32_bf16 v[156:159], a[184:187], a[108:111], v[156:159]
  ds_read_b64_tr_b16 a[174:175], v6 offset:42048
  v_exp_f32 v107, v107
  v_exp_f32 v123, v123
  v_mfma_f32_16x16x32_bf16 v[156:159], a[188:191], a[124:127], v[156:159]
  v_exp_f32 v76, v76
  v_exp_f32 v92, v92
  s_waitcnt lgkmcnt(4)
  v_mfma_f32_16x16x32_bf16 v[168:171], a[160:163], a[96:99], v[168:171]
  ds_read_b64_tr_b16 a[176:177], v6 offset:32864
  v_exp_f32 v108, v108
  v_exp_f32 v124, v124
  v_mfma_f32_16x16x32_bf16 v[168:171], a[164:167], a[112:115], v[168:171]
  v_exp_f32 v77, v77
  v_exp_f32 v93, v93
  v_mfma_f32_16x16x32_bf16 v[172:175], a[160:163], a[100:103], v[172:175]
  ds_read_b64_tr_b16 a[178:179], v6 offset:33888
  v_exp_f32 v109, v109
  v_exp_f32 v125, v125
  v_mfma_f32_16x16x32_bf16 v[172:175], a[164:167], a[116:119], v[172:175]
  v_exp_f32 v78, v78
  v_exp_f32 v94, v94
  v_mfma_f32_16x16x32_bf16 v[184:187], a[160:163], a[104:107], v[184:187]
  ds_read_b64_tr_b16 a[180:181], v6 offset:41056
  v_exp_f32 v110, v110
  v_exp_f32 v126, v126
  v_mfma_f32_16x16x32_bf16 v[184:187], a[164:167], a[120:123], v[184:187]
  v_exp_f32 v79, v79
  v_exp_f32 v95, v95
  v_mfma_f32_16x16x32_bf16 v[188:191], a[160:163], a[108:111], v[188:191]
  ds_read_b64_tr_b16 a[182:183], v6 offset:42080
  v_exp_f32 v111, v111
  v_exp_f32 v127, v127
  v_mfma_f32_16x16x32_bf16 v[188:191], a[164:167], a[124:127], v[188:191]
  v_pk_add_f32 v[48:49], v[64:65], v[66:67]
  v_pk_add_f32 v[56:57], v[80:81], v[82:83]
  v_pk_add_f32 v[50:51], v[96:97], v[98:99]
  v_pk_add_f32 v[58:59], v[112:113], v[114:115]
  v_pk_add_f32 v[48:49], v[48:49], v[68:69]
  v_pk_add_f32 v[56:57], v[56:57], v[84:85]
  v_pk_add_f32 v[50:51], v[50:51], v[100:101]
  v_pk_add_f32 v[58:59], v[58:59], v[116:117]
  v_pk_add_f32 v[48:49], v[48:49], v[70:71]
  v_pk_add_f32 v[56:57], v[56:57], v[86:87]
  v_pk_add_f32 v[50:51], v[50:51], v[102:103]
  v_pk_add_f32 v[58:59], v[58:59], v[118:119]
  v_pk_add_f32 v[48:49], v[48:49], v[72:73]
  v_pk_add_f32 v[56:57], v[56:57], v[88:89]
  v_pk_add_f32 v[50:51], v[50:51], v[104:105]
  v_pk_add_f32 v[58:59], v[58:59], v[120:121]
  v_pk_add_f32 v[48:49], v[48:49], v[74:75]
  v_pk_add_f32 v[56:57], v[56:57], v[90:91]
  v_pk_add_f32 v[50:51], v[50:51], v[106:107]
  v_pk_add_f32 v[58:59], v[58:59], v[122:123]
  v_pk_add_f32 v[48:49], v[48:49], v[76:77]
  v_pk_add_f32 v[56:57], v[56:57], v[92:93]
  v_pk_add_f32 v[50:51], v[50:51], v[108:109]
  v_pk_add_f32 v[58:59], v[58:59], v[124:125]
  v_pk_add_f32 v[48:49], v[48:49], v[78:79]
  v_pk_add_f32 v[56:57], v[56:57], v[94:95]
  v_pk_add_f32 v[50:51], v[50:51], v[110:111]
  v_pk_add_f32 v[58:59], v[58:59], v[126:127]
  s_waitcnt lgkmcnt(4)
  v_mfma_f32_16x16x32_bf16 a[8:11], a[168:171], a[96:99], a[8:11]
  ds_read_b64_tr_b16 a[184:185], v6 offset:32896
  v_add_f32 v48, v48, v49
  v_add_f32 v56, v56, v57
  v_add_f32 v50, v50, v51
  v_mfma_f32_16x16x32_bf16 a[8:11], a[172:175], a[112:115], a[8:11]
  v_add_f32 v58, v58, v59
  v_mov_b32 v52, v48
  v_mov_b32 v60, v56
  v_mov_b32 v53, v50
  v_mfma_f32_16x16x32_bf16 a[12:15], a[168:171], a[100:103], a[12:15]
  ds_read_b64_tr_b16 a[186:187], v6 offset:33920
  v_mov_b32 v61, v58
  v_permlane32_swap_b32 v48, v52
  v_permlane32_swap_b32 v56, v60
  v_mfma_f32_16x16x32_bf16 a[12:15], a[172:175], a[116:119], a[12:15]
  v_permlane32_swap_b32 v50, v53
  v_permlane32_swap_b32 v58, v61
  v_add_f32 v48, v48, v52
  v_add_f32 v56, v56, v60
  v_mfma_f32_16x16x32_bf16 a[24:27], a[168:171], a[104:107], a[24:27]
  ds_read_b64_tr_b16 a[188:189], v6 offset:41088
  v_add_f32 v50, v50, v53
  v_add_f32 v58, v58, v61
  v_rcp_f32 v48, v48
  v_mfma_f32_16x16x32_bf16 a[24:27], a[172:175], a[120:123], a[24:27]
  v_rcp_f32 v56, v56
  v_rcp_f32 v50, v50
  v_mfma_f32_16x16x32_bf16 a[28:31], a[168:171], a[108:111], a[28:31]
  ds_read_b64_tr_b16 a[190:191], v6 offset:42112
  v_rcp_f32 v58, v58
  v_pk_mul_f32 v[64:65], v[64:65], v[48:49] op_sel_hi:[1,0]
  v_pk_mul_f32 v[80:81], v[80:81], v[56:57] op_sel_hi:[1,0]
  v_pk_mul_f32 v[96:97], v[96:97], v[50:51] op_sel_hi:[1,0]
  v_pk_mul_f32 v[112:113], v[112:113], v[58:59] op_sel_hi:[1,0]
  v_pk_mul_f32 v[66:67], v[66:67], v[48:49] op_sel_hi:[1,0]
  v_pk_mul_f32 v[82:83], v[82:83], v[56:57] op_sel_hi:[1,0]
  v_pk_mul_f32 v[98:99], v[98:99], v[50:51] op_sel_hi:[1,0]
  v_pk_mul_f32 v[114:115], v[114:115], v[58:59] op_sel_hi:[1,0]
  v_pk_mul_f32 v[68:69], v[68:69], v[48:49] op_sel_hi:[1,0]
  v_pk_mul_f32 v[84:85], v[84:85], v[56:57] op_sel_hi:[1,0]
  v_pk_mul_f32 v[100:101], v[100:101], v[50:51] op_sel_hi:[1,0]
  v_pk_mul_f32 v[116:117], v[116:117], v[58:59] op_sel_hi:[1,0]
  v_pk_mul_f32 v[70:71], v[70:71], v[48:49] op_sel_hi:[1,0]
  v_pk_mul_f32 v[86:87], v[86:87], v[56:57] op_sel_hi:[1,0]
  v_pk_mul_f32 v[102:103], v[102:103], v[50:51] op_sel_hi:[1,0]
  v_pk_mul_f32 v[118:119], v[118:119], v[58:59] op_sel_hi:[1,0]
  v_pk_mul_f32 v[72:73], v[72:73], v[48:49] op_sel_hi:[1,0]
  v_pk_mul_f32 v[88:89], v[88:89], v[56:57] op_sel_hi:[1,0]
  v_pk_mul_f32 v[104:105], v[104:105], v[50:51] op_sel_hi:[1,0]
  v_pk_mul_f32 v[120:121], v[120:121], v[58:59] op_sel_hi:[1,0]
  v_pk_mul_f32 v[74:75], v[74:75], v[48:49] op_sel_hi:[1,0]
  v_pk_mul_f32 v[90:91], v[90:91], v[56:57] op_sel_hi:[1,0]
  v_pk_mul_f32 v[106:107], v[106:107], v[50:51] op_sel_hi:[1,0]
  v_pk_mul_f32 v[122:123], v[122:123], v[58:59] op_sel_hi:[1,0]
  v_pk_mul_f32 v[76:77], v[76:77], v[48:49] op_sel_hi:[1,0]
  v_pk_mul_f32 v[92:93], v[92:93], v[56:57] op_sel_hi:[1,0]
  v_pk_mul_f32 v[108:109], v[108:109], v[50:51] op_sel_hi:[1,0]
  v_pk_mul_f32 v[124:125], v[124:125], v[58:59] op_sel_hi:[1,0]
  v_pk_mul_f32 v[78:79], v[78:79], v[48:49] op_sel_hi:[1,0]
  v_pk_mul_f32 v[94:95], v[94:95], v[56:57] op_sel_hi:[1,0]
  v_pk_mul_f32 v[110:111], v[110:111], v[50:51] op_sel_hi:[1,0]
  v_pk_mul_f32 v[126:127], v[126:127], v[58:59] op_sel_hi:[1,0]
  v_mfma_f32_16x16x32_bf16 a[28:31], a[172:175], a[124:127], a[28:31]
  v_cvt_pk_bf16_f32 v64, v64, v65
  v_cvt_pk_bf16_f32 v80, v80, v81
  v_cvt_pk_bf16_f32 v65, v66, v67
  s_waitcnt lgkmcnt(4)
  v_mfma_f32_16x16x32_bf16 a[40:43], a[176:179], a[96:99], a[40:43]
  ds_read_b64_tr_b16 a[160:161], v6 offset:32928
  v_cvt_pk_bf16_f32 v81, v82, v83
  v_cvt_pk_bf16_f32 v66, v68, v69
  v_cvt_pk_bf16_f32 v82, v84, v85
  v_mfma_f32_16x16x32_bf16 a[40:43], a[180:183], a[112:115], a[40:43]
  v_cvt_pk_bf16_f32 v67, v70, v71
  v_cvt_pk_bf16_f32 v83, v86, v87
  v_cvt_pk_bf16_f32 v68, v72, v73
  v_cvt_pk_bf16_f32 v84, v88, v89
  v_mfma_f32_16x16x32_bf16 a[44:47], a[176:179], a[100:103], a[44:47]
  ds_read_b64_tr_b16 a[162:163], v6 offset:33952
  v_cvt_pk_bf16_f32 v69, v74, v75
  v_cvt_pk_bf16_f32 v85, v90, v91
  v_cvt_pk_bf16_f32 v70, v76, v77
  v_mfma_f32_16x16x32_bf16 a[44:47], a[180:183], a[116:119], a[44:47]
  v_cvt_pk_bf16_f32 v86, v92, v93
  v_cvt_pk_bf16_f32 v71, v78, v79
  v_cvt_pk_bf16_f32 v87, v94, v95
  v_cvt_pk_bf16_f32 v72, v96, v97
  v_mfma_f32_16x16x32_bf16 a[56:59], a[176:179], a[104:107], a[56:59]
  ds_read_b64_tr_b16 a[164:165], v6 offset:41120
  v_cvt_pk_bf16_f32 v88, v112, v113
  v_cvt_pk_bf16_f32 v73, v98, v99
  v_cvt_pk_bf16_f32 v89, v114, v115
  v_mfma_f32_16x16x32_bf16 a[56:59], a[180:183], a[120:123], a[56:59]
  v_cvt_pk_bf16_f32 v74, v100, v101
  v_cvt_pk_bf16_f32 v90, v116, v117
  v_cvt_pk_bf16_f32 v75, v102, v103
  v_cvt_pk_bf16_f32 v91, v118, v119
  v_mfma_f32_16x16x32_bf16 a[60:63], a[176:179], a[108:111], a[60:63]
  ds_read_b64_tr_b16 a[166:167], v6 offset:42144
  v_cvt_pk_bf16_f32 v76, v104, v105
  v_cvt_pk_bf16_f32 v92, v120, v121
  v_cvt_pk_bf16_f32 v77, v106, v107
  v_mfma_f32_16x16x32_bf16 a[60:63], a[180:183], a[124:127], a[60:63]
  v_cvt_pk_bf16_f32 v93, v122, v123
  v_cvt_pk_bf16_f32 v78, v108, v109
  v_cvt_pk_bf16_f32 v94, v124, v125
  s_waitcnt lgkmcnt(4)
  v_mfma_f32_16x16x32_bf16 a[72:75], a[184:187], a[96:99], a[72:75]
  ds_read_b64_tr_b16 a[168:169], v6 offset:32960
  v_cvt_pk_bf16_f32 v79, v110, v111
  v_cvt_pk_bf16_f32 v95, v126, v127
  ds_write_b64 v10, v[64:65] offset:0
  v_mfma_f32_16x16x32_bf16 a[72:75], a[188:191], a[112:115], a[72:75]
  ds_write_b64 v10, v[66:67] offset:16
  ds_write_b64 v10, v[68:69] offset:32
  ds_write_b64 v10, v[70:71] offset:48
  ds_write_b64 v10, v[72:73] offset:64
  v_mfma_f32_16x16x32_bf16 a[76:79], a[184:187], a[100:103], a[76:79]
  ds_read_b64_tr_b16 a[170:171], v6 offset:33984
  ds_write_b64 v10, v[74:75] offset:80
  ds_write_b64 v10, v[76:77] offset:96
  ds_write_b64 v10, v[78:79] offset:112
  v_mfma_f32_16x16x32_bf16 a[76:79], a[188:191], a[116:119], a[76:79]
  ds_write_b64 v10, v[80:81] offset:4352
  ds_write_b64 v10, v[82:83] offset:4368
  ds_write_b64 v10, v[84:85] offset:4384
  ds_write_b64 v10, v[86:87] offset:4400
  v_mfma_f32_16x16x32_bf16 a[88:91], a[184:187], a[104:107], a[88:91]
  ds_read_b64_tr_b16 a[172:173], v6 offset:41152
  ds_write_b64 v10, v[88:89] offset:4416
  ds_write_b64 v10, v[90:91] offset:4432
  ds_write_b64 v10, v[92:93] offset:4448
  v_mfma_f32_16x16x32_bf16 a[88:91], a[188:191], a[120:123], a[88:91]
  ds_write_b64 v10, v[94:95] offset:4464
  s_waitcnt lgkmcnt(0)
  s_barrier
  v_lshlrev_b32 v10, 3, v1
  buffer_load_dwordx2 v[26:27], v10, s[24:27], s57 offen sc1
  ds_read_b64_tr_b16 a[208:209], v12 offset:0
  v_mfma_f32_16x16x32_bf16 a[92:95], a[184:187], a[108:111], a[92:95]
  ds_read_b64_tr_b16 a[174:175], v6 offset:42176
  ds_read_b64_tr_b16 a[210:211], v12 offset:2176
  ds_read_b128 a[212:215], v13 offset:0
  ds_read_b128 a[216:219], v13 offset:1024
  v_mfma_f32_16x16x32_bf16 a[92:95], a[188:191], a[124:127], a[92:95]
  ds_read_b64_tr_b16 a[220:221], v12 offset:4352
  ds_read_b64_tr_b16 a[222:223], v12 offset:6528
  ds_read_b128 a[224:227], v13 offset:2048
  s_waitcnt vmcnt(13)
  s_barrier
  v_mfma_f32_16x16x32_bf16 v[200:203], a[160:163], a[96:99], v[200:203]
  ds_read_b64_tr_b16 a[176:177], v7 offset:16384
  ds_read_b128 a[228:231], v13 offset:3072
  s_waitcnt lgkmcnt(5)
  v_mfma_f32_16x16x32_bf16 a[244:247], a[208:211], a[212:215], 0
  v_mfma_f32_16x16x32_bf16 v[200:203], a[164:167], a[112:115], v[200:203]
  s_add_u32 m0, s38, 16384
  v_mfma_f32_16x16x32_bf16 a[248:251], a[208:211], a[216:219], 0
  v_mfma_f32_16x16x32_bf16 a[252:255], a[208:211], v[28:31], 0
  v_mfma_f32_16x16x32_bf16 v[204:207], a[160:163], a[100:103], v[204:207]
  ds_read_b64_tr_b16 a[178:179], v7 offset:17408
  buffer_load_dwordx4 v3, s[12:15], s36 offen lds
  ds_read_b64_tr_b16 a[232:233], v12 offset:8704
  ds_read_b64_tr_b16 a[234:235], v12 offset:10880
  v_mfma_f32_16x16x32_bf16 v[204:207], a[164:167], a[116:119], v[204:207]
  s_add_u32 s36, s36, 114688
  ds_read_b128 a[236:239], v13 offset:4096
  ds_read_b128 a[240:243], v13 offset:5120
  s_waitcnt lgkmcnt(5)
  v_mfma_f32_16x16x32_bf16 a[244:247], a[220:223], a[224:227], a[244:247]
  v_mfma_f32_16x16x32_bf16 v[216:219], a[160:163], a[104:107], v[216:219]
  ds_read_b64_tr_b16 a[180:181], v7 offset:24576
  v_mfma_f32_16x16x32_bf16 a[248:251], a[220:223], a[228:231], a[248:251]
  v_mfma_f32_16x16x32_bf16 a[252:255], a[220:223], v[28:31], a[252:255]
  v_mfma_f32_16x16x32_bf16 v[216:219], a[164:167], a[120:123], v[216:219]
  s_add_u32 m0, s38, 20480
  ds_read_b64_tr_b16 a[208:209], v12 offset:13056
  ds_read_b64_tr_b16 a[210:211], v12 offset:15232
  ds_read_b128 a[212:215], v13 offset:6144
  v_mfma_f32_16x16x32_bf16 v[220:223], a[160:163], a[108:111], v[220:223]
  ds_read_b64_tr_b16 a[182:183], v7 offset:25600
  buffer_load_dwordx4 v3, s[12:15], s36 offen lds
  ds_read_b128 a[216:219], v13 offset:7168
  s_waitcnt lgkmcnt(6)
  v_mfma_f32_16x16x32_bf16 a[244:247], a[232:235], a[236:239], a[244:247]
  v_mfma_f32_16x16x32_bf16 v[220:223], a[164:167], a[124:127], v[220:223]
  s_add_u32 s36, s36, 114688
  v_mfma_f32_16x16x32_bf16 a[248:251], a[232:235], a[240:243], a[248:251]
  v_mfma_f32_16x16x32_bf16 v[232:235], a[168:171], a[96:99], v[232:235]
  ds_read_b64_tr_b16 a[184:185], v7 offset:16416
  v_mfma_f32_16x16x32_bf16 a[252:255], a[232:235], v[28:31], a[252:255]
  ds_read_b64_tr_b16 a[220:221], v12 offset:17408
  v_mfma_f32_16x16x32_bf16 v[232:235], a[172:175], a[112:115], v[232:235]
  s_add_u32 m0, s38, 24576
  ds_read_b64_tr_b16 a[222:223], v12 offset:19584
  ds_read_b128 a[224:227], v13 offset:8192
  ds_read_b128 a[228:231], v13 offset:9216
  v_mfma_f32_16x16x32_bf16 v[236:239], a[168:171], a[100:103], v[236:239]
  ds_read_b64_tr_b16 a[186:187], v7 offset:17440
  buffer_load_dwordx4 v3, s[12:15], s36 offen lds
  s_waitcnt lgkmcnt(6)
  v_mfma_f32_16x16x32_bf16 a[244:247], a[208:211], a[212:215], a[244:247]
  v_mfma_f32_16x16x32_bf16 v[236:239], a[172:175], a[116:119], v[236:239]
  s_add_u32 s36, s36, 114688
  v_mfma_f32_16x16x32_bf16 a[248:251], a[208:211], a[216:219], a[248:251]
  v_mfma_f32_16x16x32_bf16 a[252:255], a[208:211], v[28:31], a[252:255]
  v_mfma_f32_16x16x32_bf16 v[248:251], a[168:171], a[104:107], v[248:251]
  ds_read_b64_tr_b16 a[188:189], v7 offset:24608
  ds_read_b64_tr_b16 a[232:233], v12 offset:21760
  ds_read_b64_tr_b16 a[234:235], v12 offset:23936
  ds_read_b128 a[236:239], v13 offset:10240
  v_mfma_f32_16x16x32_bf16 v[248:251], a[172:175], a[120:123], v[248:251]
  s_add_u32 m0, s38, 28672
  ds_read_b128 a[240:243], v13 offset:11264
  s_waitcnt lgkmcnt(6)
  v_mfma_f32_16x16x32_bf16 a[244:247], a[220:223], a[224:227], a[244:247]
  v_mfma_f32_16x16x32_bf16 v[252:255], a[168:171], a[108:111], v[252:255]
  ds_read_b64_tr_b16 a[190:191], v7 offset:25632
  buffer_load_dwordx4 v3, s[12:15], s36 offen lds
  v_mfma_f32_16x16x32_bf16 a[248:251], a[220:223], a[228:231], a[248:251]
  v_mfma_f32_16x16x32_bf16 v[252:255], a[172:175], a[124:127], v[252:255]
  s_add_u32 s36, s36, 114688
  v_mfma_f32_16x16x32_bf16 a[252:255], a[220:223], v[28:31], a[252:255]
  v_mfma_f32_16x16x32_bf16 v[128:131], a[176:179], a[128:131], v[128:131]
  ds_read_b64_tr_b16 a[160:161], v7 offset:16448
  ds_read_b64_tr_b16 a[208:209], v12 offset:26112
  ds_read_b64_tr_b16 a[210:211], v12 offset:28288
  ds_read_b128 a[212:215], v13 offset:12288
  v_mfma_f32_16x16x32_bf16 v[128:131], a[180:183], a[144:147], v[128:131]
  buffer_load_dwordx4 a[96:99], v4, s[20:23], s39 offen offset:0 sc1
  ds_read_b128 a[216:219], v13 offset:13312
  s_waitcnt lgkmcnt(6)
  v_mfma_f32_16x16x32_bf16 a[244:247], a[232:235], a[236:239], a[244:247]
  v_mfma_f32_16x16x32_bf16 v[132:135], a[176:179], a[132:135], v[132:135]
  ds_read_b64_tr_b16 a[162:163], v7 offset:17472
  v_mfma_f32_16x16x32_bf16 a[248:251], a[232:235], a[240:243], a[248:251]
  v_mfma_f32_16x16x32_bf16 a[252:255], a[232:235], v[28:31], a[252:255]
  v_mfma_f32_16x16x32_bf16 v[132:135], a[180:183], a[148:151], v[132:135]
  ds_read_b64_tr_b16 a[220:221], v12 offset:30464
  ds_read_b64_tr_b16 a[222:223], v12 offset:32640
  ds_read_b128 a[224:227], v13 offset:14336
  ds_read_b128 a[228:231], v13 offset:15360
  v_mfma_f32_16x16x32_bf16 v[144:147], a[176:179], a[136:139], v[144:147]
  ds_read_b64_tr_b16 a[164:165], v7 offset:24640
  s_waitcnt lgkmcnt(6)
  v_mfma_f32_16x16x32_bf16 a[244:247], a[208:211], a[212:215], a[244:247]
  v_mfma_f32_16x16x32_bf16 a[248:251], a[208:211], a[216:219], a[248:251]
  v_mfma_f32_16x16x32_bf16 v[144:147], a[180:183], a[152:155], v[144:147]
  buffer_load_dwordx4 a[100:103], v4, s[20:23], s39 offen offset:1024 sc1
  v_mfma_f32_16x16x32_bf16 a[252:255], a[208:211], v[28:31], a[252:255]
  s_waitcnt lgkmcnt(1)
  v_mfma_f32_16x16x32_bf16 a[244:247], a[220:223], a[224:227], a[244:247]
  v_mfma_f32_16x16x32_bf16 v[148:151], a[176:179], a[140:143], v[148:151]
  ds_read_b64_tr_b16 a[166:167], v7 offset:25664
  v_mfma_f32_16x16x32_bf16 a[248:251], a[220:223], a[228:231], a[248:251]
  v_mfma_f32_16x16x32_bf16 a[252:255], a[220:223], v[28:31], a[252:255]
  v_mfma_f32_16x16x32_bf16 v[148:151], a[180:183], a[156:159], v[148:151]
  s_nop 0
  s_nop 0
  s_nop 0
  v_mfma_f32_16x16x32_bf16 v[160:163], a[184:187], a[128:131], v[160:163]
  ds_read_b64_tr_b16 a[168:169], v7 offset:16480
  s_nop 0
  s_nop 0
  s_nop 0
  v_mfma_f32_16x16x32_bf16 v[160:163], a[188:191], a[144:147], v[160:163]
  buffer_load_dwordx4 a[104:107], v4, s[20:23], s39 offen offset:2048 sc1
  buffer_store_dwordx4 a[244:247], v14, s[24:27], s49 offen sc1
  buffer_store_dwordx4 a[248:251], v14, s[24:27], s49 offen offset:256 sc1
  buffer_store_dwordx4 a[252:255], v15, s[24:27], s55 offen sc1
  v_mfma_f32_16x16x32_bf16 v[164:167], a[184:187], a[132:135], v[164:167]
  ds_read_b64_tr_b16 a[170:171], v7 offset:17504
  v_mfma_f32_32x32x16_bf16 v[64:79], a[200:203], v[32:35], 0
  v_mfma_f32_32x32x16_bf16 v[80:95], a[200:203], v[40:43], 0
  v_mfma_f32_16x16x32_bf16 v[164:167], a[188:191], a[148:151], v[164:167]
  v_mfma_f32_32x32x16_bf16 v[64:79], a[204:207], v[36:39], v[64:79]
  v_mfma_f32_32x32x16_bf16 v[80:95], a[204:207], v[44:47], v[80:95]
  v_mfma_f32_16x16x32_bf16 v[176:179], a[184:187], a[136:139], v[176:179]
  ds_read_b64_tr_b16 a[172:173], v7 offset:24672
  s_waitcnt vmcnt(10)
  s_mov_b32 s65, 0
L_gb_wf:
  v_cmp_ne_u64 vcc, v[26:27], v[24:25]
  s_add_u32 s65, s65, 1
  s_cmp_eq_u64 vcc, 0
  s_cbranch_scc1 L_gb_wfok
  s_sleep 4
  buffer_load_dwordx2 v[26:27], v10, s[24:27], s57 offen sc1
  s_waitcnt vmcnt(0)
  s_cmp_lt_u32 s65, 0x200000
  s_cbranch_scc1 L_gb_wf
L_gb_wfok:
  v_mfma_f32_16x16x32_bf16 v[176:179], a[188:191], a[152:155], v[176:179]
  buffer_load_dwordx4 a[108:111], v4, s[20:23], s39 offen offset:3072 sc1
  s_add_u32 s39, s39, 0x20000
  v_cvt_pk_bf16_f32 v64, 0, v64
  v_cvt_pk_bf16_f32 v80, 0, v80
  v_mfma_f32_16x16x32_bf16 v[180:183], a[184:187], a[140:143], v[180:183]
  ds_read_b64_tr_b16 a[174:175], v7 offset:25696
  v_cvt_pk_bf16_f32 v65, 0, v65
  v_cvt_pk_bf16_f32 v81, 0, v81
  v_cvt_pk_bf16_f32 v66, 0, v66
  v_mfma_f32_16x16x32_bf16 v[180:183], a[188:191], a[156:159], v[180:183]
  v_cvt_pk_bf16_f32 v82, 0, v82
  v_cvt_pk_bf16_f32 v67, 0, v67
  v_cvt_pk_bf16_f32 v83, 0, v83
  s_waitcnt lgkmcnt(4)
  v_mfma_f32_16x16x32_bf16 a[0:3], a[160:163], a[128:131], a[0:3]
  ds_read_b64_tr_b16 a[176:177], v7 offset:16512
  v_cvt_pk_bf16_f32 v68, 0, v68
  v_cvt_pk_bf16_f32 v84, 0, v84
  v_cvt_pk_bf16_f32 v69, 0, v69
  v_mfma_f32_16x16x32_bf16 a[0:3], a[164:167], a[144:147], a[0:3]
  buffer_load_dwordx4 a[112:115], v4, s[20:23], s39 offen offset:0 sc1
  v_cvt_pk_bf16_f32 v85, 0, v85
  v_cvt_pk_bf16_f32 v70, 0, v70
  v_cvt_pk_bf16_f32 v86, 0, v86
  v_mfma_f32_16x16x32_bf16 a[4:7], a[160:163], a[132:135], a[4:7]
  ds_read_b64_tr_b16 a[178:179], v7 offset:17536
  v_cvt_pk_bf16_f32 v71, 0, v71
  v_cvt_pk_bf16_f32 v87, 0, v87
  v_cvt_pk_bf16_f32 v72, 0, v72
  v_mfma_f32_16x16x32_bf16 a[4:7], a[164:167], a[148:151], a[4:7]
  v_cvt_pk_bf16_f32 v88, 0, v88
  v_cvt_pk_bf16_f32 v73, 0, v73
  v_cvt_pk_bf16_f32 v89, 0, v89
  v_cvt_pk_bf16_f32 v74, 0, v74
  v_mfma_f32_16x16x32_bf16 a[16:19], a[160:163], a[136:139], a[16:19]
  ds_read_b64_tr_b16 a[180:181], v7 offset:24704
  v_cvt_pk_bf16_f32 v90, 0, v90
  v_cvt_pk_bf16_f32 v75, 0, v75
  v_cvt_pk_bf16_f32 v91, 0, v91
  v_mfma_f32_16x16x32_bf16 a[16:19], a[164:167], a[152:155], a[16:19]
  buffer_load_dwordx4 a[116:119], v4, s[20:23], s39 offen offset:1024 sc1
  v_cvt_pk_bf16_f32 v76, 0, v76
  v_cvt_pk_bf16_f32 v92, 0, v92
  v_cvt_pk_bf16_f32 v77, 0, v77
  v_mfma_f32_16x16x32_bf16 a[20:23], a[160:163], a[140:143], a[20:23]
  ds_read_b64_tr_b16 a[182:183], v7 offset:25728
  v_cvt_pk_bf16_f32 v93, 0, v93
  v_cvt_pk_bf16_f32 v78, 0, v78
  v_cvt_pk_bf16_f32 v94, 0, v94
  v_mfma_f32_16x16x32_bf16 a[20:23], a[164:167], a[156:159], a[20:23]
  v_cvt_pk_bf16_f32 v79, 0, v79
  v_cvt_pk_bf16_f32 v95, 0, v95
  v_max3_f32 v48, v64, v65, v66
  s_waitcnt lgkmcnt(4)
  v_mfma_f32_16x16x32_bf16 a[32:35], a[168:171], a[128:131], a[32:35]
  ds_read_b64_tr_b16 a[184:185], v7 offset:16544
  v_max3_f32 v56, v80, v81, v82
  v_min3_f32 v50, v64, v65, v66
  v_min3_f32 v58, v80, v81, v82
  v_mfma_f32_16x16x32_bf16 a[32:35], a[172:175], a[144:147], a[32:35]
  buffer_load_dwordx4 a[120:123], v4, s[20:23], s39 offen offset:2048 sc1
  v_max3_f32 v48, v48, v67, v68
  v_max3_f32 v56, v56, v83, v84
  v_min3_f32 v50, v50, v67, v68
  v_mfma_f32_16x16x32_bf16 a[36:39], a[168:171], a[132:135], a[36:39]
  ds_read_b64_tr_b16 a[186:187], v7 offset:17568
  v_min3_f32 v58, v58, v83, v84
  v_max3_f32 v48, v48, v69, v70
  v_max3_f32 v56, v56, v85, v86
  v_mfma_f32_16x16x32_bf16 a[36:39], a[172:175], a[148:151], a[36:39]
  v_min3_f32 v50, v50, v69, v70
  v_min3_f32 v58, v58, v85, v86
  v_max3_f32 v48, v48, v71, v72
  v_max3_f32 v56, v56, v87, v88
  v_mfma_f32_16x16x32_bf16 a[48:51], a[168:171], a[136:139], a[48:51]
  ds_read_b64_tr_b16 a[188:189], v7 offset:24736
  v_min3_f32 v50, v50, v71, v72
  v_min3_f32 v58, v58, v87, v88
  v_max3_f32 v48, v48, v73, v74
  v_mfma_f32_16x16x32_bf16 a[48:51], a[172:175], a[152:155], a[48:51]
  buffer_load_dwordx4 a[124:127], v4, s[20:23], s39 offen offset:3072 sc1
  s_add_u32 s39, s39, 0x20000
  v_max3_f32 v56, v56, v89, v90
  v_min3_f32 v50, v50, v73, v74
  v_mfma_f32_16x16x32_bf16 a[52:55], a[168:171], a[140:143], a[52:55]
  ds_read_b64_tr_b16 a[190:191], v7 offset:25760
  v_min3_f32 v58, v58, v89, v90
  v_max3_f32 v48, v48, v75, v76
  v_max3_f32 v56, v56, v91, v92
  v_mfma_f32_16x16x32_bf16 a[52:55], a[172:175], a[156:159], a[52:55]
  v_min3_f32 v50, v50, v75, v76
  v_min3_f32 v58, v58, v91, v92
  v_max3_f32 v48, v48, v77, v78
  s_waitcnt lgkmcnt(4)
  v_mfma_f32_16x16x32_bf16 a[64:67], a[176:179], a[128:131], a[64:67]
  ds_read_b64_tr_b16 a[160:161], v7 offset:16576
  v_max3_f32 v56, v56, v93, v94
  v_min3_f32 v50, v50, v77, v78
  v_min3_f32 v58, v58, v93, v94
  v_mfma_f32_16x16x32_bf16 a[64:67], a[180:183], a[144:147], a[64:67]
  buffer_load_dwordx4 a[208:211], v4, s[20:23], s39 offen offset:0 sc1
  v_max_f32 v48, v48, v79
  v_max_f32 v56, v56, v95
  v_min_f32 v50, v50, v79
  v_mfma_f32_16x16x32_bf16 a[68:71], a[176:179], a[132:135], a[68:71]
  ds_read_b64_tr_b16 a[162:163], v7 offset:17600
  v_min_f32 v58, v58, v95
  v_mov_b32 v52, v48
  v_mov_b32 v60, v56
  v_mfma_f32_16x16x32_bf16 a[68:71], a[180:183], a[148:151], a[68:71]
  v_mov_b32 v53, v50
  v_mov_b32 v61, v58
  v_permlane32_swap_b32 v48, v52
  v_permlane32_swap_b32 v56, v60
  v_mfma_f32_16x16x32_bf16 a[80:83], a[176:179], a[136:139], a[80:83]
  ds_read_b64_tr_b16 a[164:165], v7 offset:24768
  v_permlane32_swap_b32 v50, v53
  v_permlane32_swap_b32 v58, v61
  v_max_f32 v48, v48, v52
  v_mfma_f32_16x16x32_bf16 a[80:83], a[180:183], a[152:155], a[80:83]
  buffer_load_dwordx4 a[212:215], v4, s[20:23], s39 offen offset:1024 sc1
  v_max_f32 v56, v56, v60
  v_min_f32 v50, v50, v53
  v_min_f32 v58, v58, v61
  v_mfma_f32_16x16x32_bf16 a[84:87], a[176:179], a[140:143], a[84:87]
  ds_read_b64_tr_b16 a[166:167], v7 offset:25792
  v_mul_f32 v48, s50, v48
  v_mul_f32 v56, s50, v56
  v_mul_f32 v50, s50, v50
  v_mfma_f32_16x16x32_bf16 a[84:87], a[180:183], a[156:159], a[84:87]
  v_mul_f32 v58, s50, v58
  v_pk_fma_f32 v[96:97], v[64:65], s[50:51], v[50:51] op_sel_hi:[1,1,0] neg_lo:[1,0,0] neg_hi:[1,0,0]
  v_pk_fma_f32 v[112:113], v[80:81], s[50:51], v[58:59] op_sel_hi:[1,1,0] neg_lo:[1,0,0] neg_hi:[1,0,0]
  v_pk_fma_f32 v[64:65], v[64:65], s[50:51], v[48:49] op_sel_hi:[1,1,0] neg_lo:[0,0,1] neg_hi:[0,0,1]
  v_pk_fma_f32 v[80:81], v[80:81], s[50:51], v[56:57] op_sel_hi:[1,1,0] neg_lo:[0,0,1] neg_hi:[0,0,1]
  v_pk_fma_f32 v[98:99], v[66:67], s[50:51], v[50:51] op_sel_hi:[1,1,0] neg_lo:[1,0,0] neg_hi:[1,0,0]
  v_pk_fma_f32 v[114:115], v[82:83], s[50:51], v[58:59] op_sel_hi:[1,1,0] neg_lo:[1,0,0] neg_hi:[1,0,0]
  v_pk_fma_f32 v[66:67], v[66:67], s[50:51], v[48:49] op_sel_hi:[1,1,0] neg_lo:[0,0,1] neg_hi:[0,0,1]
  v_pk_fma_f32 v[82:83], v[82:83], s[50:51], v[56:57] op_sel_hi:[1,1,0] neg_lo:[0,0,1] neg_hi:[0,0,1]
  v_pk_fma_f32 v[100:101], v[68:69], s[50:51], v[50:51] op_sel_hi:[1,1,0] neg_lo:[1,0,0] neg_hi:[1,0,0]
  v_pk_fma_f32 v[116:117], v[84:85], s[50:51], v[58:59] op_sel_hi:[1,1,0] neg_lo:[1,0,0] neg_hi:[1,0,0]
  v_pk_fma_f32 v[68:69], v[68:69], s[50:51], v[48:49] op_sel_hi:[1,1,0] neg_lo:[0,0,1] neg_hi:[0,0,1]
  v_pk_fma_f32 v[84:85], v[84:85], s[50:51], v[56:57] op_sel_hi:[1,1,0] neg_lo:[0,0,1] neg_hi:[0,0,1]
  v_pk_fma_f32 v[102:103], v[70:71], s[50:51], v[50:51] op_sel_hi:[1,1,0] neg_lo:[1,0,0] neg_hi:[1,0,0]
  v_pk_fma_f32 v[118:119], v[86:87], s[50:51], v[58:59] op_sel_hi:[1,1,0] neg_lo:[1,0,0] neg_hi:[1,0,0]
  v_pk_fma_f32 v[70:71], v[70:71], s[50:51], v[48:49] op_sel_hi:[1,1,0] neg_lo:[0,0,1] neg_hi:[0,0,1]
  v_pk_fma_f32 v[86:87], v[86:87], s[50:51], v[56:57] op_sel_hi:[1,1,0] neg_lo:[0,0,1] neg_hi:[0,0,1]
  v_pk_fma_f32 v[104:105], v[72:73], s[50:51], v[50:51] op_sel_hi:[1,1,0] neg_lo:[1,0,0] neg_hi:[1,0,0]
  v_pk_fma_f32 v[120:121], v[88:89], s[50:51], v[58:59] op_sel_hi:[1,1,0] neg_lo:[1,0,0] neg_hi:[1,0,0]
  v_pk_fma_f32 v[72:73], v[72:73], s[50:51], v[48:49] op_sel_hi:[1,1,0] neg_lo:[0,0,1] neg_hi:[0,0,1]
  v_pk_fma_f32 v[88:89], v[88:89], s[50:51], v[56:57] op_sel_hi:[1,1,0] neg_lo:[0,0,1] neg_hi:[0,0,1]
  v_pk_fma_f32 v[106:107], v[74:75], s[50:51], v[50:51] op_sel_hi:[1,1,0] neg_lo:[1,0,0] neg_hi:[1,0,0]
  v_pk_fma_f32 v[122:123], v[90:91], s[50:51], v[58:59] op_sel_hi:[1,1,0] neg_lo:[1,0,0] neg_hi:[1,0,0]
  v_pk_fma_f32 v[74:75], v[74:75], s[50:51], v[48:49] op_sel_hi:[1,1,0] neg_lo:[0,0,1] neg_hi:[0,0,1]
  v_pk_fma_f32 v[90:91], v[90:91], s[50:51], v[56:57] op_sel_hi:[1,1,0] neg_lo:[0,0,1] neg_hi:[0,0,1]
  v_pk_fma_f32 v[108:109], v[76:77], s[50:51], v[50:51] op_sel_hi:[1,1,0] neg_lo:[1,0,0] neg_hi:[1,0,0]
  v_pk_fma_f32 v[124:125], v[92:93], s[50:51], v[58:59] op_sel_hi:[1,1,0] neg_lo:[1,0,0] neg_hi:[1,0,0]
  v_pk_fma_f32 v[76:77], v[76:77], s[50:51], v[48:49] op_sel_hi:[1,1,0] neg_lo:[0,0,1] neg_hi:[0,0,1]
  v_pk_fma_f32 v[92:93], v[92:93], s[50:51], v[56:57] op_sel_hi:[1,1,0] neg_lo:[0,0,1] neg_hi:[0,0,1]
  v_pk_fma_f32 v[110:111], v[78:79], s[50:51], v[50:51] op_sel_hi:[1,1,0] neg_lo:[1,0,0] neg_hi:[1,0,0]
  v_pk_fma_f32 v[126:127], v[94:95], s[50:51], v[58:59] op_sel_hi:[1,1,0] neg_lo:[1,0,0] neg_hi:[1,0,0]
  v_pk_fma_f32 v[78:79], v[78:79], s[50:51], v[48:49] op_sel_hi:[1,1,0] neg_lo:[0,0,1] neg_hi:[0,0,1]
  v_pk_fma_f32 v[94:95], v[94:95], s[50:51], v[56:57] op_sel_hi:[1,1,0] neg_lo:[0,0,1] neg_hi:[0,0,1]
  s_barrier
  s_waitcnt lgkmcnt(4)
  v_mfma_f32_16x16x32_bf16 v[192:195], a[184:187], a[128:131], v[192:195]
  ds_read_b64_tr_b16 a[168:169], v7 offset:0
  v_exp_f32 v64, v64
  v_exp_f32 v80, v80
  v_mfma_f32_16x16x32_bf16 v[192:195], a[188:191], a[144:147], v[192:195]
  buffer_load_dwordx4 a[216:219], v4, s[20:23], s39 offen offset:2048 sc1
  v_exp_f32 v96, v96
  v_exp_f32 v112, v112
  v_mfma_f32_16x16x32_bf16 v[196:199], a[184:187], a[132:135], v[196:199]
  ds_read_b64_tr_b16 a[170:171], v7 offset:1024
  v_exp_f32 v65, v65
  v_exp_f32 v81, v81
  v_mfma_f32_16x16x32_bf16 v[196:199], a[188:191], a[148:151], v[196:199]
  v_exp_f32 v97, v97
  v_exp_f32 v113, v113
  v_mfma_f32_16x16x32_bf16 v[208:211], a[184:187], a[136:139], v[208:211]
  ds_read_b64_tr_b16 a[172:173], v7 offset:8192
  v_exp_f32 v66, v66
  v_exp_f32 v82, v82
  v_mfma_f32_16x16x32_bf16 v[208:211], a[188:191], a[152:155], v[208:211]
  buffer_load_dwordx4 a[220:223], v4, s[20:23], s39 offen offset:3072 sc1
  s_add_u32 s39, s39, 0x20000
  v_exp_f32 v98, v98
  v_mfma_f32_16x16x32_bf16 v[212:215], a[184:187], a[140:143], v[212:215]
  ds_read_b64_tr_b16 a[174:175], v7 offset:9216
  v_exp_f32 v114, v114
  v_exp_f32 v67, v67
  v_mfma_f32_16x16x32_bf16 v[212:215], a[188:191], a[156:159], v[212:215]
  v_exp_f32 v83, v83
  v_exp_f32 v99, v99
  s_waitcnt lgkmcnt(4)
  v_mfma_f32_16x16x32_bf16 v[224:227], a[160:163], a[128:131], v[224:227]
  ds_read_b64_tr_b16 a[176:177], v7 offset:32
  v_exp_f32 v115, v115
  s_waitcnt vmcnt(9)
  buffer_store_dwordx2 v[24:25], v20, s[24:27], s55 offen offset:64 sc1
  v_mfma_f32_16x16x32_bf16 v[224:227], a[164:167], a[144:147], v[224:227]
  buffer_load_dwordx4 a[224:227], v4, s[20:23], s39 offen offset:0 sc1
  v_bfe_u32 v14, v1, 4, 1
  v_lshrrev_b32 v13, 5, v1
  v_lshl_add_u32 v14, v14, 1, v13
  v_mfma_f32_16x16x32_bf16 v[228:231], a[160:163], a[132:135], v[228:231]
  ds_read_b64_tr_b16 a[178:179], v7 offset:1056
  v_and_b32 v13, 15, v1
  v_lshlrev_b32 v13, 4, v13
  v_lshl_add_u32 v14, v14, 8, v13
  v_mfma_f32_16x16x32_bf16 v[228:231], a[164:167], a[148:151], v[228:231]
  s_lshl_b32 s28, s33, 2
  s_add_u32 s28, s28, s66
  s_lshl_b32 s28, s28, 17
  s_lshl_b32 s29, s34, 14
  v_mfma_f32_16x16x32_bf16 v[240:243], a[160:163], a[136:139], v[240:243]
  ds_read_b64_tr_b16 a[180:181], v7 offset:8224
  s_add_u32 s28, s28, s29
  s_add_u32 s28, s28, s56
  s_add_u32 s28, s28, 0x2f00000
  v_mfma_f32_16x16x32_bf16 v[240:243], a[164:167], a[152:155], v[240:243]
  buffer_load_dwordx4 a[228:231], v4, s[20:23], s39 offen offset:1024 sc1
  buffer_load_dwordx4 a[192:195], v14, s[24:27], s28 offen offset:0 sc1
  buffer_load_dwordx4 a[196:199], v14, s[24:27], s28 offen offset:1024 sc1
  buffer_load_dwordx4 a[200:203], v14, s[24:27], s28 offen offset:2048 sc1
  v_mfma_f32_16x16x32_bf16 v[244:247], a[160:163], a[140:143], v[244:247]
  ds_read_b64_tr_b16 a[182:183], v7 offset:9248
  buffer_load_dwordx4 a[204:207], v14, s[24:27], s28 offen offset:3072 sc1
  v_exp_f32 v68, v68
  v_mfma_f32_16x16x32_bf16 v[244:247], a[164:167], a[156:159], v[244:247]
  v_exp_f32 v84, v84
  v_exp_f32 v100, v100
  s_waitcnt lgkmcnt(4)
  v_mfma_f32_16x16x32_bf16 v[136:139], a[168:171], a[128:131], v[136:139]
  ds_read_b64_tr_b16 a[184:185], v7 offset:64
  v_exp_f32 v116, v116
  v_exp_f32 v69, v69
  v_mfma_f32_16x16x32_bf16 v[136:139], a[172:175], a[144:147], v[136:139]
  buffer_load_dwordx4 a[232:235], v4, s[20:23], s39 offen offset:2048 sc1
  v_exp_f32 v85, v85
  v_exp_f32 v101, v101
  v_mfma_f32_16x16x32_bf16 v[140:143], a[168:171], a[132:135], v[140:143]
  ds_read_b64_tr_b16 a[186:187], v7 offset:1088
  v_exp_f32 v117, v117
  v_exp_f32 v70, v70
  v_mfma_f32_16x16x32_bf16 v[140:143], a[172:175], a[148:151], v[140:143]
  v_exp_f32 v86, v86
  v_exp_f32 v102, v102
  v_mfma_f32_16x16x32_bf16 v[152:155], a[168:171], a[136:139], v[152:155]
  ds_read_b64_tr_b16 a[188:189], v7 offset:8256
  v_exp_f32 v118, v118
  v_exp_f32 v71, v71
  v_mfma_f32_16x16x32_bf16 v[152:155], a[172:175], a[152:155], v[152:155]
  buffer_load_dwordx4 a[236:239], v4, s[20:23], s39 offen offset:3072 sc1
  s_add_u32 s39, s39, 0x20000
  v_exp_f32 v87, v87
  v_mfma_f32_16x16x32_bf16 v[156:159], a[168:171], a[140:143], v[156:159]
  ds_read_b64_tr_b16 a[190:191], v7 offset:9280
  v_exp_f32 v103, v103
  v_exp_f32 v119, v119
  v_mfma_f32_16x16x32_bf16 v[156:159], a[172:175], a[156:159], v[156:159]
  v_exp_f32 v72, v72
  v_exp_f32 v88, v88
  s_waitcnt lgkmcnt(4)
  v_mfma_f32_16x16x32_bf16 v[168:171], a[176:179], a[128:131], v[168:171]
  ds_read_b64_tr_b16 a[160:161], v7 offset:96
  v_exp_f32 v104, v104
  v_exp_f32 v120, v120
  v_mfma_f32_16x16x32_bf16 v[168:171], a[180:183], a[144:147], v[168:171]
  s_add_u32 m0, s38, 32768
  v_exp_f32 v73, v73
  v_exp_f32 v89, v89
  v_mfma_f32_16x16x32_bf16 v[172:175], a[176:179], a[132:135], v[172:175]
  ds_read_b64_tr_b16 a[162:163], v7 offset:1120
  buffer_load_dwordx4 v3, s[16:19], s37 offen lds
  v_exp_f32 v105, v105
  v_mfma_f32_16x16x32_bf16 v[172:175], a[180:183], a[148:151], v[172:175]
  s_add_u32 s37, s37, 114688
  v_exp_f32 v121, v121
  v_exp_f32 v74, v74
  v_mfma_f32_16x16x32_bf16 v[184:187], a[176:179], a[136:139], v[184:187]
  ds_read_b64_tr_b16 a[164:165], v7 offset:8288
  v_exp_f32 v90, v90
  v_exp_f32 v106, v106
  v_mfma_f32_16x16x32_bf16 v[184:187], a[180:183], a[152:155], v[184:187]
  s_add_u32 m0, s38, 36864
  v_exp_f32 v122, v122
  v_exp_f32 v75, v75
  v_mfma_f32_16x16x32_bf16 v[188:191], a[176:179], a[140:143], v[188:191]
  ds_read_b64_tr_b16 a[166:167], v7 offset:9312
  buffer_load_dwordx4 v3, s[16:19], s37 offen lds
  v_exp_f32 v91, v91
  v_mfma_f32_16x16x32_bf16 v[188:191], a[180:183], a[156:159], v[188:191]
  s_add_u32 s37, s37, 114688
  v_exp_f32 v107, v107
  s_waitcnt lgkmcnt(4)
  v_mfma_f32_16x16x32_bf16 a[8:11], a[184:187], a[128:131], a[8:11]
  ds_read_b64_tr_b16 a[168:169], v7 offset:128
  v_exp_f32 v123, v123
  v_exp_f32 v76, v76
  v_mfma_f32_16x16x32_bf16 a[8:11], a[188:191], a[144:147], a[8:11]
  s_add_u32 m0, s38, 40960
  v_exp_f32 v92, v92
  v_exp_f32 v108, v108
  v_mfma_f32_16x16x32_bf16 a[12:15], a[184:187], a[132:135], a[12:15]
  ds_read_b64_tr_b16 a[170:171], v7 offset:1152
  buffer_load_dwordx4 v3, s[16:19], s37 offen lds
  v_exp_f32 v124, v124
  v_mfma_f32_16x16x32_bf16 a[12:15], a[188:191], a[148:151], a[12:15]
  s_add_u32 s37, s37, 114688
  v_exp_f32 v77, v77
  v_exp_f32 v93, v93
  v_mfma_f32_16x16x32_bf16 a[24:27], a[184:187], a[136:139], a[24:27]
  ds_read_b64_tr_b16 a[172:173], v7 offset:8320
  v_exp_f32 v109, v109
  v_exp_f32 v125, v125
  v_mfma_f32_16x16x32_bf16 a[24:27], a[188:191], a[152:155], a[24:27]
  s_add_u32 m0, s38, 45056
  v_exp_f32 v78, v78
  v_exp_f32 v94, v94
  v_mfma_f32_16x16x32_bf16 a[28:31], a[184:187], a[140:143], a[28:31]
  ds_read_b64_tr_b16 a[174:175], v7 offset:9344
  buffer_load_dwordx4 v3, s[16:19], s37 offen lds
  v_exp_f32 v110, v110
  v_mfma_f32_16x16x32_bf16 a[28:31], a[188:191], a[156:159], a[28:31]
  s_add_u32 s37, s37, 114688
  v_exp_f32 v126, v126
  s_waitcnt lgkmcnt(4)
  v_mfma_f32_16x16x32_bf16 a[40:43], a[160:163], a[128:131], a[40:43]
  ds_read_b64_tr_b16 a[176:177], v7 offset:160
  v_exp_f32 v79, v79
  v_exp_f32 v95, v95
  v_mfma_f32_16x16x32_bf16 a[40:43], a[164:167], a[144:147], a[40:43]
  s_add_u32 m0, s56, 100352
  v_exp_f32 v111, v111
  v_exp_f32 v127, v127
  v_mfma_f32_16x16x32_bf16 a[44:47], a[160:163], a[132:135], a[44:47]
  ds_read_b64_tr_b16 a[178:179], v7 offset:1184
  buffer_load_dwordx4 v2, s[60:63], s58 offen offset:0 sc1 lds
  v_pk_add_f32 v[48:49], v[64:65], v[66:67]
  v_pk_add_f32 v[56:57], v[80:81], v[82:83]
  v_pk_add_f32 v[50:51], v[96:97], v[98:99]
  v_pk_add_f32 v[58:59], v[112:113], v[114:115]
  v_pk_add_f32 v[48:49], v[48:49], v[68:69]
  v_pk_add_f32 v[56:57], v[56:57], v[84:85]
  v_pk_add_f32 v[50:51], v[50:51], v[100:101]
  v_pk_add_f32 v[58:59], v[58:59], v[116:117]
  v_pk_add_f32 v[48:49], v[48:49], v[70:71]
  v_pk_add_f32 v[56:57], v[56:57], v[86:87]
  v_pk_add_f32 v[50:51], v[50:51], v[102:103]
  v_pk_add_f32 v[58:59], v[58:59], v[118:119]
  v_pk_add_f32 v[48:49], v[48:49], v[72:73]
  v_pk_add_f32 v[56:57], v[56:57], v[88:89]
  v_pk_add_f32 v[50:51], v[50:51], v[104:105]
  v_pk_add_f32 v[58:59], v[58:59], v[120:121]
  v_pk_add_f32 v[48:49], v[48:49], v[74:75]
  v_pk_add_f32 v[56:57], v[56:57], v[90:91]
  v_pk_add_f32 v[50:51], v[50:51], v[106:107]
  v_pk_add_f32 v[58:59], v[58:59], v[122:123]
  v_pk_add_f32 v[48:49], v[48:49], v[76:77]
  v_pk_add_f32 v[56:57], v[56:57], v[92:93]
  v_pk_add_f32 v[50:51], v[50:51], v[108:109]
  v_pk_add_f32 v[58:59], v[58:59], v[124:125]
  v_pk_add_f32 v[48:49], v[48:49], v[78:79]
  v_pk_add_f32 v[56:57], v[56:57], v[94:95]
  v_pk_add_f32 v[50:51], v[50:51], v[110:111]
  v_pk_add_f32 v[58:59], v[58:59], v[126:127]
  v_mfma_f32_16x16x32_bf16 a[44:47], a[164:167], a[148:151], a[44:47]
  v_add_f32 v48, v48, v49
  v_add_f32 v56, v56, v57
  v_add_f32 v50, v50, v51
  v_add_f32 v58, v58, v59
  v_mfma_f32_16x16x32_bf16 a[56:59], a[160:163], a[136:139], a[56:59]
  ds_read_b64_tr_b16 a[180:181], v7 offset:8352
  v_mov_b32 v52, v48
  v_mov_b32 v60, v56
  v_mov_b32 v53, v50
  v_mfma_f32_16x16x32_bf16 a[56:59], a[164:167], a[152:155], a[56:59]
  s_add_u32 m0, s56, 100352
  v_mov_b32 v61, v58
  v_permlane32_swap_b32 v48, v52
  v_permlane32_swap_b32 v56, v60
  v_mfma_f32_16x16x32_bf16 a[60:63], a[160:163], a[140:143], a[60:63]
  ds_read_b64_tr_b16 a[182:183], v7 offset:9376
  buffer_load_dwordx4 v2, s[60:63], s58 offen offset:1024 sc1 lds
  v_permlane32_swap_b32 v50, v53
  v_permlane32_swap_b32 v58, v61
  v_mfma_f32_16x16x32_bf16 a[60:63], a[164:167], a[156:159], a[60:63]
  v_add_f32 v48, v48, v52
  v_add_f32 v56, v56, v60
  v_add_f32 v50, v50, v53
  s_waitcnt lgkmcnt(4)
  v_mfma_f32_16x16x32_bf16 a[72:75], a[168:171], a[128:131], a[72:75]
  ds_read_b64_tr_b16 a[184:185], v7 offset:192
  v_add_f32 v58, v58, v61
  v_rcp_f32 v48, v48
  v_mfma_f32_16x16x32_bf16 a[72:75], a[172:175], a[144:147], a[72:75]
  s_add_u32 m0, s56, 100352
  v_rcp_f32 v56, v56
  v_rcp_f32 v50, v50
  v_mfma_f32_16x16x32_bf16 a[76:79], a[168:171], a[132:135], a[76:79]
  ds_read_b64_tr_b16 a[186:187], v7 offset:1216
  buffer_load_dwordx4 v8, s[60:63], s58 offen offset:2048 sc1 lds
  v_rcp_f32 v58, v58
  v_mfma_f32_16x16x32_bf16 a[76:79], a[172:175], a[148:151], a[76:79]
  v_pk_mul_f32 v[64:65], v[64:65], v[48:49] op_sel_hi:[1,0]
  v_pk_mul_f32 v[80:81], v[80:81], v[56:57] op_sel_hi:[1,0]
  v_pk_mul_f32 v[96:97], v[96:97], v[50:51] op_sel_hi:[1,0]
  v_pk_mul_f32 v[112:113], v[112:113], v[58:59] op_sel_hi:[1,0]
  v_pk_mul_f32 v[66:67], v[66:67], v[48:49] op_sel_hi:[1,0]
  v_pk_mul_f32 v[82:83], v[82:83], v[56:57] op_sel_hi:[1,0]
  v_pk_mul_f32 v[98:99], v[98:99], v[50:51] op_sel_hi:[1,0]
  v_pk_mul_f32 v[114:115], v[114:115], v[58:59] op_sel_hi:[1,0]
  v_pk_mul_f32 v[68:69], v[68:69], v[48:49] op_sel_hi:[1,0]
  v_pk_mul_f32 v[84:85], v[84:85], v[56:57] op_sel_hi:[1,0]
  v_pk_mul_f32 v[100:101], v[100:101], v[50:51] op_sel_hi:[1,0]
  v_pk_mul_f32 v[116:117], v[116:117], v[58:59] op_sel_hi:[1,0]
  v_pk_mul_f32 v[70:71], v[70:71], v[48:49] op_sel_hi:[1,0]
  v_pk_mul_f32 v[86:87], v[86:87], v[56:57] op_sel_hi:[1,0]
  v_pk_mul_f32 v[102:103], v[102:103], v[50:51] op_sel_hi:[1,0]
  v_pk_mul_f32 v[118:119], v[118:119], v[58:59] op_sel_hi:[1,0]
  v_pk_mul_f32 v[72:73], v[72:73], v[48:49] op_sel_hi:[1,0]
  v_pk_mul_f32 v[88:89], v[88:89], v[56:57] op_sel_hi:[1,0]
  v_pk_mul_f32 v[104:105], v[104:105], v[50:51] op_sel_hi:[1,0]
  v_pk_mul_f32 v[120:121], v[120:121], v[58:59] op_sel_hi:[1,0]
  v_pk_mul_f32 v[74:75], v[74:75], v[48:49] op_sel_hi:[1,0]
  v_pk_mul_f32 v[90:91], v[90:91], v[56:57] op_sel_hi:[1,0]
  v_pk_mul_f32 v[106:107], v[106:107], v[50:51] op_sel_hi:[1,0]
  v_pk_mul_f32 v[122:123], v[122:123], v[58:59] op_sel_hi:[1,0]
  v_pk_mul_f32 v[76:77], v[76:77], v[48:49] op_sel_hi:[1,0]
  v_pk_mul_f32 v[92:93], v[92:93], v[56:57] op_sel_hi:[1,0]
  v_pk_mul_f32 v[108:109], v[108:109], v[50:51] op_sel_hi:[1,0]
  v_pk_mul_f32 v[124:125], v[124:125], v[58:59] op_sel_hi:[1,0]
  v_pk_mul_f32 v[78:79], v[78:79], v[48:49] op_sel_hi:[1,0]
  v_pk_mul_f32 v[94:95], v[94:95], v[56:57] op_sel_hi:[1,0]
  v_pk_mul_f32 v[110:111], v[110:111], v[50:51] op_sel_hi:[1,0]
  v_pk_mul_f32 v[126:127], v[126:127], v[58:59] op_sel_hi:[1,0]
  v_mfma_f32_16x16x32_bf16 a[88:91], a[168:171], a[136:139], a[88:91]
  ds_read_b64_tr_b16 a[188:189], v7 offset:8384
  v_cvt_pk_bf16_f32 v64, v64, v65
  v_cvt_pk_bf16_f32 v80, v80, v81
  v_cvt_pk_bf16_f32 v65, v66, v67
  v_mfma_f32_16x16x32_bf16 a[88:91], a[172:175], a[152:155], a[88:91]
  s_add_u32 m0, s56, 100352
  v_cvt_pk_bf16_f32 v81, v82, v83
  v_cvt_pk_bf16_f32 v66, v68, v69
  v_cvt_pk_bf16_f32 v82, v84, v85
  v_mfma_f32_16x16x32_bf16 a[92:95], a[168:171], a[140:143], a[92:95]
  ds_read_b64_tr_b16 a[190:191], v7 offset:9408
  buffer_load_dwordx4 v8, s[60:63], s58 offen offset:3072 sc1 lds
  v_cvt_pk_bf16_f32 v67, v70, v71
  v_cvt_pk_bf16_f32 v83, v86, v87
  v_mfma_f32_16x16x32_bf16 a[92:95], a[172:175], a[156:159], a[92:95]
  s_add_u32 s58, s58, 0x20000
  v_cvt_pk_bf16_f32 v68, v72, v73
  v_cvt_pk_bf16_f32 v84, v88, v89
  s_waitcnt vmcnt(4)
  s_barrier
  s_waitcnt lgkmcnt(4)
  v_mfma_f32_16x16x32_bf16 v[200:203], a[176:179], a[128:131], v[200:203]
  ds_read_b64_tr_b16 a[160:161], v7 offset:32768
  v_cvt_pk_bf16_f32 v69, v74, v75
  v_cvt_pk_bf16_f32 v85, v90, v91
  v_cvt_pk_bf16_f32 v70, v76, v77
  v_mfma_f32_16x16x32_bf16 v[200:203], a[180:183], a[144:147], v[200:203]
  s_add_u32 m0, s56, 116736
  v_cvt_pk_bf16_f32 v86, v92, v93
  v_cvt_pk_bf16_f32 v71, v78, v79
  v_cvt_pk_bf16_f32 v87, v94, v95
  v_mfma_f32_16x16x32_bf16 v[204:207], a[176:179], a[132:135], v[204:207]
  ds_read_b64_tr_b16 a[162:163], v7 offset:33792
  buffer_load_dwordx4 v2, s[60:63], s58 offen offset:0 sc1 lds
  v_cvt_pk_bf16_f32 v72, v96, v97
  v_cvt_pk_bf16_f32 v88, v112, v113
  v_mfma_f32_16x16x32_bf16 v[204:207], a[180:183], a[148:151], v[204:207]
  v_cvt_pk_bf16_f32 v73, v98, v99
  v_cvt_pk_bf16_f32 v89, v114, v115
  v_cvt_pk_bf16_f32 v74, v100, v101
  v_cvt_pk_bf16_f32 v90, v116, v117
  v_mfma_f32_16x16x32_bf16 v[216:219], a[176:179], a[136:139], v[216:219]
  ds_read_b64_tr_b16 a[164:165], v7 offset:40960
  v_cvt_pk_bf16_f32 v75, v102, v103
  v_cvt_pk_bf16_f32 v91, v118, v119
  v_cvt_pk_bf16_f32 v76, v104, v105
  v_mfma_f32_16x16x32_bf16 v[216:219], a[180:183], a[152:155], v[216:219]
  s_add_u32 m0, s56, 116736
  v_cvt_pk_bf16_f32 v92, v120, v121
  v_cvt_pk_bf16_f32 v77, v106, v107
  v_cvt_pk_bf16_f32 v93, v122, v123
  v_mfma_f32_16x16x32_bf16 v[220:223], a[176:179], a[140:143], v[220:223]
  ds_read_b64_tr_b16 a[166:167], v7 offset:41984
  buffer_load_dwordx4 v2, s[60:63], s58 offen offset:1024 sc1 lds
  v_cvt_pk_bf16_f32 v78, v108, v109
  v_cvt_pk_bf16_f32 v94, v124, v125
  v_mfma_f32_16x16x32_bf16 v[220:223], a[180:183], a[156:159], v[220:223]
  v_cvt_pk_bf16_f32 v79, v110, v111
  v_cvt_pk_bf16_f32 v95, v126, v127
  buffer_load_dwordx2 v[26:27], v17, s[24:27], s70 offen offset:64 sc1
  s_waitcnt lgkmcnt(4)
  v_mfma_f32_16x16x32_bf16 v[232:235], a[184:187], a[128:131], v[232:235]
  ds_read_b64_tr_b16 a[168:169], v6 offset:16384
  s_cmp_ge_u32 s48, 12
  s_cselect_b32 s35, 26, 0
  s_cmp_ge_u32 s48, 10
  s_cselect_b32 s64, 38, 12
  v_mfma_f32_16x16x32_bf16 v[232:235], a[188:191], a[144:147], v[232:235]
  s_add_u32 m0, s56, 116736
  s_cmp_ge_u32 s48, 22
  s_cselect_b32 s35, 54, s35
  s_cselect_b32 s64, 64, s64
  v_mfma_f32_16x16x32_bf16 v[236:239], a[184:187], a[132:135], v[236:239]
  ds_read_b64_tr_b16 a[170:171], v6 offset:17408
  buffer_load_dwordx4 v8, s[60:63], s58 offen offset:2048 sc1 lds
  s_add_u32 s35, s35, s48
  s_lshl_b32 s35, s35, 17
  v_mfma_f32_16x16x32_bf16 v[236:239], a[188:191], a[148:151], v[236:239]
  s_add_u32 s41, s35, 0x800000
  s_add_u32 s42, s41, 512
  s_add_u32 s64, s64, s48
  s_lshl_b32 s64, s64, 17
  v_mfma_f32_16x16x32_bf16 v[248:251], a[184:187], a[136:139], v[248:251]
  ds_read_b64_tr_b16 a[172:173], v6 offset:24576
  s_add_u32 s43, s64, 0x800000
  s_add_u32 s44, s43, 512
  s_mul_i32 s40, s48, 3
  v_mfma_f32_16x16x32_bf16 v[248:251], a[188:191], a[152:155], v[248:251]
  s_add_u32 m0, s56, 116736
  s_add_u32 s35, s40, 0
  s_cmp_ge_u32 s35, 32
  s_cselect_b32 s64, 88, 44
  s_cmp_ge_u32 s35, 64
  s_cselect_b32 s64, 128, s64
  v_mfma_f32_16x16x32_bf16 v[252:255], a[184:187], a[140:143], v[252:255]
  ds_read_b64_tr_b16 a[174:175], v6 offset:25600
  buffer_load_dwordx4 v8, s[60:63], s58 offen offset:3072 sc1 lds
  s_add_u32 s35, s35, s64
  s_lshr_b32 s64, s35, 1
  v_mfma_f32_16x16x32_bf16 v[252:255], a[188:191], a[156:159], v[252:255]
  s_add_u32 s58, s58, 0x20000
  s_lshl_b32 s64, s64, 17
  s_and_b32 s35, s35, 1
  s_waitcnt lgkmcnt(4)
  v_mfma_f32_16x16x32_bf16 v[128:131], a[160:163], a[96:99], v[128:131]
  ds_read_b64_tr_b16 a[176:177], v6 offset:0
  s_lshl_b32 s35, s35, 9
  s_add_u32 s35, s35, s64
  v_mfma_f32_16x16x32_bf16 v[128:131], a[164:167], a[112:115], v[128:131]
  s_add_u32 m0, s56, 133120
  s_add_u32 s45, s35, 0x800000
  s_add_u32 s35, s40, 1
  v_mfma_f32_16x16x32_bf16 v[132:135], a[160:163], a[100:103], v[132:135]
  ds_read_b64_tr_b16 a[178:179], v6 offset:1024
  buffer_load_dwordx4 v2, s[60:63], s58 offen offset:0 sc1 lds
  s_cmp_ge_u32 s35, 32
  s_cselect_b32 s64, 88, 44
  s_cmp_ge_u32 s35, 64
  s_cselect_b32 s64, 128, s64
  v_mfma_f32_16x16x32_bf16 v[132:135], a[164:167], a[116:119], v[132:135]
  s_add_u32 s35, s35, s64
  s_lshr_b32 s64, s35, 1
  s_lshl_b32 s64, s64, 17
  v_mfma_f32_16x16x32_bf16 v[144:147], a[160:163], a[104:107], v[144:147]
  ds_read_b64_tr_b16 a[180:181], v6 offset:8192
  s_and_b32 s35, s35, 1
  s_lshl_b32 s35, s35, 9
  v_mfma_f32_16x16x32_bf16 v[144:147], a[164:167], a[120:123], v[144:147]
  s_add_u32 m0, s56, 133120
  s_add_u32 s35, s35, s64
  s_add_u32 s46, s35, 0x800000
  v_mfma_f32_16x16x32_bf16 v[148:151], a[160:163], a[108:111], v[148:151]
  ds_read_b64_tr_b16 a[182:183], v6 offset:9216
  buffer_load_dwordx4 v2, s[60:63], s58 offen offset:1024 sc1 lds
  s_add_u32 s35, s40, 2
  v_mfma_f32_16x16x32_bf16 v[148:151], a[164:167], a[124:127], v[148:151]
  s_cmp_ge_u32 s35, 32
  s_cselect_b32 s64, 88, 44
  s_cmp_ge_u32 s35, 64
  s_cselect_b32 s64, 128, s64
  s_waitcnt lgkmcnt(4)
  v_mfma_f32_16x16x32_bf16 v[128:131], a[168:171], a[208:211], v[128:131]
  ds_read_b64_tr_b16 a[184:185], v6 offset:32768
  s_add_u32 s35, s35, s64
  s_lshr_b32 s64, s35, 1
  v_mfma_f32_16x16x32_bf16 v[128:131], a[172:175], a[224:227], v[128:131]
  s_add_u32 m0, s56, 133120
  s_lshl_b32 s64, s64, 17
  s_and_b32 s35, s35, 1
  v_mfma_f32_16x16x32_bf16 v[132:135], a[168:171], a[212:215], v[132:135]
  ds_read_b64_tr_b16 a[186:187], v6 offset:33792
  buffer_load_dwordx4 v8, s[60:63], s58 offen offset:2048 sc1 lds
  s_lshl_b32 s35, s35, 9
  v_mfma_f32_16x16x32_bf16 v[132:135], a[172:175], a[228:231], v[132:135]
  s_add_u32 s35, s35, s64
  s_add_u32 s47, s35, 0x800000
  s_lshl_b32 s48, s48, 17
  v_mfma_f32_16x16x32_bf16 v[144:147], a[168:171], a[216:219], v[144:147]
  ds_read_b64_tr_b16 a[188:189], v6 offset:40960
  s_add_u32 s48, s48, 0x400000
  s_waitcnt vmcnt(5)
  s_mov_b32 s65, 0
L_ga_poll:
  v_cmp_ne_u64 vcc, v[26:27], v[24:25]
  s_add_u32 s65, s65, 1
  s_cmp_eq_u64 vcc, 0
  s_cbranch_scc1 L_ga_go
  s_sleep 1
  buffer_load_dwordx2 v[26:27], v17, s[24:27], s70 offen offset:64 sc1
  s_waitcnt vmcnt(0)
  s_cmp_lt_u32 s65, 0x200000
  s_cbranch_scc1 L_ga_poll
L_ga_go:
  v_mfma_f32_16x16x32_bf16 v[144:147], a[172:175], a[232:235], v[144:147]
  s_add_u32 m0, s56, 133120
  buffer_load_dwordx4 v[32:35], v21, s[24:27], s68 offen offset:0 sc1
  v_mov_b32 v12, s72
  v_mfma_f32_16x16x32_bf16 v[148:151], a[168:171], a[220:223], v[148:151]
  ds_read_b64_tr_b16 a[190:191], v6 offset:41984
  buffer_load_dwordx4 v8, s[60:63], s58 offen offset:3072 sc1 lds
  buffer_load_dwordx4 v[36:39], v21, s[24:27], s68 offen offset:1024 sc1
  v_mfma_f32_16x16x32_bf16 v[148:151], a[172:175], a[236:239], v[148:151]
  s_add_u32 s58, s58, 0x20000
  v_mov_b32 v13, s73
  s_waitcnt lgkmcnt(4)
  v_mfma_f32_16x16x32_bf16 v[136:139], a[176:179], a[96:99], v[136:139]
  ds_read_b64_tr_b16 a[160:161], v7 offset:32800
  s_add_u32 s68, s68, 262144
  v_add_u32 v15, s71, v5
  v_mfma_f32_16x16x32_bf16 v[136:139], a[180:183], a[112:115], v[136:139]
  buffer_load_dwordx4 v[40:43], v21, s[24:27], s68 offen offset:0 sc1
  s_mov_b32 s30, s66
  buffer_load_dwordx4 v[44:47], v21, s[24:27], s68 offen offset:1024 sc1
  v_mfma_f32_16x16x32_bf16 v[140:143], a[176:179], a[100:103], v[140:143]
  ds_read_b64_tr_b16 a[162:163], v7 offset:33824
  s_lshl_b32 s29, s34, 11
  s_add_u32 s68, s68, 262144
  v_mfma_f32_16x16x32_bf16 v[140:143], a[180:183], a[116:119], v[140:143]
  s_lshl_b32 s37, s32, 9
  buffer_load_dwordx4 v[48:51], v21, s[24:27], s68 offen offset:0 sc1
  s_add_u32 s29, s29, s37
  v_mfma_f32_16x16x32_bf16 v[152:155], a[176:179], a[104:107], v[152:155]
  ds_read_b64_tr_b16 a[164:165], v7 offset:40992
  buffer_load_dwordx4 v[52:55], v21, s[24:27], s68 offen offset:1024 sc1
  s_add_u32 s29, s29, 0x1980080
  v_mfma_f32_16x16x32_bf16 v[152:155], a[180:183], a[120:123], v[152:155]
  s_add_u32 s68, s68, 262144
  s_mul_i32 s36, s30, 10
  buffer_load_dwordx4 v[56:59], v21, s[24:27], s68 offen offset:0 sc1
  v_mfma_f32_16x16x32_bf16 v[156:159], a[176:179], a[108:111], v[156:159]
  ds_read_b64_tr_b16 a[166:167], v7 offset:42016
  s_add_u32 s37, s36, 11
  buffer_load_dwordx4 v[60:63], v21, s[24:27], s68 offen offset:1024 sc1
  v_mfma_f32_16x16x32_bf16 v[156:159], a[180:183], a[124:127], v[156:159]
  s_add_u32 s36, s36, 2
  s_add_u32 s68, s68, 262144
  s_waitcnt lgkmcnt(4)
  v_mfma_f32_16x16x32_bf16 v[136:139], a[184:187], a[208:211], v[136:139]
  ds_read_b64_tr_b16 a[168:169], v6 offset:16416
  s_min_u32 s37, s37, 31
  buffer_load_dwordx4 v[96:99], v21, s[24:27], s68 offen offset:0 sc1
  v_mfma_f32_16x16x32_bf16 v[136:139], a[188:191], a[224:227], v[136:139]
  s_cmp_eq_u32 s30, 0
  s_cselect_b32 s36, 0, s36
  buffer_load_dwordx4 v[100:103], v21, s[24:27], s68 offen offset:1024 sc1
  v_mfma_f32_16x16x32_bf16 v[140:143], a[184:187], a[212:215], v[140:143]
  ds_read_b64_tr_b16 a[170:171], v6 offset:17440
  s_cmp_eq_u32 s30, 3
  s_cselect_b32 s36, 0, s36
  s_cselect_b32 s38, 1, 0
  s_cselect_b32 s39, 1, 2
  v_mfma_f32_16x16x32_bf16 v[140:143], a[188:191], a[228:231], v[140:143]
  s_add_u32 s68, s68, 262144
  s_lshl_b32 s38, s38, 7
  buffer_load_dwordx4 v[104:107], v21, s[24:27], s68 offen offset:0 sc1
  v_mfma_f32_16x16x32_bf16 v[152:155], a[184:187], a[216:219], v[152:155]
  ds_read_b64_tr_b16 a[172:173], v6 offset:24608
  s_lshl_b32 s39, s39, 7
  buffer_load_dwordx4 v[108:111], v21, s[24:27], s68 offen offset:1024 sc1
  v_mfma_f32_16x16x32_bf16 v[152:155], a[188:191], a[232:235], v[152:155]
  s_add_u32 s28, s29, s39
  s_add_u32 s68, s68, 262144
  s_sub_u32 s31, s29, 56
  v_mfma_f32_16x16x32_bf16 v[156:159], a[184:187], a[220:223], v[156:159]
  ds_read_b64_tr_b16 a[174:175], v6 offset:25632
  buffer_load_dwordx4 v[112:115], v21, s[24:27], s68 offen offset:0 sc1
  s_add_u32 s29, s29, s38
  v_mfma_f32_16x16x32_bf16 v[156:159], a[188:191], a[236:239], v[156:159]
  buffer_load_dwordx4 v[116:119], v21, s[24:27], s68 offen offset:1024 sc1
  v_add_u32 v4, s36, v1
  s_waitcnt lgkmcnt(4)
  v_mfma_f32_16x16x32_bf16 v[160:163], a[160:163], a[96:99], v[160:163]
  ds_read_b64_tr_b16 a[176:177], v6 offset:32
  s_add_u32 s68, s68, 262144
  v_min_u32 v4, s37, v4
  v_mfma_f32_16x16x32_bf16 v[160:163], a[164:167], a[112:115], v[160:163]
  buffer_load_dwordx4 v[120:123], v21, s[24:27], s68 offen offset:0 sc1
  v_lshlrev_b32 v4, 14, v4
  buffer_load_dwordx4 v[124:127], v21, s[24:27], s68 offen offset:1024 sc1
  v_mfma_f32_16x16x32_bf16 v[164:167], a[160:163], a[100:103], v[164:167]
  ds_read_b64_tr_b16 a[178:179], v6 offset:1056
  s_mul_i32 s36, s30, 21
  buffer_load_dwordx4 v[24:27], v16, s[24:27], s70 offen sc1
  v_mfma_f32_16x16x32_bf16 v[164:167], a[164:167], a[116:119], v[164:167]
  s_lshr_b32 s36, s36, 1
  s_add_u32 s37, s36, 11
  s_min_u32 s37, s37, 31
  v_mfma_f32_16x16x32_bf16 v[176:179], a[160:163], a[104:107], v[176:179]
  ds_read_b64_tr_b16 a[180:181], v6 offset:8224
  s_cmp_eq_u32 s30, 3
  s_cselect_b32 s36, 0, s36
  s_cselect_b32 s31, s29, s31
  v_mfma_f32_16x16x32_bf16 v[176:179], a[164:167], a[120:123], v[176:179]
  s_cmp_eq_u32 s30, 0
  s_cselect_b32 s37, 10, s37
  v_add_u32 v11, s36, v1
  v_mfma_f32_16x16x32_bf16 v[180:183], a[160:163], a[108:111], v[180:183]
  ds_read_b64_tr_b16 a[182:183], v6 offset:9248
  v_min_u32 v11, s37, v11
  v_lshlrev_b32 v11, 14, v11
  v_mfma_f32_16x16x32_bf16 v[180:183], a[164:167], a[124:127], v[180:183]
  s_mov_b32 s36, 100352
  s_mov_b32 s37, 49152
  s_waitcnt lgkmcnt(4)
  v_mfma_f32_16x16x32_bf16 v[160:163], a[168:171], a[208:211], v[160:163]
  ds_read_b64_tr_b16 a[184:185], v6 offset:32800
  s_cmp_eq_u32 s30, 3
  s_cselect_b32 s57, 2, 3
  s_cselect_b32 s38, s37, s36
  s_cselect_b32 s39, s36, s37
  v_mfma_f32_16x16x32_bf16 v[160:163], a[172:175], a[224:227], v[160:163]
  s_add_u32 s12, s56, s38
  s_add_u32 s13, s56, s39
  v_add_u32 v5, s38, v21
  v_mfma_f32_16x16x32_bf16 v[164:167], a[168:171], a[212:215], v[164:167]
  ds_read_b64_tr_b16 a[186:187], v6 offset:33824
  v_add_u32 v10, s39, v21
  s_lshl_b32 s59, s54, 18
  v_mfma_f32_16x16x32_bf16 v[164:167], a[172:175], a[228:231], v[164:167]
  s_add_u32 s59, s59, 0x400000
  s_lshl_b32 s38, s67, 18
  s_add_u32 s10, s59, s38
  v_mfma_f32_16x16x32_bf16 v[176:179], a[168:171], a[216:219], v[176:179]
  ds_read_b64_tr_b16 a[188:189], v6 offset:40992
  s_lshl_b32 s37, s34, 14
  s_add_u32 s37, s37, s56
  v_mfma_f32_16x16x32_bf16 v[176:179], a[172:175], a[232:235], v[176:179]
  v_add_u32 v3, s37, v21
  s_mov_b32 s8, s24
  s_mov_b32 s9, s25
  v_mfma_f32_16x16x32_bf16 v[180:183], a[168:171], a[220:223], v[180:183]
  ds_read_b64_tr_b16 a[190:191], v6 offset:42016
  v_pk_mul_f32 v[128:129], v[128:129], v[136:137]
  v_pk_mul_f32 v[144:145], v[144:145], v[152:153]
  v_pk_mul_f32 v[130:131], v[130:131], v[138:139]
  v_pk_mul_f32 v[146:147], v[146:147], v[154:155]
  v_pk_mul_f32 v[132:133], v[132:133], v[140:141]
  v_pk_mul_f32 v[148:149], v[148:149], v[156:157]
  v_pk_mul_f32 v[134:135], v[134:135], v[142:143]
  v_pk_mul_f32 v[150:151], v[150:151], v[158:159]
  v_mfma_f32_16x16x32_bf16 v[180:183], a[172:175], a[236:239], v[180:183]
  v_cvt_pk_bf16_f32 v136, v128, v129
  v_cvt_pk_bf16_f32 v152, v144, v145
  s_waitcnt lgkmcnt(4)
  v_mfma_f32_16x16x32_bf16 v[168:171], a[176:179], a[96:99], v[168:171]
  ds_read_b64_tr_b16 a[160:161], v7 offset:32832
  v_cvt_pk_bf16_f32 v137, v130, v131
  v_cvt_pk_bf16_f32 v153, v146, v147
  v_mfma_f32_16x16x32_bf16 v[168:171], a[180:183], a[112:115], v[168:171]
  v_cvt_pk_bf16_f32 v138, v132, v133
  v_cvt_pk_bf16_f32 v154, v148, v149
  v_cvt_pk_bf16_f32 v139, v134, v135
  v_mfma_f32_16x16x32_bf16 v[172:175], a[176:179], a[100:103], v[172:175]
  ds_read_b64_tr_b16 a[162:163], v7 offset:33856
  v_cvt_pk_bf16_f32 v155, v150, v151
  v_permlane16_swap_b32 v136, v138
  v_mfma_f32_16x16x32_bf16 v[172:175], a[180:183], a[116:119], v[172:175]
  v_permlane16_swap_b32 v152, v154
  v_permlane16_swap_b32 v137, v139
  v_permlane16_swap_b32 v153, v155
  v_mfma_f32_16x16x32_bf16 v[184:187], a[176:179], a[104:107], v[184:187]
  ds_read_b64_tr_b16 a[164:165], v7 offset:41024
  buffer_store_dwordx4 v[136:139], v9, s[24:27], s41 offen offset:0 sc1
  buffer_store_dwordx4 v[152:155], v9, s[24:27], s41 offen offset:2048 sc1
  v_mfma_f32_16x16x32_bf16 v[184:187], a[180:183], a[120:123], v[184:187]
  v_mfma_f32_16x16x32_bf16 v[188:191], a[176:179], a[108:111], v[188:191]
  ds_read_b64_tr_b16 a[166:167], v7 offset:42048
  v_mfma_f32_16x16x32_bf16 v[188:191], a[180:183], a[124:127], v[188:191]
  s_waitcnt lgkmcnt(4)
  v_mfma_f32_16x16x32_bf16 v[168:171], a[184:187], a[208:211], v[168:171]
  ds_read_b64_tr_b16 a[168:169], v6 offset:16448
  v_mfma_f32_16x16x32_bf16 v[168:171], a[188:191], a[224:227], v[168:171]
  v_mfma_f32_16x16x32_bf16 v[172:175], a[184:187], a[212:215], v[172:175]
  ds_read_b64_tr_b16 a[170:171], v6 offset:17472
  v_mfma_f32_16x16x32_bf16 v[172:175], a[188:191], a[228:231], v[172:175]
  v_mfma_f32_16x16x32_bf16 v[184:187], a[184:187], a[216:219], v[184:187]
  ds_read_b64_tr_b16 a[172:173], v6 offset:24640
  v_mfma_f32_16x16x32_bf16 v[184:187], a[188:191], a[232:235], v[184:187]
  v_mfma_f32_16x16x32_bf16 v[188:191], a[184:187], a[220:223], v[188:191]
  ds_read_b64_tr_b16 a[174:175], v6 offset:25664
  v_mfma_f32_16x16x32_bf16 v[188:191], a[188:191], a[236:239], v[188:191]
  s_waitcnt lgkmcnt(4)
  v_mfma_f32_16x16x32_bf16 a[0:3], a[160:163], a[96:99], a[0:3]
  ds_read_b64_tr_b16 a[176:177], v6 offset:64
  v_pk_mul_f32 v[160:161], v[160:161], v[168:169]
  s_nop 0
  v_pk_mul_f32 v[176:177], v[176:177], v[184:185]
  v_pk_mul_f32 v[162:163], v[162:163], v[170:171]
  v_pk_mul_f32 v[178:179], v[178:179], v[186:187]
  v_pk_mul_f32 v[164:165], v[164:165], v[172:173]
  v_pk_mul_f32 v[180:181], v[180:181], v[188:189]
  v_pk_mul_f32 v[166:167], v[166:167], v[174:175]
  v_pk_mul_f32 v[182:183], v[182:183], v[190:191]
  v_mfma_f32_16x16x32_bf16 a[0:3], a[164:167], a[112:115], a[0:3]
  v_cvt_pk_bf16_f32 v168, v160, v161
  v_cvt_pk_bf16_f32 v184, v176, v177
  v_cvt_pk_bf16_f32 v169, v162, v163
  v_mfma_f32_16x16x32_bf16 a[4:7], a[160:163], a[100:103], a[4:7]
  ds_read_b64_tr_b16 a[178:179], v6 offset:1088
  v_cvt_pk_bf16_f32 v185, v178, v179
  v_cvt_pk_bf16_f32 v170, v164, v165
  v_mfma_f32_16x16x32_bf16 a[4:7], a[164:167], a[116:119], a[4:7]
  v_cvt_pk_bf16_f32 v186, v180, v181
  v_cvt_pk_bf16_f32 v171, v166, v167
  v_cvt_pk_bf16_f32 v187, v182, v183
  v_mfma_f32_16x16x32_bf16 a[16:19], a[160:163], a[104:107], a[16:19]
  ds_read_b64_tr_b16 a[180:181], v6 offset:8256
  v_permlane16_swap_b32 v168, v170
  v_permlane16_swap_b32 v184, v186
  v_mfma_f32_16x16x32_bf16 a[16:19], a[164:167], a[120:123], a[16:19]
  v_permlane16_swap_b32 v169, v171
  v_permlane16_swap_b32 v185, v187
  buffer_store_dwordx4 v[168:171], v9, s[24:27], s42 offen offset:0 sc1
  v_mfma_f32_16x16x32_bf16 a[20:23], a[160:163], a[108:111], a[20:23]
  ds_read_b64_tr_b16 a[182:183], v6 offset:9280
  buffer_store_dwordx4 v[184:187], v9, s[24:27], s42 offen offset:2048 sc1
  s_waitcnt vmcnt(4)
  v_pk_add_f32 v[32:33], v[32:33], v[40:41]
  v_pk_add_f32 v[34:35], v[34:35], v[42:43]
  v_pk_add_f32 v[36:37], v[36:37], v[44:45]
  v_pk_add_f32 v[38:39], v[38:39], v[46:47]
  v_pk_add_f32 v[32:33], v[32:33], v[48:49]
  v_pk_add_f32 v[34:35], v[34:35], v[50:51]
  v_pk_add_f32 v[36:37], v[36:37], v[52:53]
  v_pk_add_f32 v[38:39], v[38:39], v[54:55]
  v_pk_add_f32 v[32:33], v[32:33], v[56:57]
  v_pk_add_f32 v[34:35], v[34:35], v[58:59]
  v_pk_add_f32 v[36:37], v[36:37], v[60:61]
  v_pk_add_f32 v[38:39], v[38:39], v[62:63]
  v_pk_add_f32 v[32:33], v[32:33], v[96:97]
  v_pk_add_f32 v[34:35], v[34:35], v[98:99]
  v_pk_add_f32 v[36:37], v[36:37], v[100:101]
  v_pk_add_f32 v[38:39], v[38:39], v[102:103]
  v_pk_add_f32 v[32:33], v[32:33], v[104:105]
  v_pk_add_f32 v[34:35], v[34:35], v[106:107]
  v_pk_add_f32 v[36:37], v[36:37], v[108:109]
  v_pk_add_f32 v[38:39], v[38:39], v[110:111]
  v_pk_add_f32 v[32:33], v[32:33], v[112:113]
  v_pk_add_f32 v[34:35], v[34:35], v[114:115]
  v_pk_add_f32 v[36:37], v[36:37], v[116:117]
  v_pk_add_f32 v[38:39], v[38:39], v[118:119]
  v_pk_add_f32 v[32:33], v[32:33], v[120:121]
  v_pk_add_f32 v[34:35], v[34:35], v[122:123]
  v_pk_add_f32 v[36:37], v[36:37], v[124:125]
  v_pk_add_f32 v[38:39], v[38:39], v[126:127]
  v_mfma_f32_16x16x32_bf16 a[20:23], a[164:167], a[124:127], a[20:23]
  v_cvt_pk_bf16_f32 v40, v32, v33
  v_cvt_pk_bf16_f32 v41, v34, v35
  s_waitcnt lgkmcnt(4)
  v_mfma_f32_16x16x32_bf16 a[0:3], a[168:171], a[208:211], a[0:3]
  ds_read_b64_tr_b16 a[184:185], v6 offset:32832
  v_cvt_pk_bf16_f32 v42, v36, v37
  v_cvt_pk_bf16_f32 v43, v38, v39
  v_mfma_f32_16x16x32_bf16 a[0:3], a[172:175], a[224:227], a[0:3]
  ds_write_b128 v22, v[40:43]
  v_add_f32_dpp v24, v24, v24 row_ror:4 row_mask:0xf bank_mask:0xf
  v_add_f32_dpp v25, v25, v25 row_ror:4 row_mask:0xf bank_mask:0xf
  v_mfma_f32_16x16x32_bf16 a[4:7], a[168:171], a[212:215], a[4:7]
  ds_read_b64_tr_b16 a[186:187], v6 offset:33856
  v_add_f32_dpp v26, v26, v26 row_ror:4 row_mask:0xf bank_mask:0xf
  v_add_f32_dpp v27, v27, v27 row_ror:4 row_mask:0xf bank_mask:0xf
  v_mfma_f32_16x16x32_bf16 a[4:7], a[172:175], a[228:231], a[4:7]
  v_add_f32_dpp v24, v24, v24 row_ror:8 row_mask:0xf bank_mask:0xf
  v_add_f32_dpp v25, v25, v25 row_ror:8 row_mask:0xf bank_mask:0xf
  v_add_f32_dpp v26, v26, v26 row_ror:8 row_mask:0xf bank_mask:0xf
  v_mfma_f32_16x16x32_bf16 a[16:19], a[168:171], a[216:219], a[16:19]
  ds_read_b64_tr_b16 a[188:189], v6 offset:41024
  v_add_f32_dpp v27, v27, v27 row_ror:8 row_mask:0xf bank_mask:0xf
  v_mov_b32 v28, v24
  v_mfma_f32_16x16x32_bf16 a[16:19], a[172:175], a[232:235], a[16:19]
  v_mov_b32 v29, v25
  v_mov_b32 v30, v26
  v_mov_b32 v31, v27
  v_mfma_f32_16x16x32_bf16 a[20:23], a[168:171], a[220:223], a[20:23]
  ds_read_b64_tr_b16 a[190:191], v6 offset:42048
  v_permlane16_swap_b32 v24, v28
  v_permlane16_swap_b32 v25, v29
  v_mfma_f32_16x16x32_bf16 a[20:23], a[172:175], a[236:239], a[20:23]
  v_permlane16_swap_b32 v26, v30
  v_permlane16_swap_b32 v27, v31
  s_waitcnt lgkmcnt(5)
  v_mfma_f32_16x16x32_bf16 a[8:11], a[176:179], a[96:99], a[8:11]
  ds_read_b64_tr_b16 a[160:161], v7 offset:32864
  v_add_f32 v24, v24, v28
  v_add_f32 v25, v25, v29
  v_mfma_f32_16x16x32_bf16 a[8:11], a[180:183], a[112:115], a[8:11]
  v_add_f32 v26, v26, v30
  v_add_f32 v27, v27, v31
  v_cvt_pk_bf16_f32 v28, v24, v25
  v_mfma_f32_16x16x32_bf16 a[12:15], a[176:179], a[100:103], a[12:15]
  ds_read_b64_tr_b16 a[162:163], v7 offset:33888
  v_cvt_pk_bf16_f32 v29, v26, v27
  ds_write_b64 v18, v[28:29]
  v_mfma_f32_16x16x32_bf16 a[12:15], a[180:183], a[116:119], a[12:15]
  s_waitcnt lgkmcnt(0)
  s_barrier
  ds_read_b128 a[128:131], v23 offset:0
  ds_read_b128 a[132:135], v23 offset:2048
  ds_read_b128 a[136:139], v23 offset:4096
  v_mfma_f32_16x16x32_bf16 a[24:27], a[176:179], a[104:107], a[24:27]
  ds_read_b64_tr_b16 a[164:165], v7 offset:41056
  ds_read_b128 a[140:143], v23 offset:6144
  ds_read_b64 a[144:145], v19 offset:0
  v_mfma_f32_16x16x32_bf16 a[24:27], a[180:183], a[120:123], a[24:27]
  ds_read_b64 a[146:147], v19 offset:16
  ds_read_b64 a[148:149], v19 offset:2048
  ds_read_b64 a[150:151], v19 offset:2064
  v_mfma_f32_16x16x32_bf16 a[28:31], a[176:179], a[108:111], a[28:31]
  ds_read_b64_tr_b16 a[166:167], v7 offset:42080
  ds_read_b64 a[152:153], v19 offset:4096
  ds_read_b64 a[154:155], v19 offset:4112
  v_mfma_f32_16x16x32_bf16 a[28:31], a[180:183], a[124:127], a[28:31]
  ds_read_b64 a[156:157], v19 offset:6144
  ds_read_b64 a[158:159], v19 offset:6160
  v_mfma_f32_16x16x32_bf16 a[8:11], a[184:187], a[208:211], a[8:11]
  ds_read_b64_tr_b16 a[168:169], v6 offset:16480
  s_nop 0
  s_nop 0
  v_mfma_f32_16x16x32_bf16 a[8:11], a[188:191], a[224:227], a[8:11]
  s_add_u32 m0, s56, 49152
  s_nop 0
  s_nop 0
  v_mfma_f32_16x16x32_bf16 a[12:15], a[184:187], a[212:215], a[12:15]
  ds_read_b64_tr_b16 a[170:171], v6 offset:17504
  buffer_load_dwordx4 v2, s[60:63], s58 offen offset:0 sc1 lds
  s_nop 0
  v_mfma_f32_16x16x32_bf16 a[12:15], a[188:191], a[228:231], a[12:15]
  s_nop 0
  s_nop 0
  s_nop 0
  v_mfma_f32_16x16x32_bf16 a[24:27], a[184:187], a[216:219], a[24:27]
  ds_read_b64_tr_b16 a[172:173], v6 offset:24672
  s_waitcnt lgkmcnt(3)
  v_mfma_f32_32x32x16_bf16 v[96:111], a[144:147], v[64:67], 0
  v_mfma_f32_16x16x32_bf16 a[24:27], a[188:191], a[232:235], a[24:27]
  s_add_u32 m0, s56, 49152
  v_mfma_f32_32x32x16_bf16 v[32:47], a[128:131], v[64:67], 0
  v_mfma_f32_16x16x32_bf16 a[28:31], a[184:187], a[220:223], a[28:31]
  ds_read_b64_tr_b16 a[174:175], v6 offset:25696
  buffer_load_dwordx4 v2, s[60:63], s58 offen offset:1024 sc1 lds
  v_mfma_f32_32x32x16_bf16 v[96:111], a[148:151], v[68:71], v[96:111]
  v_mfma_f32_16x16x32_bf16 a[28:31], a[188:191], a[236:239], a[28:31]
  v_mfma_f32_32x32x16_bf16 v[32:47], a[132:135], v[68:71], v[32:47]
  v_mfma_f32_16x16x32_bf16 a[32:35], a[160:163], a[96:99], a[32:35]
  ds_read_b64_tr_b16 a[176:177], v6 offset:96
  v_mfma_f32_32x32x16_bf16 v[96:111], a[152:155], v[72:75], v[96:111]
  v_mfma_f32_16x16x32_bf16 a[32:35], a[164:167], a[112:115], a[32:35]
  s_add_u32 m0, s56, 49152
  v_mfma_f32_32x32x16_bf16 v[32:47], a[136:139], v[72:75], v[32:47]
  v_mfma_f32_16x16x32_bf16 a[36:39], a[160:163], a[100:103], a[36:39]
  ds_read_b64_tr_b16 a[178:179], v6 offset:1120
  buffer_load_dwordx4 v8, s[60:63], s58 offen offset:2048 sc1 lds
  v_mfma_f32_32x32x16_bf16 v[96:111], a[156:159], v[76:79], v[96:111]
  v_mfma_f32_16x16x32_bf16 a[36:39], a[164:167], a[116:119], a[36:39]
  v_mfma_f32_32x32x16_bf16 v[32:47], a[140:143], v[76:79], v[32:47]
  v_mfma_f32_32x32x16_bf16 v[112:127], a[144:147], v[80:83], 0
  v_mfma_f32_16x16x32_bf16 a[48:51], a[160:163], a[104:107], a[48:51]
  ds_read_b64_tr_b16 a[180:181], v6 offset:8288
  v_mfma_f32_32x32x16_bf16 v[48:63], a[128:131], v[80:83], 0
  v_mfma_f32_16x16x32_bf16 a[48:51], a[164:167], a[120:123], a[48:51]
  s_add_u32 m0, s56, 49152
  v_mfma_f32_32x32x16_bf16 v[112:127], a[148:151], v[84:87], v[112:127]
  v_mfma_f32_16x16x32_bf16 a[52:55], a[160:163], a[108:111], a[52:55]
  ds_read_b64_tr_b16 a[182:183], v6 offset:9312
  buffer_load_dwordx4 v8, s[60:63], s58 offen offset:3072 sc1 lds
  v_mfma_f32_32x32x16_bf16 v[48:63], a[132:135], v[84:87], v[48:63]
  v_mfma_f32_16x16x32_bf16 a[52:55], a[164:167], a[124:127], a[52:55]
  s_add_u32 s58, s58, 0x20000
  v_mfma_f32_32x32x16_bf16 v[112:127], a[152:155], v[88:91], v[112:127]
  s_waitcnt lgkmcnt(4)
  v_mfma_f32_16x16x32_bf16 a[32:35], a[168:171], a[208:211], a[32:35]
  ds_read_b64_tr_b16 a[184:185], v6 offset:32864
  v_mfma_f32_32x32x16_bf16 v[48:63], a[136:139], v[88:91], v[48:63]
  v_mfma_f32_16x16x32_bf16 a[32:35], a[172:175], a[224:227], a[32:35]
  v_mfma_f32_32x32x16_bf16 v[112:127], a[156:159], v[92:95], v[112:127]
  v_mfma_f32_32x32x16_bf16 v[48:63], a[140:143], v[92:95], v[48:63]
  v_mfma_f32_16x16x32_bf16 a[36:39], a[168:171], a[212:215], a[36:39]
  ds_read_b64_tr_b16 a[186:187], v6 offset:33888
  s_waitcnt vmcnt(4)
  buffer_store_dwordx2 v[12:13], v20, s[24:27], s55 offen offset:128 sc1
  buffer_load_dword a240, v0, s[4:7], s3 offen
  v_mfma_f32_16x16x32_bf16 a[36:39], a[172:175], a[228:231], a[36:39]
  v_cvt_pk_bf16_f32 v96, 0, v96
  v_add_f32 v96, 0x358637bd, v96
  v_cvt_pk_bf16_f32 v96, 0, v96
  v_mfma_f32_16x16x32_bf16 a[48:51], a[168:171], a[216:219], a[48:51]
  ds_read_b64_tr_b16 a[188:189], v6 offset:41056
  v_rcp_f32 v96, v96
  v_mfma_f32_16x16x32_bf16 a[48:51], a[172:175], a[232:235], a[48:51]
  v_pk_mul_f32 v[32:33], v[32:33], v[96:97] op_sel_hi:[1,0]
  v_pk_mul_f32 v[34:35], v[34:35], v[96:97] op_sel_hi:[1,0]
  v_pk_mul_f32 v[36:37], v[36:37], v[96:97] op_sel_hi:[1,0]
  v_pk_mul_f32 v[38:39], v[38:39], v[96:97] op_sel_hi:[1,0]
  v_pk_mul_f32 v[40:41], v[40:41], v[96:97] op_sel_hi:[1,0]
  v_pk_mul_f32 v[42:43], v[42:43], v[96:97] op_sel_hi:[1,0]
  v_pk_mul_f32 v[44:45], v[44:45], v[96:97] op_sel_hi:[1,0]
  v_pk_mul_f32 v[46:47], v[46:47], v[96:97] op_sel_hi:[1,0]
  v_mfma_f32_16x16x32_bf16 a[52:55], a[168:171], a[220:223], a[52:55]
  ds_read_b64_tr_b16 a[190:191], v6 offset:42080
  v_cvt_pk_bf16_f32 v100, v32, v33
  v_cvt_pk_bf16_f32 v101, v34, v35
  v_mfma_f32_16x16x32_bf16 a[52:55], a[172:175], a[236:239], a[52:55]
  v_cvt_pk_bf16_f32 v102, v36, v37
  v_cvt_pk_bf16_f32 v103, v38, v39
  s_waitcnt lgkmcnt(4)
  v_mfma_f32_16x16x32_bf16 a[40:43], a[176:179], a[96:99], a[40:43]
  ds_read_b64_tr_b16 a[160:161], v7 offset:32896
  v_cvt_pk_bf16_f32 v104, v40, v41
  v_cvt_pk_bf16_f32 v105, v42, v43
  v_mfma_f32_16x16x32_bf16 a[40:43], a[180:183], a[112:115], a[40:43]
  v_cvt_pk_bf16_f32 v106, v44, v45
  v_cvt_pk_bf16_f32 v107, v46, v47
  v_permlane32_swap_b32 v100, v102
  v_mfma_f32_16x16x32_bf16 a[44:47], a[176:179], a[100:103], a[44:47]
  ds_read_b64_tr_b16 a[162:163], v7 offset:33920
  v_permlane32_swap_b32 v101, v103
  v_permlane32_swap_b32 v104, v106
  v_mfma_f32_16x16x32_bf16 a[44:47], a[180:183], a[116:119], a[44:47]
  v_permlane32_swap_b32 v105, v107
  buffer_store_dwordx4 v[100:103], v9, s[24:27], s48 offen offset:0 sc1
  buffer_store_dwordx4 v[104:107], v9, s[24:27], s48 offen offset:512 sc1
  v_mfma_f32_16x16x32_bf16 a[56:59], a[176:179], a[104:107], a[56:59]
  ds_read_b64_tr_b16 a[164:165], v7 offset:41088
  v_cvt_pk_bf16_f32 v112, 0, v112
  v_add_f32 v112, 0x358637bd, v112
  v_mfma_f32_16x16x32_bf16 a[56:59], a[180:183], a[120:123], a[56:59]
  v_cvt_pk_bf16_f32 v112, 0, v112
  v_rcp_f32 v112, v112
  v_mfma_f32_16x16x32_bf16 a[60:63], a[176:179], a[108:111], a[60:63]
  ds_read_b64_tr_b16 a[166:167], v7 offset:42112
  v_pk_mul_f32 v[48:49], v[48:49], v[112:113] op_sel_hi:[1,0]
  v_pk_mul_f32 v[50:51], v[50:51], v[112:113] op_sel_hi:[1,0]
  v_pk_mul_f32 v[52:53], v[52:53], v[112:113] op_sel_hi:[1,0]
  v_pk_mul_f32 v[54:55], v[54:55], v[112:113] op_sel_hi:[1,0]
  v_pk_mul_f32 v[56:57], v[56:57], v[112:113] op_sel_hi:[1,0]
  v_pk_mul_f32 v[58:59], v[58:59], v[112:113] op_sel_hi:[1,0]
  v_pk_mul_f32 v[60:61], v[60:61], v[112:113] op_sel_hi:[1,0]
  v_pk_mul_f32 v[62:63], v[62:63], v[112:113] op_sel_hi:[1,0]
  v_mfma_f32_16x16x32_bf16 a[60:63], a[180:183], a[124:127], a[60:63]
  v_cvt_pk_bf16_f32 v116, v48, v49
  v_cvt_pk_bf16_f32 v117, v50, v51
  s_waitcnt lgkmcnt(4)
  v_mfma_f32_16x16x32_bf16 a[40:43], a[184:187], a[208:211], a[40:43]
  ds_read_b64_tr_b16 a[168:169], v6 offset:16512
  v_cvt_pk_bf16_f32 v118, v52, v53
  v_cvt_pk_bf16_f32 v119, v54, v55
  v_mfma_f32_16x16x32_bf16 a[40:43], a[188:191], a[224:227], a[40:43]
  v_cvt_pk_bf16_f32 v120, v56, v57
  v_cvt_pk_bf16_f32 v121, v58, v59
  v_cvt_pk_bf16_f32 v122, v60, v61
  v_mfma_f32_16x16x32_bf16 a[44:47], a[184:187], a[212:215], a[44:47]
  ds_read_b64_tr_b16 a[170:171], v6 offset:17536
  v_cvt_pk_bf16_f32 v123, v62, v63
  v_permlane32_swap_b32 v116, v118
  v_mfma_f32_16x16x32_bf16 a[44:47], a[188:191], a[228:231], a[44:47]
  v_permlane32_swap_b32 v117, v119
  v_permlane32_swap_b32 v120, v122
  v_permlane32_swap_b32 v121, v123
  v_mfma_f32_16x16x32_bf16 a[56:59], a[184:187], a[216:219], a[56:59]
  ds_read_b64_tr_b16 a[172:173], v6 offset:24704
  buffer_store_dwordx4 v[116:119], v9, s[24:27], s48 offen offset:2048 sc1
  buffer_store_dwordx4 v[120:123], v9, s[24:27], s48 offen offset:2560 sc1
  v_mfma_f32_16x16x32_bf16 a[56:59], a[188:191], a[232:235], a[56:59]
  v_accvgpr_read_b32 v128, a0
  v_accvgpr_read_b32 v144, a16
  v_accvgpr_read_b32 v129, a1
  v_mfma_f32_16x16x32_bf16 a[60:63], a[184:187], a[220:223], a[60:63]
  ds_read_b64_tr_b16 a[174:175], v6 offset:25728
  v_accvgpr_read_b32 v145, a17
  v_accvgpr_read_b32 v130, a2
  v_mfma_f32_16x16x32_bf16 a[60:63], a[188:191], a[236:239], a[60:63]
  v_accvgpr_read_b32 v146, a18
  v_accvgpr_read_b32 v131, a3
  s_waitcnt lgkmcnt(4)
  v_mfma_f32_16x16x32_bf16 a[64:67], a[160:163], a[96:99], a[64:67]
  ds_read_b64_tr_b16 a[176:177], v6 offset:128
  v_accvgpr_read_b32 v147, a19
  v_accvgpr_read_b32 v132, a4
  v_mfma_f32_16x16x32_bf16 a[64:67], a[164:167], a[112:115], a[64:67]
  v_accvgpr_read_b32 v148, a20
  v_accvgpr_read_b32 v133, a5
  v_accvgpr_read_b32 v149, a21
  v_mfma_f32_16x16x32_bf16 a[68:71], a[160:163], a[100:103], a[68:71]
  ds_read_b64_tr_b16 a[178:179], v6 offset:1152
  v_accvgpr_read_b32 v134, a6
  v_accvgpr_read_b32 v150, a22
  v_mfma_f32_16x16x32_bf16 a[68:71], a[164:167], a[116:119], a[68:71]
  v_accvgpr_read_b32 v135, a7
  v_accvgpr_read_b32 v151, a23
  v_accvgpr_read_b32 v136, a8
  v_mfma_f32_16x16x32_bf16 a[80:83], a[160:163], a[104:107], a[80:83]
  ds_read_b64_tr_b16 a[180:181], v6 offset:8320
  v_accvgpr_read_b32 v152, a24
  v_accvgpr_read_b32 v137, a9
  v_mfma_f32_16x16x32_bf16 a[80:83], a[164:167], a[120:123], a[80:83]
  v_accvgpr_read_b32 v153, a25
  v_accvgpr_read_b32 v138, a10
  v_accvgpr_read_b32 v154, a26
  v_mfma_f32_16x16x32_bf16 a[84:87], a[160:163], a[108:111], a[84:87]
  ds_read_b64_tr_b16 a[182:183], v6 offset:9344
  v_accvgpr_read_b32 v139, a11
  v_accvgpr_read_b32 v155, a27
  v_mfma_f32_16x16x32_bf16 a[84:87], a[164:167], a[124:127], a[84:87]
  v_accvgpr_read_b32 v140, a12
  v_accvgpr_read_b32 v156, a28
  s_waitcnt lgkmcnt(4)
  v_mfma_f32_16x16x32_bf16 a[64:67], a[168:171], a[208:211], a[64:67]
  ds_read_b64_tr_b16 a[184:185], v6 offset:32896
  v_accvgpr_read_b32 v141, a13
  v_accvgpr_read_b32 v157, a29
  v_mfma_f32_16x16x32_bf16 a[64:67], a[172:175], a[224:227], a[64:67]
  v_accvgpr_read_b32 v142, a14
  v_accvgpr_read_b32 v158, a30
  v_accvgpr_read_b32 v143, a15
  v_mfma_f32_16x16x32_bf16 a[68:71], a[168:171], a[212:215], a[68:71]
  ds_read_b64_tr_b16 a[186:187], v6 offset:33920
  v_accvgpr_read_b32 v159, a31
  v_pk_mul_f32 v[128:129], v[128:129], v[136:137]
  v_pk_mul_f32 v[144:145], v[144:145], v[152:153]
  v_pk_mul_f32 v[130:131], v[130:131], v[138:139]
  v_pk_mul_f32 v[146:147], v[146:147], v[154:155]
  v_pk_mul_f32 v[132:133], v[132:133], v[140:141]
  v_pk_mul_f32 v[148:149], v[148:149], v[156:157]
  v_pk_mul_f32 v[134:135], v[134:135], v[142:143]
  v_pk_mul_f32 v[150:151], v[150:151], v[158:159]
  v_mfma_f32_16x16x32_bf16 a[68:71], a[172:175], a[228:231], a[68:71]
  v_cvt_pk_bf16_f32 v136, v128, v129
  v_cvt_pk_bf16_f32 v152, v144, v145
  v_cvt_pk_bf16_f32 v137, v130, v131
  v_mfma_f32_16x16x32_bf16 a[80:83], a[168:171], a[216:219], a[80:83]
  ds_read_b64_tr_b16 a[188:189], v6 offset:41088
  v_cvt_pk_bf16_f32 v153, v146, v147
  v_cvt_pk_bf16_f32 v138, v132, v133
  v_mfma_f32_16x16x32_bf16 a[80:83], a[172:175], a[232:235], a[80:83]
  v_cvt_pk_bf16_f32 v154, v148, v149
  v_cvt_pk_bf16_f32 v139, v134, v135
  v_cvt_pk_bf16_f32 v155, v150, v151
  v_mfma_f32_16x16x32_bf16 a[84:87], a[168:171], a[220:223], a[84:87]
  ds_read_b64_tr_b16 a[190:191], v6 offset:42112
  v_permlane16_swap_b32 v136, v138
  v_permlane16_swap_b32 v152, v154
  v_mfma_f32_16x16x32_bf16 a[84:87], a[172:175], a[236:239], a[84:87]
  v_permlane16_swap_b32 v137, v139
  v_permlane16_swap_b32 v153, v155
  s_waitcnt lgkmcnt(4)
  v_mfma_f32_16x16x32_bf16 a[72:75], a[176:179], a[96:99], a[72:75]
  ds_read_b64_tr_b16 a[160:161], v7 offset:32928
  buffer_store_dwordx4 v[136:139], v9, s[24:27], s43 offen offset:0 sc1
  buffer_store_dwordx4 v[152:155], v9, s[24:27], s43 offen offset:2048 sc1
  v_mfma_f32_16x16x32_bf16 a[72:75], a[180:183], a[112:115], a[72:75]
  v_accvgpr_read_b32 v160, a32
  v_accvgpr_read_b32 v176, a48
  v_accvgpr_read_b32 v161, a33
  v_mfma_f32_16x16x32_bf16 a[76:79], a[176:179], a[100:103], a[76:79]
  ds_read_b64_tr_b16 a[162:163], v7 offset:33952
  v_accvgpr_read_b32 v177, a49
  v_accvgpr_read_b32 v162, a34
  v_mfma_f32_16x16x32_bf16 a[76:79], a[180:183], a[116:119], a[76:79]
  v_accvgpr_read_b32 v178, a50
  v_accvgpr_read_b32 v163, a35
  v_accvgpr_read_b32 v179, a51
  v_mfma_f32_16x16x32_bf16 a[88:91], a[176:179], a[104:107], a[88:91]
  ds_read_b64_tr_b16 a[164:165], v7 offset:41120
  v_accvgpr_read_b32 v164, a36
  v_accvgpr_read_b32 v180, a52
  v_mfma_f32_16x16x32_bf16 a[88:91], a[180:183], a[120:123], a[88:91]
  v_accvgpr_read_b32 v165, a37
  v_accvgpr_read_b32 v181, a53
  v_accvgpr_read_b32 v166, a38
  v_mfma_f32_16x16x32_bf16 a[92:95], a[176:179], a[108:111], a[92:95]
  ds_read_b64_tr_b16 a[166:167], v7 offset:42144
  v_accvgpr_read_b32 v182, a54
  v_accvgpr_read_b32 v167, a39
  v_mfma_f32_16x16x32_bf16 a[92:95], a[180:183], a[124:127], a[92:95]
  v_accvgpr_read_b32 v183, a55
  v_accvgpr_read_b32 v168, a40
  s_waitcnt lgkmcnt(4)
  v_mfma_f32_16x16x32_bf16 a[72:75], a[184:187], a[208:211], a[72:75]
  ds_read_b64_tr_b16 a[168:169], v6 offset:16544
  v_accvgpr_read_b32 v184, a56
  v_accvgpr_read_b32 v169, a41
  v_mfma_f32_16x16x32_bf16 a[72:75], a[188:191], a[224:227], a[72:75]
  v_accvgpr_read_b32 v185, a57
  v_accvgpr_read_b32 v170, a42
  v_accvgpr_read_b32 v186, a58
  v_mfma_f32_16x16x32_bf16 a[76:79], a[184:187], a[212:215], a[76:79]
  ds_read_b64_tr_b16 a[170:171], v6 offset:17568
  v_accvgpr_read_b32 v171, a43
  v_accvgpr_read_b32 v187, a59
  v_mfma_f32_16x16x32_bf16 a[76:79], a[188:191], a[228:231], a[76:79]
  v_accvgpr_read_b32 v172, a44
  v_accvgpr_read_b32 v188, a60
  v_accvgpr_read_b32 v173, a45
  v_mfma_f32_16x16x32_bf16 a[88:91], a[184:187], a[216:219], a[88:91]
  ds_read_b64_tr_b16 a[172:173], v6 offset:24736
  v_accvgpr_read_b32 v189, a61
  v_accvgpr_read_b32 v174, a46
  v_mfma_f32_16x16x32_bf16 a[88:91], a[188:191], a[232:235], a[88:91]
  v_accvgpr_read_b32 v190, a62
  v_accvgpr_read_b32 v175, a47
  v_accvgpr_read_b32 v191, a63
  v_mfma_f32_16x16x32_bf16 a[92:95], a[184:187], a[220:223], a[92:95]
  ds_read_b64_tr_b16 a[174:175], v6 offset:25760
  v_pk_mul_f32 v[160:161], v[160:161], v[168:169]
  v_pk_mul_f32 v[176:177], v[176:177], v[184:185]
  v_pk_mul_f32 v[162:163], v[162:163], v[170:171]
  v_pk_mul_f32 v[178:179], v[178:179], v[186:187]
  v_pk_mul_f32 v[164:165], v[164:165], v[172:173]
  v_pk_mul_f32 v[180:181], v[180:181], v[188:189]
  v_pk_mul_f32 v[166:167], v[166:167], v[174:175]
  v_pk_mul_f32 v[182:183], v[182:183], v[190:191]
  v_mfma_f32_16x16x32_bf16 a[92:95], a[188:191], a[236:239], a[92:95]
  v_cvt_pk_bf16_f32 v168, v160, v161
  v_cvt_pk_bf16_f32 v184, v176, v177
  s_waitcnt lgkmcnt(4)
  v_mfma_f32_16x16x32_bf16 v[192:195], a[160:163], a[96:99], v[192:195]
  ds_read_b64_tr_b16 a[176:177], v6 offset:160
  v_cvt_pk_bf16_f32 v169, v162, v163
  v_cvt_pk_bf16_f32 v185, v178, v179
  v_mfma_f32_16x16x32_bf16 v[192:195], a[164:167], a[112:115], v[192:195]
  v_cvt_pk_bf16_f32 v170, v164, v165
  v_cvt_pk_bf16_f32 v186, v180, v181
  v_cvt_pk_bf16_f32 v171, v166, v167
  v_mfma_f32_16x16x32_bf16 v[196:199], a[160:163], a[100:103], v[196:199]
  ds_read_b64_tr_b16 a[178:179], v6 offset:1184
  v_cvt_pk_bf16_f32 v187, v182, v183
  v_permlane16_swap_b32 v168, v170
  v_mfma_f32_16x16x32_bf16 v[196:199], a[164:167], a[116:119], v[196:199]
  v_permlane16_swap_b32 v184, v186
  v_permlane16_swap_b32 v169, v171
  v_permlane16_swap_b32 v185, v187
  v_mfma_f32_16x16x32_bf16 v[208:211], a[160:163], a[104:107], v[208:211]
  ds_read_b64_tr_b16 a[180:181], v6 offset:8352
  buffer_store_dwordx4 v[168:171], v9, s[24:27], s44 offen offset:0 sc1
  buffer_store_dwordx4 v[184:187], v9, s[24:27], s44 offen offset:2048 sc1
  v_mfma_f32_16x16x32_bf16 v[208:211], a[164:167], a[120:123], v[208:211]
  s_waitcnt vmcnt(4)
  buffer_store_dwordx2 v[12:13], v20, s[24:27], s55 offen offset:256 sc1
  v_accvgpr_read_b32 v128, a64
  v_accvgpr_read_b32 v144, a80
  v_mfma_f32_16x16x32_bf16 v[212:215], a[160:163], a[108:111], v[212:215]
  ds_read_b64_tr_b16 a[182:183], v6 offset:9376
  v_accvgpr_read_b32 v129, a65
  v_accvgpr_read_b32 v145, a81
  v_mfma_f32_16x16x32_bf16 v[212:215], a[164:167], a[124:127], v[212:215]
  v_accvgpr_read_b32 v130, a66
  v_accvgpr_read_b32 v146, a82
  s_waitcnt lgkmcnt(4)
  v_mfma_f32_16x16x32_bf16 v[192:195], a[168:171], a[208:211], v[192:195]
  ds_read_b64_tr_b16 a[184:185], v6 offset:32928
  v_accvgpr_read_b32 v131, a67
  v_accvgpr_read_b32 v147, a83
  v_mfma_f32_16x16x32_bf16 v[192:195], a[172:175], a[224:227], v[192:195]
  v_accvgpr_read_b32 v132, a68
  v_accvgpr_read_b32 v148, a84
  v_accvgpr_read_b32 v133, a69
  v_mfma_f32_16x16x32_bf16 v[196:199], a[168:171], a[212:215], v[196:199]
  ds_read_b64_tr_b16 a[186:187], v6 offset:33952
  v_accvgpr_read_b32 v149, a85
  v_accvgpr_read_b32 v134, a70
  v_mfma_f32_16x16x32_bf16 v[196:199], a[172:175], a[228:231], v[196:199]
  v_accvgpr_read_b32 v150, a86
  v_accvgpr_read_b32 v135, a71
  v_accvgpr_read_b32 v151, a87
  v_mfma_f32_16x16x32_bf16 v[208:211], a[168:171], a[216:219], v[208:211]
  ds_read_b64_tr_b16 a[188:189], v6 offset:41120
  v_accvgpr_read_b32 v136, a72
  v_accvgpr_read_b32 v152, a88
  v_mfma_f32_16x16x32_bf16 v[208:211], a[172:175], a[232:235], v[208:211]
  v_accvgpr_read_b32 v137, a73
  v_accvgpr_read_b32 v153, a89
  v_accvgpr_read_b32 v138, a74
  v_mfma_f32_16x16x32_bf16 v[212:215], a[168:171], a[220:223], v[212:215]
  ds_read_b64_tr_b16 a[190:191], v6 offset:42144
  v_accvgpr_read_b32 v154, a90
  v_accvgpr_read_b32 v139, a75
  v_mfma_f32_16x16x32_bf16 v[212:215], a[172:175], a[236:239], v[212:215]
  v_accvgpr_read_b32 v155, a91
  v_accvgpr_read_b32 v140, a76
  s_waitcnt lgkmcnt(4)
  v_mfma_f32_16x16x32_bf16 v[200:203], a[176:179], a[96:99], v[200:203]
  ds_read_b64_tr_b16 a[160:161], v7 offset:32960
  v_accvgpr_read_b32 v156, a92
  v_accvgpr_read_b32 v141, a77
  v_mfma_f32_16x16x32_bf16 v[200:203], a[180:183], a[112:115], v[200:203]
  v_accvgpr_read_b32 v157, a93
  v_accvgpr_read_b32 v142, a78
  v_accvgpr_read_b32 v158, a94
  v_mfma_f32_16x16x32_bf16 v[204:207], a[176:179], a[100:103], v[204:207]
  ds_read_b64_tr_b16 a[162:163], v7 offset:33984
  v_accvgpr_read_b32 v143, a79
  v_accvgpr_read_b32 v159, a95
  v_mfma_f32_16x16x32_bf16 v[204:207], a[180:183], a[116:119], v[204:207]
  v_pk_mul_f32 v[128:129], v[128:129], v[136:137]
  v_pk_mul_f32 v[144:145], v[144:145], v[152:153]
  v_pk_mul_f32 v[130:131], v[130:131], v[138:139]
  v_pk_mul_f32 v[146:147], v[146:147], v[154:155]
  v_pk_mul_f32 v[132:133], v[132:133], v[140:141]
  v_pk_mul_f32 v[148:149], v[148:149], v[156:157]
  v_pk_mul_f32 v[134:135], v[134:135], v[142:143]
  v_pk_mul_f32 v[150:151], v[150:151], v[158:159]
  v_mfma_f32_16x16x32_bf16 v[216:219], a[176:179], a[104:107], v[216:219]
  ds_read_b64_tr_b16 a[164:165], v7 offset:41152
  v_cvt_pk_bf16_f32 v136, v128, v129
  v_cvt_pk_bf16_f32 v152, v144, v145
  v_mfma_f32_16x16x32_bf16 v[216:219], a[180:183], a[120:123], v[216:219]
  v_cvt_pk_bf16_f32 v137, v130, v131
  v_cvt_pk_bf16_f32 v153, v146, v147
  v_cvt_pk_bf16_f32 v138, v132, v133
  v_mfma_f32_16x16x32_bf16 v[220:223], a[176:179], a[108:111], v[220:223]
  ds_read_b64_tr_b16 a[166:167], v7 offset:42176
  v_cvt_pk_bf16_f32 v154, v148, v149
  v_cvt_pk_bf16_f32 v139, v134, v135
  v_mfma_f32_16x16x32_bf16 v[220:223], a[180:183], a[124:127], v[220:223]
  v_cvt_pk_bf16_f32 v155, v150, v151
  v_permlane16_swap_b32 v136, v138
  s_waitcnt lgkmcnt(4)
  v_mfma_f32_16x16x32_bf16 v[200:203], a[184:187], a[208:211], v[200:203]
  ds_read_b64_tr_b16 a[168:169], v6 offset:16576
  v_permlane16_swap_b32 v152, v154
  v_permlane16_swap_b32 v137, v139
  v_mfma_f32_16x16x32_bf16 v[200:203], a[188:191], a[224:227], v[200:203]
  v_permlane16_swap_b32 v153, v155
  buffer_store_dwordx4 v[136:139], v9, s[24:27], s45 offen offset:0 sc1
  buffer_store_dwordx4 v[152:155], v9, s[24:27], s45 offen offset:2048 sc1
  v_mfma_f32_16x16x32_bf16 v[204:207], a[184:187], a[212:215], v[204:207]
  ds_read_b64_tr_b16 a[170:171], v6 offset:17600
  buffer_load_dwordx2 v[16:17], v4, s[24:27], s29 offen sc1
  s_barrier
  v_mfma_f32_16x16x32_bf16 v[204:207], a[188:191], a[228:231], v[204:207]
  v_add_u32 v18, 100352, v21
  ds_read_b128 a[128:131], v18 offset:0
  ds_read_b128 a[132:135], v18 offset:8192
  v_mfma_f32_16x16x32_bf16 v[216:219], a[184:187], a[216:219], v[216:219]
  ds_read_b64_tr_b16 a[172:173], v6 offset:24768
  ds_read_b128 a[136:139], v18 offset:1024
  ds_read_b128 a[140:143], v18 offset:9216
  v_mfma_f32_16x16x32_bf16 v[216:219], a[188:191], a[232:235], v[216:219]
  v_mfma_f32_16x16x32_bf16 v[220:223], a[184:187], a[220:223], v[220:223]
  ds_read_b64_tr_b16 a[174:175], v6 offset:25792
  v_mfma_f32_16x16x32_bf16 v[220:223], a[188:191], a[236:239], v[220:223]
  s_waitcnt lgkmcnt(8)
  v_mfma_f32_16x16x32_bf16 v[224:227], a[160:163], a[96:99], v[224:227]
  ds_read_b64_tr_b16 a[176:177], v6 offset:192
  v_pk_mul_f32 v[192:193], v[192:193], v[200:201]
  s_nop 0
  v_pk_mul_f32 v[208:209], v[208:209], v[216:217]
  v_pk_mul_f32 v[194:195], v[194:195], v[202:203]
  v_pk_mul_f32 v[210:211], v[210:211], v[218:219]
  v_pk_mul_f32 v[196:197], v[196:197], v[204:205]
  v_pk_mul_f32 v[212:213], v[212:213], v[220:221]
  v_pk_mul_f32 v[198:199], v[198:199], v[206:207]
  v_pk_mul_f32 v[214:215], v[214:215], v[222:223]
  v_mfma_f32_16x16x32_bf16 v[224:227], a[164:167], a[112:115], v[224:227]
  v_cvt_pk_bf16_f32 v200, v192, v193
  v_cvt_pk_bf16_f32 v216, v208, v209
  v_cvt_pk_bf16_f32 v201, v194, v195
  v_mfma_f32_16x16x32_bf16 v[228:231], a[160:163], a[100:103], v[228:231]
  ds_read_b64_tr_b16 a[178:179], v6 offset:1216
  v_cvt_pk_bf16_f32 v217, v210, v211
  v_cvt_pk_bf16_f32 v202, v196, v197
  v_mfma_f32_16x16x32_bf16 v[228:231], a[164:167], a[116:119], v[228:231]
  v_cvt_pk_bf16_f32 v218, v212, v213
  v_cvt_pk_bf16_f32 v203, v198, v199
  v_cvt_pk_bf16_f32 v219, v214, v215
  v_mfma_f32_16x16x32_bf16 v[240:243], a[160:163], a[104:107], v[240:243]
  ds_read_b64_tr_b16 a[180:181], v6 offset:8384
  v_permlane16_swap_b32 v200, v202
  v_permlane16_swap_b32 v216, v218
  v_mfma_f32_16x16x32_bf16 v[240:243], a[164:167], a[120:123], v[240:243]
  v_permlane16_swap_b32 v201, v203
  v_permlane16_swap_b32 v217, v219
  buffer_store_dwordx4 v[200:203], v9, s[24:27], s46 offen offset:0 sc1
  v_mfma_f32_16x16x32_bf16 v[244:247], a[160:163], a[108:111], v[244:247]
  ds_read_b64_tr_b16 a[182:183], v6 offset:9408
  buffer_store_dwordx4 v[216:219], v9, s[24:27], s46 offen offset:2048 sc1
  s_waitcnt vmcnt(6)
  buffer_store_dwordx2 v[12:13], v20, s[24:27], s55 offen offset:72 sc1
  v_mfma_f32_16x16x32_bf16 v[244:247], a[164:167], a[124:127], v[244:247]
  s_waitcnt lgkmcnt(4)
  v_mfma_f32_16x16x32_bf16 v[224:227], a[168:171], a[208:211], v[224:227]
  ds_read_b64_tr_b16 a[184:185], v6 offset:32960
  v_mfma_f32_16x16x32_bf16 v[224:227], a[172:175], a[224:227], v[224:227]
  v_mfma_f32_16x16x32_bf16 v[228:231], a[168:171], a[212:215], v[228:231]
  ds_read_b64_tr_b16 a[186:187], v6 offset:33984
  v_mfma_f32_16x16x32_bf16 v[228:231], a[172:175], a[228:231], v[228:231]
  v_mfma_f32_16x16x32_bf16 v[240:243], a[168:171], a[216:219], v[240:243]
  ds_read_b64_tr_b16 a[188:189], v6 offset:41152
  v_mfma_f32_16x16x32_bf16 v[240:243], a[172:175], a[232:235], v[240:243]
  v_mfma_f32_16x16x32_bf16 v[244:247], a[168:171], a[220:223], v[244:247]
  ds_read_b64_tr_b16 a[190:191], v6 offset:42176
  v_mfma_f32_16x16x32_bf16 v[244:247], a[172:175], a[236:239], v[244:247]
  s_waitcnt lgkmcnt(4)
  v_mfma_f32_16x16x32_bf16 v[232:235], a[176:179], a[96:99], v[232:235]
  v_mfma_f32_16x16x32_bf16 v[232:235], a[180:183], a[112:115], v[232:235]
  v_mfma_f32_16x16x32_bf16 v[236:239], a[176:179], a[100:103], v[236:239]
  v_mfma_f32_16x16x32_bf16 v[236:239], a[180:183], a[116:119], v[236:239]
  v_mfma_f32_16x16x32_bf16 v[248:251], a[176:179], a[104:107], v[248:251]
  v_mfma_f32_16x16x32_bf16 v[248:251], a[180:183], a[120:123], v[248:251]
  v_mfma_f32_16x16x32_bf16 v[252:255], a[176:179], a[108:111], v[252:255]
  v_mfma_f32_16x16x32_bf16 v[252:255], a[180:183], a[124:127], v[252:255]
  s_waitcnt lgkmcnt(0)
  v_mfma_f32_16x16x32_bf16 v[232:235], a[184:187], a[208:211], v[232:235]
  s_waitcnt vmcnt(3)
  v_cmp_ne_u64 vcc, v[16:17], v[12:13]
  s_nop 0
  s_cmp_eq_u64 vcc, 0
  s_cselect_b32 s64, 1, 0
  v_mfma_f32_16x16x32_bf16 v[232:235], a[188:191], a[224:227], v[232:235]
  s_cmp_eq_u32 s64, 0
  s_cbranch_scc1 L_gb_ne0
  buffer_load_dwordx4 a[0:3], v3, s[8:11], s59 offen offset:0 sc1
  buffer_load_dwordx4 a[4:7], v3, s[8:11], s59 offen offset:1024 sc1
  buffer_load_dwordx4 a[8:11], v3, s[8:11], s59 offen offset:2048 sc1
  buffer_load_dwordx4 a[12:15], v3, s[8:11], s59 offen offset:3072 sc1
  s_add_u32 s59, s59, 0x20000
  buffer_load_dwordx4 a[16:19], v3, s[8:11], s59 offen offset:0 sc1
  buffer_load_dwordx4 a[20:23], v3, s[8:11], s59 offen offset:1024 sc1
  buffer_load_dwordx4 a[24:27], v3, s[8:11], s59 offen offset:2048 sc1
  buffer_load_dwordx4 a[28:31], v3, s[8:11], s59 offen offset:3072 sc1
  s_add_u32 s59, s59, 0x20000
L_gb_ne0:
  v_mfma_f32_16x16x32_bf16 v[236:239], a[184:187], a[212:215], v[236:239]
  v_mfma_f32_16x16x32_bf16 v[236:239], a[188:191], a[228:231], v[236:239]
  v_mfma_f32_16x16x32_bf16 v[248:251], a[184:187], a[216:219], v[248:251]
  v_mfma_f32_16x16x32_bf16 v[248:251], a[188:191], a[232:235], v[248:251]
  v_mfma_f32_16x16x32_bf16 v[252:255], a[184:187], a[220:223], v[252:255]
  v_mfma_f32_16x16x32_bf16 v[252:255], a[188:191], a[236:239], v[252:255]
  v_mov_b32 v28, 0
  v_mov_b32 v22, v12
  v_mov_b32 v23, v13
  v_mov_b32 v7, v15
  s_waitcnt lgkmcnt(0)
  v_pk_mul_f32 v[224:225], v[224:225], v[232:233]
  v_pk_mul_f32 v[240:241], v[240:241], v[248:249]
  v_pk_mul_f32 v[226:227], v[226:227], v[234:235]
  v_pk_mul_f32 v[242:243], v[242:243], v[250:251]
  v_pk_mul_f32 v[228:229], v[228:229], v[236:237]
  v_pk_mul_f32 v[244:245], v[244:245], v[252:253]
  v_pk_mul_f32 v[230:231], v[230:231], v[238:239]
  v_pk_mul_f32 v[246:247], v[246:247], v[254:255]
  v_cvt_pk_bf16_f32 v232, v224, v225
  v_cvt_pk_bf16_f32 v248, v240, v241
  v_cvt_pk_bf16_f32 v233, v226, v227
  v_cvt_pk_bf16_f32 v249, v242, v243
  v_cvt_pk_bf16_f32 v234, v228, v229
  v_cvt_pk_bf16_f32 v250, v244, v245
  v_cvt_pk_bf16_f32 v235, v230, v231
  v_cvt_pk_bf16_f32 v251, v246, v247
  v_permlane16_swap_b32 v232, v234
  v_permlane16_swap_b32 v248, v250
  v_permlane16_swap_b32 v233, v235
  v_permlane16_swap_b32 v249, v251
  buffer_store_dwordx4 v[232:235], v9, s[24:27], s47 offen offset:0 sc1
  buffer_store_dwordx4 v[248:251], v9, s[24:27], s47 offen offset:2048 sc1
  s_cmp_eq_u32 s64, 1
  s_cbranch_scc1 L_gb_go
  s_mov_b32 s37, 0
L_gb_hp:
  buffer_load_dwordx2 v[16:17], v4, s[24:27], s29 offen sc1
  s_waitcnt vmcnt(0)
  v_cmp_ne_u64 vcc, v[16:17], v[12:13]
  s_add_u32 s37, s37, 1
  s_cmp_eq_u64 vcc, 0
  s_cbranch_scc1 L_gb_hok
  s_sleep 4
  s_cmp_lt_u32 s37, 0x200000
  s_cbranch_scc1 L_gb_hp
L_gb_hok:
  buffer_load_dwordx4 a[0:3], v3, s[8:11], s59 offen offset:0 sc1
  buffer_load_dwordx4 a[4:7], v3, s[8:11], s59 offen offset:1024 sc1
  buffer_load_dwordx4 a[8:11], v3, s[8:11], s59 offen offset:2048 sc1
  buffer_load_dwordx4 a[12:15], v3, s[8:11], s59 offen offset:3072 sc1
  s_add_u32 s59, s59, 0x20000
  buffer_load_dwordx4 a[16:19], v3, s[8:11], s59 offen offset:0 sc1
  buffer_load_dwordx4 a[20:23], v3, s[8:11], s59 offen offset:1024 sc1
  buffer_load_dwordx4 a[24:27], v3, s[8:11], s59 offen offset:2048 sc1
  buffer_load_dwordx4 a[28:31], v3, s[8:11], s59 offen offset:3072 sc1
  s_add_u32 s59, s59, 0x20000
  buffer_load_dwordx4 a[32:35], v3, s[8:11], s59 offen offset:0 sc1
  buffer_load_dwordx4 a[36:39], v3, s[8:11], s59 offen offset:1024 sc1
  buffer_load_dwordx4 a[40:43], v3, s[8:11], s59 offen offset:2048 sc1
  buffer_load_dwordx4 a[44:47], v3, s[8:11], s59 offen offset:3072 sc1
  s_add_u32 s59, s59, 0x20000
  buffer_load_dwordx4 a[48:51], v3, s[8:11], s59 offen offset:0 sc1
  buffer_load_dwordx4 a[52:55], v3, s[8:11], s59 offen offset:1024 sc1
  buffer_load_dwordx4 a[56:59], v3, s[8:11], s59 offen offset:2048 sc1
  buffer_load_dwordx4 a[60:63], v3, s[8:11], s59 offen offset:3072 sc1
  s_add_u32 s59, s59, 0x20000
  s_waitcnt vmcnt(8)
  s_branch L_gb_go2
L_gb_go:
  buffer_load_dwordx4 a[32:35], v3, s[8:11], s59 offen offset:0 sc1
  buffer_load_dwordx4 a[36:39], v3, s[8:11], s59 offen offset:1024 sc1
  buffer_load_dwordx4 a[40:43], v3, s[8:11], s59 offen offset:2048 sc1
  buffer_load_dwordx4 a[44:47], v3, s[8:11], s59 offen offset:3072 sc1
  s_add_u32 s59, s59, 0x20000
  buffer_load_dwordx4 a[48:51], v3, s[8:11], s59 offen offset:0 sc1
  buffer_load_dwordx4 a[52:55], v3, s[8:11], s59 offen offset:1024 sc1
  buffer_load_dwordx4 a[56:59], v3, s[8:11], s59 offen offset:2048 sc1
  buffer_load_dwordx4 a[60:63], v3, s[8:11], s59 offen offset:3072 sc1
  s_add_u32 s59, s59, 0x20000
L_gb_go2:
  s_waitcnt vmcnt(10)
  v_mfma_f32_16x16x32_bf16 v[128:131], a[128:131], a[0:3], 0
  ds_read_b128 a[144:147], v18 offset:2048
  v_mfma_f32_16x16x32_bf16 v[128:131], a[132:135], a[16:19], v[128:131]
  v_mfma_f32_16x16x32_bf16 v[136:139], a[128:131], a[4:7], 0
  buffer_load_dwordx4 a[64:67], v3, s[8:11], s59 offen offset:0 sc1
  v_mfma_f32_16x16x32_bf16 v[136:139], a[132:135], a[20:23], v[136:139]
  v_mfma_f32_16x16x32_bf16 v[144:147], a[128:131], a[8:11], 0
  ds_read_b128 a[148:151], v18 offset:10240
  v_mfma_f32_16x16x32_bf16 v[144:147], a[132:135], a[24:27], v[144:147]
  s_add_u32 m0, s56, 65536
  v_mfma_f32_16x16x32_bf16 v[152:155], a[128:131], a[12:15], 0
  buffer_load_dwordx4 v2, s[60:63], s58 offen offset:0 sc1 lds
  v_mfma_f32_16x16x32_bf16 v[152:155], a[132:135], a[28:31], v[152:155]
  v_mfma_f32_16x16x32_bf16 v[132:135], a[136:139], a[0:3], 0
  ds_read_b128 a[152:155], v18 offset:3072
  v_mfma_f32_16x16x32_bf16 v[132:135], a[140:143], a[16:19], v[132:135]
  v_mfma_f32_16x16x32_bf16 v[140:143], a[136:139], a[4:7], 0
  buffer_load_dwordx4 a[68:71], v3, s[8:11], s59 offen offset:1024 sc1
  v_mfma_f32_16x16x32_bf16 v[140:143], a[140:143], a[20:23], v[140:143]
  v_mfma_f32_16x16x32_bf16 v[148:151], a[136:139], a[8:11], 0
  ds_read_b128 a[156:159], v18 offset:11264
  v_mfma_f32_16x16x32_bf16 v[148:151], a[140:143], a[24:27], v[148:151]
  v_mfma_f32_16x16x32_bf16 v[156:159], a[136:139], a[12:15], 0
  buffer_load_dwordx4 v2, s[60:63], s58 offen offset:1024 sc1 lds
  v_mfma_f32_16x16x32_bf16 v[156:159], a[140:143], a[28:31], v[156:159]
  s_waitcnt lgkmcnt(2)
  v_mfma_f32_16x16x32_bf16 v[160:163], a[144:147], a[0:3], 0
  ds_read_b128 a[128:131], v18 offset:4096
  v_mfma_f32_16x16x32_bf16 v[160:163], a[148:151], a[16:19], v[160:163]
  v_mfma_f32_16x16x32_bf16 v[168:171], a[144:147], a[4:7], 0
  buffer_load_dwordx4 a[72:75], v3, s[8:11], s59 offen offset:2048 sc1
  v_mfma_f32_16x16x32_bf16 v[168:171], a[148:151], a[20:23], v[168:171]
  v_mfma_f32_16x16x32_bf16 v[176:179], a[144:147], a[8:11], 0
  ds_read_b128 a[132:135], v18 offset:12288
  v_mfma_f32_16x16x32_bf16 v[176:179], a[148:151], a[24:27], v[176:179]
  v_mfma_f32_16x16x32_bf16 v[184:187], a[144:147], a[12:15], 0
  buffer_load_dwordx4 v8, s[60:63], s58 offen offset:2048 sc1 lds
  v_mfma_f32_16x16x32_bf16 v[184:187], a[148:151], a[28:31], v[184:187]
  s_waitcnt lgkmcnt(2)
  v_mfma_f32_16x16x32_bf16 v[164:167], a[152:155], a[0:3], 0
  ds_read_b128 a[136:139], v18 offset:5120
  v_mfma_f32_16x16x32_bf16 v[164:167], a[156:159], a[16:19], v[164:167]
  v_mfma_f32_16x16x32_bf16 v[172:175], a[152:155], a[4:7], 0
  buffer_load_dwordx4 a[76:79], v3, s[8:11], s59 offen offset:3072 sc1
  s_add_u32 s59, s59, 0x20000
  v_mfma_f32_16x16x32_bf16 v[172:175], a[156:159], a[20:23], v[172:175]
  v_mfma_f32_16x16x32_bf16 v[180:183], a[152:155], a[8:11], 0
  ds_read_b128 a[140:143], v18 offset:13312
  v_mfma_f32_16x16x32_bf16 v[180:183], a[156:159], a[24:27], v[180:183]
  v_mfma_f32_16x16x32_bf16 v[188:191], a[152:155], a[12:15], 0
  buffer_load_dwordx4 v8, s[60:63], s58 offen offset:3072 sc1 lds
  s_add_u32 s58, s58, 0x20000
  v_mfma_f32_16x16x32_bf16 v[188:191], a[156:159], a[28:31], v[188:191]
  s_waitcnt lgkmcnt(2)
  v_mfma_f32_16x16x32_bf16 v[192:195], a[128:131], a[0:3], 0
  ds_read_b128 a[144:147], v18 offset:6144
  v_mfma_f32_16x16x32_bf16 v[192:195], a[132:135], a[16:19], v[192:195]
  v_mfma_f32_16x16x32_bf16 v[200:203], a[128:131], a[4:7], 0
  buffer_load_dwordx4 a[80:83], v3, s[8:11], s59 offen offset:0 sc1
  v_mfma_f32_16x16x32_bf16 v[200:203], a[132:135], a[20:23], v[200:203]
  v_mfma_f32_16x16x32_bf16 v[208:211], a[128:131], a[8:11], 0
  ds_read_b128 a[148:151], v18 offset:14336
  v_mfma_f32_16x16x32_bf16 v[208:211], a[132:135], a[24:27], v[208:211]
  v_mfma_f32_16x16x32_bf16 v[216:219], a[128:131], a[12:15], 0
  v_mfma_f32_16x16x32_bf16 v[216:219], a[132:135], a[28:31], v[216:219]
  s_waitcnt lgkmcnt(2)
  v_mfma_f32_16x16x32_bf16 v[196:199], a[136:139], a[0:3], 0
  ds_read_b128 a[152:155], v18 offset:7168
  v_mfma_f32_16x16x32_bf16 v[196:199], a[140:143], a[16:19], v[196:199]
  v_mfma_f32_16x16x32_bf16 v[204:207], a[136:139], a[4:7], 0
  buffer_load_dwordx4 a[84:87], v3, s[8:11], s59 offen offset:1024 sc1
  v_mfma_f32_16x16x32_bf16 v[204:207], a[140:143], a[20:23], v[204:207]
  v_mfma_f32_16x16x32_bf16 v[212:215], a[136:139], a[8:11], 0
  ds_read_b128 a[156:159], v18 offset:15360
  v_mfma_f32_16x16x32_bf16 v[212:215], a[140:143], a[24:27], v[212:215]
  v_mfma_f32_16x16x32_bf16 v[220:223], a[136:139], a[12:15], 0
  v_mfma_f32_16x16x32_bf16 v[220:223], a[140:143], a[28:31], v[220:223]
  s_waitcnt vmcnt(10)
  s_barrier
  buffer_store_dwordx2 v[12:13], v20, s[24:27], s55 offen offset:384 sc1
  s_waitcnt lgkmcnt(2)
  v_mfma_f32_16x16x32_bf16 v[224:227], a[144:147], a[0:3], 0
  ds_read_b128 a[128:131], v18 offset:16384
  v_mfma_f32_16x16x32_bf16 v[224:227], a[148:151], a[16:19], v[224:227]
  v_mfma_f32_16x16x32_bf16 v[232:235], a[144:147], a[4:7], 0
  buffer_load_dwordx4 a[88:91], v3, s[8:11], s59 offen offset:2048 sc1
  v_mfma_f32_16x16x32_bf16 v[232:235], a[148:151], a[20:23], v[232:235]
  v_mfma_f32_16x16x32_bf16 v[240:243], a[144:147], a[8:11], 0
  ds_read_b128 a[132:135], v18 offset:24576
  v_mfma_f32_16x16x32_bf16 v[240:243], a[148:151], a[24:27], v[240:243]
  v_mfma_f32_16x16x32_bf16 v[248:251], a[144:147], a[12:15], 0
  v_mfma_f32_16x16x32_bf16 v[248:251], a[148:151], a[28:31], v[248:251]
  s_waitcnt lgkmcnt(2)
  v_mfma_f32_16x16x32_bf16 v[228:231], a[152:155], a[0:3], 0
  ds_read_b128 a[136:139], v18 offset:17408
  v_mfma_f32_16x16x32_bf16 v[228:231], a[156:159], a[16:19], v[228:231]
  v_mfma_f32_16x16x32_bf16 v[236:239], a[152:155], a[4:7], 0
  buffer_load_dwordx4 a[92:95], v3, s[8:11], s59 offen offset:3072 sc1
  s_add_u32 s59, s59, 0x20000
  v_mfma_f32_16x16x32_bf16 v[236:239], a[156:159], a[20:23], v[236:239]
  v_mfma_f32_16x16x32_bf16 v[244:247], a[152:155], a[8:11], 0
  ds_read_b128 a[140:143], v18 offset:25600
  v_mfma_f32_16x16x32_bf16 v[244:247], a[156:159], a[24:27], v[244:247]
  v_mfma_f32_16x16x32_bf16 v[252:255], a[152:155], a[12:15], 0
  v_mfma_f32_16x16x32_bf16 v[252:255], a[156:159], a[28:31], v[252:255]
  s_cmp_eq_u32 s30, 3
  s_cbranch_scc1 L_gb_in4
  s_branch L_gb_in1
.p2align 6
L_gb_loop:
  v_cmp_ne_u64 vcc, v[22:23], v[12:13]
  s_nop 0
  s_cmp_lg_u64 vcc, 0
  s_cbranch_scc1 L_gb_late0
L_gb_cont0:
  s_waitcnt lgkmcnt(2)
  v_mfma_f32_16x16x32_bf16 v[128:131], a[128:131], a[0:3], v[128:131]
  ds_read_b128 a[144:147], v5 offset:2048
  v_mfma_f32_16x16x32_bf16 v[128:131], a[132:135], a[16:19], v[128:131]
  v_mfma_f32_16x16x32_bf16 v[136:139], a[128:131], a[4:7], v[136:139]
  buffer_load_dwordx4 a[64:67], v3, s[8:11], s59 offen offset:0 sc1
  v_mfma_f32_16x16x32_bf16 v[136:139], a[132:135], a[20:23], v[136:139]
  v_mfma_f32_16x16x32_bf16 v[144:147], a[128:131], a[8:11], v[144:147]
  ds_read_b128 a[148:151], v5 offset:10240
  v_mfma_f32_16x16x32_bf16 v[144:147], a[132:135], a[24:27], v[144:147]
  s_add_u32 m0, s13, 16384
  v_mfma_f32_16x16x32_bf16 v[152:155], a[128:131], a[12:15], v[152:155]
  buffer_load_dwordx4 v2, s[60:63], s58 offen offset:0 sc1 lds
  v_mfma_f32_16x16x32_bf16 v[152:155], a[132:135], a[28:31], v[152:155]
  s_waitcnt lgkmcnt(2)
  v_mfma_f32_16x16x32_bf16 v[132:135], a[136:139], a[0:3], v[132:135]
  ds_read_b128 a[152:155], v5 offset:3072
  v_mfma_f32_16x16x32_bf16 v[132:135], a[140:143], a[16:19], v[132:135]
  v_mfma_f32_16x16x32_bf16 v[140:143], a[136:139], a[4:7], v[140:143]
  buffer_load_dwordx4 a[68:71], v3, s[8:11], s59 offen offset:1024 sc1
  v_mfma_f32_16x16x32_bf16 v[140:143], a[140:143], a[20:23], v[140:143]
  v_mfma_f32_16x16x32_bf16 v[148:151], a[136:139], a[8:11], v[148:151]
  ds_read_b128 a[156:159], v5 offset:11264
  v_mfma_f32_16x16x32_bf16 v[148:151], a[140:143], a[24:27], v[148:151]
  v_mfma_f32_16x16x32_bf16 v[156:159], a[136:139], a[12:15], v[156:159]
  buffer_load_dwordx4 v2, s[60:63], s58 offen offset:1024 sc1 lds
  v_mfma_f32_16x16x32_bf16 v[156:159], a[140:143], a[28:31], v[156:159]
  s_waitcnt lgkmcnt(2)
  v_mfma_f32_16x16x32_bf16 v[160:163], a[144:147], a[0:3], v[160:163]
  ds_read_b128 a[128:131], v5 offset:4096
  v_mfma_f32_16x16x32_bf16 v[160:163], a[148:151], a[16:19], v[160:163]
  v_mfma_f32_16x16x32_bf16 v[168:171], a[144:147], a[4:7], v[168:171]
  buffer_load_dwordx4 a[72:75], v3, s[8:11], s59 offen offset:2048 sc1
  v_mfma_f32_16x16x32_bf16 v[168:171], a[148:151], a[20:23], v[168:171]
  v_mfma_f32_16x16x32_bf16 v[176:179], a[144:147], a[8:11], v[176:179]
  ds_read_b128 a[132:135], v5 offset:12288
  v_mfma_f32_16x16x32_bf16 v[176:179], a[148:151], a[24:27], v[176:179]
  v_mfma_f32_16x16x32_bf16 v[184:187], a[144:147], a[12:15], v[184:187]
  buffer_load_dwordx4 v8, s[60:63], s58 offen offset:2048 sc1 lds
  v_mfma_f32_16x16x32_bf16 v[184:187], a[148:151], a[28:31], v[184:187]
  s_waitcnt lgkmcnt(2)
  v_mfma_f32_16x16x32_bf16 v[164:167], a[152:155], a[0:3], v[164:167]
  ds_read_b128 a[136:139], v5 offset:5120
  v_mfma_f32_16x16x32_bf16 v[164:167], a[156:159], a[16:19], v[164:167]
  v_mfma_f32_16x16x32_bf16 v[172:175], a[152:155], a[4:7], v[172:175]
  buffer_load_dwordx4 a[76:79], v3, s[8:11], s59 offen offset:3072 sc1
  s_add_u32 s59, s59, 0x20000
  v_mfma_f32_16x16x32_bf16 v[172:175], a[156:159], a[20:23], v[172:175]
  v_mfma_f32_16x16x32_bf16 v[180:183], a[152:155], a[8:11], v[180:183]
  ds_read_b128 a[140:143], v5 offset:13312
  v_mfma_f32_16x16x32_bf16 v[180:183], a[156:159], a[24:27], v[180:183]
  v_mfma_f32_16x16x32_bf16 v[188:191], a[152:155], a[12:15], v[188:191]
  buffer_load_dwordx4 v8, s[60:63], s58 offen offset:3072 sc1 lds
  s_add_u32 s58, s58, 0x20000
  v_mfma_f32_16x16x32_bf16 v[188:191], a[156:159], a[28:31], v[188:191]
  s_waitcnt lgkmcnt(2)
  v_mfma_f32_16x16x32_bf16 v[192:195], a[128:131], a[0:3], v[192:195]
  ds_read_b128 a[144:147], v5 offset:6144
  v_mfma_f32_16x16x32_bf16 v[192:195], a[132:135], a[16:19], v[192:195]
  v_mfma_f32_16x16x32_bf16 v[200:203], a[128:131], a[4:7], v[200:203]
  buffer_load_dwordx4 a[80:83], v3, s[8:11], s59 offen offset:0 sc1
  v_mfma_f32_16x16x32_bf16 v[200:203], a[132:135], a[20:23], v[200:203]
  v_mfma_f32_16x16x32_bf16 v[208:211], a[128:131], a[8:11], v[208:211]
  ds_read_b128 a[148:151], v5 offset:14336
  v_mfma_f32_16x16x32_bf16 v[208:211], a[132:135], a[24:27], v[208:211]
  v_mfma_f32_16x16x32_bf16 v[216:219], a[128:131], a[12:15], v[216:219]
  v_mfma_f32_16x16x32_bf16 v[216:219], a[132:135], a[28:31], v[216:219]
  s_waitcnt lgkmcnt(2)
  v_mfma_f32_16x16x32_bf16 v[196:199], a[136:139], a[0:3], v[196:199]
  ds_read_b128 a[152:155], v5 offset:7168
  v_mfma_f32_16x16x32_bf16 v[196:199], a[140:143], a[16:19], v[196:199]
  v_mfma_f32_16x16x32_bf16 v[204:207], a[136:139], a[4:7], v[204:207]
  buffer_load_dwordx4 a[84:87], v3, s[8:11], s59 offen offset:1024 sc1
  v_mfma_f32_16x16x32_bf16 v[204:207], a[140:143], a[20:23], v[204:207]
  v_mfma_f32_16x16x32_bf16 v[212:215], a[136:139], a[8:11], v[212:215]
  ds_read_b128 a[156:159], v5 offset:15360
  v_mfma_f32_16x16x32_bf16 v[212:215], a[140:143], a[24:27], v[212:215]
  v_mfma_f32_16x16x32_bf16 v[220:223], a[136:139], a[12:15], v[220:223]
  v_mfma_f32_16x16x32_bf16 v[220:223], a[140:143], a[28:31], v[220:223]
  s_waitcnt vmcnt(11)
  s_barrier
  s_waitcnt lgkmcnt(2)
  v_mfma_f32_16x16x32_bf16 v[224:227], a[144:147], a[0:3], v[224:227]
  ds_read_b128 a[128:131], v5 offset:16384
  v_mfma_f32_16x16x32_bf16 v[224:227], a[148:151], a[16:19], v[224:227]
  v_mfma_f32_16x16x32_bf16 v[232:235], a[144:147], a[4:7], v[232:235]
  buffer_load_dwordx4 a[88:91], v3, s[8:11], s59 offen offset:2048 sc1
  v_mfma_f32_16x16x32_bf16 v[232:235], a[148:151], a[20:23], v[232:235]
  v_mfma_f32_16x16x32_bf16 v[240:243], a[144:147], a[8:11], v[240:243]
  ds_read_b128 a[132:135], v5 offset:24576
  v_mfma_f32_16x16x32_bf16 v[240:243], a[148:151], a[24:27], v[240:243]
  v_mfma_f32_16x16x32_bf16 v[248:251], a[144:147], a[12:15], v[248:251]
  v_mfma_f32_16x16x32_bf16 v[248:251], a[148:151], a[28:31], v[248:251]
  s_waitcnt lgkmcnt(2)
  v_mfma_f32_16x16x32_bf16 v[228:231], a[152:155], a[0:3], v[228:231]
  ds_read_b128 a[136:139], v5 offset:17408
  v_mfma_f32_16x16x32_bf16 v[228:231], a[156:159], a[16:19], v[228:231]
  v_mfma_f32_16x16x32_bf16 v[236:239], a[152:155], a[4:7], v[236:239]
  buffer_load_dwordx4 a[92:95], v3, s[8:11], s59 offen offset:3072 sc1
  s_add_u32 s59, s59, 0x20000
  v_mfma_f32_16x16x32_bf16 v[236:239], a[156:159], a[20:23], v[236:239]
  v_mfma_f32_16x16x32_bf16 v[244:247], a[152:155], a[8:11], v[244:247]
  ds_read_b128 a[140:143], v5 offset:25600
  v_mfma_f32_16x16x32_bf16 v[244:247], a[156:159], a[24:27], v[244:247]
  v_mfma_f32_16x16x32_bf16 v[252:255], a[152:155], a[12:15], v[252:255]
  v_mfma_f32_16x16x32_bf16 v[252:255], a[156:159], a[28:31], v[252:255]
L_gb_in1:
  s_waitcnt lgkmcnt(2)
  v_mfma_f32_16x16x32_bf16 v[128:131], a[128:131], a[32:35], v[128:131]
  ds_read_b128 a[144:147], v5 offset:18432
  v_mfma_f32_16x16x32_bf16 v[128:131], a[132:135], a[48:51], v[128:131]
  v_mfma_f32_16x16x32_bf16 v[136:139], a[128:131], a[36:39], v[136:139]
  buffer_load_dwordx4 a[0:3], v3, s[8:11], s59 offen offset:0 sc1
  v_mfma_f32_16x16x32_bf16 v[136:139], a[132:135], a[52:55], v[136:139]
  v_mfma_f32_16x16x32_bf16 v[144:147], a[128:131], a[40:43], v[144:147]
  ds_read_b128 a[148:151], v5 offset:26624
  v_mfma_f32_16x16x32_bf16 v[144:147], a[132:135], a[56:59], v[144:147]
  s_add_u32 m0, s13, 32768
  v_mfma_f32_16x16x32_bf16 v[152:155], a[128:131], a[44:47], v[152:155]
  buffer_load_dwordx4 v2, s[60:63], s58 offen offset:0 sc1 lds
  v_mfma_f32_16x16x32_bf16 v[152:155], a[132:135], a[60:63], v[152:155]
  s_waitcnt lgkmcnt(2)
  v_mfma_f32_16x16x32_bf16 v[132:135], a[136:139], a[32:35], v[132:135]
  ds_read_b128 a[152:155], v5 offset:19456
  v_mfma_f32_16x16x32_bf16 v[132:135], a[140:143], a[48:51], v[132:135]
  v_mfma_f32_16x16x32_bf16 v[140:143], a[136:139], a[36:39], v[140:143]
  buffer_load_dwordx4 a[4:7], v3, s[8:11], s59 offen offset:1024 sc1
  v_mfma_f32_16x16x32_bf16 v[140:143], a[140:143], a[52:55], v[140:143]
  v_mfma_f32_16x16x32_bf16 v[148:151], a[136:139], a[40:43], v[148:151]
  ds_read_b128 a[156:159], v5 offset:27648
  v_mfma_f32_16x16x32_bf16 v[148:151], a[140:143], a[56:59], v[148:151]
  v_mfma_f32_16x16x32_bf16 v[156:159], a[136:139], a[44:47], v[156:159]
  buffer_load_dwordx4 v2, s[60:63], s58 offen offset:1024 sc1 lds
  v_mfma_f32_16x16x32_bf16 v[156:159], a[140:143], a[60:63], v[156:159]
  s_waitcnt lgkmcnt(2)
  v_mfma_f32_16x16x32_bf16 v[160:163], a[144:147], a[32:35], v[160:163]
  ds_read_b128 a[128:131], v5 offset:20480
  v_mfma_f32_16x16x32_bf16 v[160:163], a[148:151], a[48:51], v[160:163]
  v_mfma_f32_16x16x32_bf16 v[168:171], a[144:147], a[36:39], v[168:171]
  buffer_load_dwordx4 a[8:11], v3, s[8:11], s59 offen offset:2048 sc1
  v_mfma_f32_16x16x32_bf16 v[168:171], a[148:151], a[52:55], v[168:171]
  v_mfma_f32_16x16x32_bf16 v[176:179], a[144:147], a[40:43], v[176:179]
  ds_read_b128 a[132:135], v5 offset:28672
  v_mfma_f32_16x16x32_bf16 v[176:179], a[148:151], a[56:59], v[176:179]
  v_mfma_f32_16x16x32_bf16 v[184:187], a[144:147], a[44:47], v[184:187]
  buffer_load_dwordx4 v8, s[60:63], s58 offen offset:2048 sc1 lds
  v_mfma_f32_16x16x32_bf16 v[184:187], a[148:151], a[60:63], v[184:187]
  s_waitcnt lgkmcnt(2)
  v_mfma_f32_16x16x32_bf16 v[164:167], a[152:155], a[32:35], v[164:167]
  ds_read_b128 a[136:139], v5 offset:21504
  v_mfma_f32_16x16x32_bf16 v[164:167], a[156:159], a[48:51], v[164:167]
  v_mfma_f32_16x16x32_bf16 v[172:175], a[152:155], a[36:39], v[172:175]
  buffer_load_dwordx4 a[12:15], v3, s[8:11], s59 offen offset:3072 sc1
  s_add_u32 s59, s59, 0x20000
  v_mfma_f32_16x16x32_bf16 v[172:175], a[156:159], a[52:55], v[172:175]
  v_mfma_f32_16x16x32_bf16 v[180:183], a[152:155], a[40:43], v[180:183]
  ds_read_b128 a[140:143], v5 offset:29696
  v_mfma_f32_16x16x32_bf16 v[180:183], a[156:159], a[56:59], v[180:183]
  v_mfma_f32_16x16x32_bf16 v[188:191], a[152:155], a[44:47], v[188:191]
  buffer_load_dwordx4 v8, s[60:63], s58 offen offset:3072 sc1 lds
  s_add_u32 s58, s58, 0x20000
  v_mfma_f32_16x16x32_bf16 v[188:191], a[156:159], a[60:63], v[188:191]
  s_waitcnt lgkmcnt(2)
  v_mfma_f32_16x16x32_bf16 v[192:195], a[128:131], a[32:35], v[192:195]
  ds_read_b128 a[144:147], v5 offset:22528
  v_mfma_f32_16x16x32_bf16 v[192:195], a[132:135], a[48:51], v[192:195]
  v_mfma_f32_16x16x32_bf16 v[200:203], a[128:131], a[36:39], v[200:203]
  buffer_load_dwordx4 a[16:19], v3, s[8:11], s59 offen offset:0 sc1
  v_mfma_f32_16x16x32_bf16 v[200:203], a[132:135], a[52:55], v[200:203]
  v_mfma_f32_16x16x32_bf16 v[208:211], a[128:131], a[40:43], v[208:211]
  ds_read_b128 a[148:151], v5 offset:30720
  v_mfma_f32_16x16x32_bf16 v[208:211], a[132:135], a[56:59], v[208:211]
  v_mfma_f32_16x16x32_bf16 v[216:219], a[128:131], a[44:47], v[216:219]
  v_mfma_f32_16x16x32_bf16 v[216:219], a[132:135], a[60:63], v[216:219]
  s_waitcnt lgkmcnt(2)
  v_mfma_f32_16x16x32_bf16 v[196:199], a[136:139], a[32:35], v[196:199]
  ds_read_b128 a[152:155], v5 offset:23552
  v_mfma_f32_16x16x32_bf16 v[196:199], a[140:143], a[48:51], v[196:199]
  v_mfma_f32_16x16x32_bf16 v[204:207], a[136:139], a[36:39], v[204:207]
  buffer_load_dwordx4 a[20:23], v3, s[8:11], s59 offen offset:1024 sc1
  v_mfma_f32_16x16x32_bf16 v[204:207], a[140:143], a[52:55], v[204:207]
  v_mfma_f32_16x16x32_bf16 v[212:215], a[136:139], a[40:43], v[212:215]
  ds_read_b128 a[156:159], v5 offset:31744
  v_mfma_f32_16x16x32_bf16 v[212:215], a[140:143], a[56:59], v[212:215]
  v_mfma_f32_16x16x32_bf16 v[220:223], a[136:139], a[44:47], v[220:223]
  v_mfma_f32_16x16x32_bf16 v[220:223], a[140:143], a[60:63], v[220:223]
  s_waitcnt vmcnt(10)
  s_barrier
  s_waitcnt lgkmcnt(2)
  v_mfma_f32_16x16x32_bf16 v[224:227], a[144:147], a[32:35], v[224:227]
  ds_read_b128 a[128:131], v5 offset:32768
  v_mfma_f32_16x16x32_bf16 v[224:227], a[148:151], a[48:51], v[224:227]
  v_mfma_f32_16x16x32_bf16 v[232:235], a[144:147], a[36:39], v[232:235]
  buffer_load_dwordx4 a[24:27], v3, s[8:11], s59 offen offset:2048 sc1
  v_mfma_f32_16x16x32_bf16 v[232:235], a[148:151], a[52:55], v[232:235]
  v_mfma_f32_16x16x32_bf16 v[240:243], a[144:147], a[40:43], v[240:243]
  ds_read_b128 a[132:135], v5 offset:40960
  v_mfma_f32_16x16x32_bf16 v[240:243], a[148:151], a[56:59], v[240:243]
  v_mfma_f32_16x16x32_bf16 v[248:251], a[144:147], a[44:47], v[248:251]
  v_mfma_f32_16x16x32_bf16 v[248:251], a[148:151], a[60:63], v[248:251]
  s_waitcnt lgkmcnt(2)
  v_mfma_f32_16x16x32_bf16 v[228:231], a[152:155], a[32:35], v[228:231]
  ds_read_b128 a[136:139], v5 offset:33792
  v_mfma_f32_16x16x32_bf16 v[228:231], a[156:159], a[48:51], v[228:231]
  buffer_load_dwordx2 v[22:23], v11, s[24:27], s31 offen sc1
  v_mfma_f32_16x16x32_bf16 v[236:239], a[152:155], a[36:39], v[236:239]
  buffer_load_dwordx4 a[28:31], v3, s[8:11], s59 offen offset:3072 sc1
  s_add_u32 s59, s59, 0x20000
  v_mfma_f32_16x16x32_bf16 v[236:239], a[156:159], a[52:55], v[236:239]
  v_mfma_f32_16x16x32_bf16 v[244:247], a[152:155], a[40:43], v[244:247]
  ds_read_b128 a[140:143], v5 offset:41984
  v_mfma_f32_16x16x32_bf16 v[244:247], a[156:159], a[56:59], v[244:247]
  v_mfma_f32_16x16x32_bf16 v[252:255], a[152:155], a[44:47], v[252:255]
  v_mfma_f32_16x16x32_bf16 v[252:255], a[156:159], a[60:63], v[252:255]
  s_waitcnt lgkmcnt(2)
  v_mfma_f32_16x16x32_bf16 v[128:131], a[128:131], a[64:67], v[128:131]
  ds_read_b128 a[144:147], v5 offset:34816
  v_mfma_f32_16x16x32_bf16 v[128:131], a[132:135], a[80:83], v[128:131]
  v_mfma_f32_16x16x32_bf16 v[136:139], a[128:131], a[68:71], v[136:139]
  buffer_load_dwordx4 a[32:35], v3, s[8:11], s59 offen offset:0 sc1
  v_mfma_f32_16x16x32_bf16 v[136:139], a[132:135], a[84:87], v[136:139]
  v_mfma_f32_16x16x32_bf16 v[144:147], a[128:131], a[72:75], v[144:147]
  ds_read_b128 a[148:151], v5 offset:43008
  v_mfma_f32_16x16x32_bf16 v[144:147], a[132:135], a[88:91], v[144:147]
  s_add_u32 m0, s12, 0
  v_mfma_f32_16x16x32_bf16 v[152:155], a[128:131], a[76:79], v[152:155]
  buffer_load_dwordx4 v2, s[60:63], s58 offen offset:0 sc1 lds
  v_mfma_f32_16x16x32_bf16 v[152:155], a[132:135], a[92:95], v[152:155]
  s_waitcnt lgkmcnt(2)
  v_mfma_f32_16x16x32_bf16 v[132:135], a[136:139], a[64:67], v[132:135]
  ds_read_b128 a[152:155], v5 offset:35840
  v_mfma_f32_16x16x32_bf16 v[132:135], a[140:143], a[80:83], v[132:135]
  v_mfma_f32_16x16x32_bf16 v[140:143], a[136:139], a[68:71], v[140:143]
  buffer_load_dwordx4 a[36:39], v3, s[8:11], s59 offen offset:1024 sc1
  v_mfma_f32_16x16x32_bf16 v[140:143], a[140:143], a[84:87], v[140:143]
  v_mfma_f32_16x16x32_bf16 v[148:151], a[136:139], a[72:75], v[148:151]
  ds_read_b128 a[156:159], v5 offset:44032
  v_mfma_f32_16x16x32_bf16 v[148:151], a[140:143], a[88:91], v[148:151]
  v_mfma_f32_16x16x32_bf16 v[156:159], a[136:139], a[76:79], v[156:159]
  buffer_load_dwordx4 v2, s[60:63], s58 offen offset:1024 sc1 lds
  v_mfma_f32_16x16x32_bf16 v[156:159], a[140:143], a[92:95], v[156:159]
  s_waitcnt lgkmcnt(2)
  v_mfma_f32_16x16x32_bf16 v[160:163], a[144:147], a[64:67], v[160:163]
  ds_read_b128 a[128:131], v5 offset:36864
  v_mfma_f32_16x16x32_bf16 v[160:163], a[148:151], a[80:83], v[160:163]
  v_mfma_f32_16x16x32_bf16 v[168:171], a[144:147], a[68:71], v[168:171]
  buffer_load_dwordx4 a[40:43], v3, s[8:11], s59 offen offset:2048 sc1
  v_mfma_f32_16x16x32_bf16 v[168:171], a[148:151], a[84:87], v[168:171]
  v_mfma_f32_16x16x32_bf16 v[176:179], a[144:147], a[72:75], v[176:179]
  ds_read_b128 a[132:135], v5 offset:45056
  v_mfma_f32_16x16x32_bf16 v[176:179], a[148:151], a[88:91], v[176:179]
  v_mfma_f32_16x16x32_bf16 v[184:187], a[144:147], a[76:79], v[184:187]
  buffer_load_dwordx4 v8, s[60:63], s58 offen offset:2048 sc1 lds
  v_mfma_f32_16x16x32_bf16 v[184:187], a[148:151], a[92:95], v[184:187]
  s_waitcnt lgkmcnt(2)
  v_mfma_f32_16x16x32_bf16 v[164:167], a[152:155], a[64:67], v[164:167]
  ds_read_b128 a[136:139], v5 offset:37888
  v_mfma_f32_16x16x32_bf16 v[164:167], a[156:159], a[80:83], v[164:167]
  v_mfma_f32_16x16x32_bf16 v[172:175], a[152:155], a[68:71], v[172:175]
  buffer_load_dwordx4 a[44:47], v3, s[8:11], s59 offen offset:3072 sc1
  s_add_u32 s59, s59, 0x20000
  v_mfma_f32_16x16x32_bf16 v[172:175], a[156:159], a[84:87], v[172:175]
  v_mfma_f32_16x16x32_bf16 v[180:183], a[152:155], a[72:75], v[180:183]
  ds_read_b128 a[140:143], v5 offset:46080
  v_mfma_f32_16x16x32_bf16 v[180:183], a[156:159], a[88:91], v[180:183]
  v_mfma_f32_16x16x32_bf16 v[188:191], a[152:155], a[76:79], v[188:191]
  buffer_load_dwordx4 v8, s[60:63], s58 offen offset:3072 sc1 lds
  s_add_u32 s58, s58, 0x20000
  v_mfma_f32_16x16x32_bf16 v[188:191], a[156:159], a[92:95], v[188:191]
  s_waitcnt lgkmcnt(2)
  v_mfma_f32_16x16x32_bf16 v[192:195], a[128:131], a[64:67], v[192:195]
  ds_read_b128 a[144:147], v5 offset:38912
  v_mfma_f32_16x16x32_bf16 v[192:195], a[132:135], a[80:83], v[192:195]
  v_mfma_f32_16x16x32_bf16 v[200:203], a[128:131], a[68:71], v[200:203]
  buffer_load_dwordx4 a[48:51], v3, s[8:11], s59 offen offset:0 sc1
  v_mfma_f32_16x16x32_bf16 v[200:203], a[132:135], a[84:87], v[200:203]
  v_mfma_f32_16x16x32_bf16 v[208:211], a[128:131], a[72:75], v[208:211]
  ds_read_b128 a[148:151], v5 offset:47104
  v_mfma_f32_16x16x32_bf16 v[208:211], a[132:135], a[88:91], v[208:211]
  v_mfma_f32_16x16x32_bf16 v[216:219], a[128:131], a[76:79], v[216:219]
  v_mfma_f32_16x16x32_bf16 v[216:219], a[132:135], a[92:95], v[216:219]
  s_waitcnt lgkmcnt(2)
  v_mfma_f32_16x16x32_bf16 v[196:199], a[136:139], a[64:67], v[196:199]
  ds_read_b128 a[152:155], v5 offset:39936
  v_mfma_f32_16x16x32_bf16 v[196:199], a[140:143], a[80:83], v[196:199]
  v_mfma_f32_16x16x32_bf16 v[204:207], a[136:139], a[68:71], v[204:207]
  buffer_load_dwordx4 a[52:55], v3, s[8:11], s59 offen offset:1024 sc1
  v_mfma_f32_16x16x32_bf16 v[204:207], a[140:143], a[84:87], v[204:207]
  v_mfma_f32_16x16x32_bf16 v[212:215], a[136:139], a[72:75], v[212:215]
  ds_read_b128 a[156:159], v5 offset:48128
  v_mfma_f32_16x16x32_bf16 v[212:215], a[140:143], a[88:91], v[212:215]
  v_mfma_f32_16x16x32_bf16 v[220:223], a[136:139], a[76:79], v[220:223]
  v_mfma_f32_16x16x32_bf16 v[220:223], a[140:143], a[92:95], v[220:223]
  s_waitcnt vmcnt(10)
  s_barrier
  s_waitcnt lgkmcnt(2)
  v_mfma_f32_16x16x32_bf16 v[224:227], a[144:147], a[64:67], v[224:227]
  ds_read_b128 a[128:131], v10 offset:0
  v_mfma_f32_16x16x32_bf16 v[224:227], a[148:151], a[80:83], v[224:227]
  v_mfma_f32_16x16x32_bf16 v[232:235], a[144:147], a[68:71], v[232:235]
  buffer_load_dwordx4 a[56:59], v3, s[8:11], s59 offen offset:2048 sc1
  v_mfma_f32_16x16x32_bf16 v[232:235], a[148:151], a[84:87], v[232:235]
  v_mfma_f32_16x16x32_bf16 v[240:243], a[144:147], a[72:75], v[240:243]
  ds_read_b128 a[132:135], v10 offset:8192
  v_mfma_f32_16x16x32_bf16 v[240:243], a[148:151], a[88:91], v[240:243]
  v_mfma_f32_16x16x32_bf16 v[248:251], a[144:147], a[76:79], v[248:251]
  v_mfma_f32_16x16x32_bf16 v[248:251], a[148:151], a[92:95], v[248:251]
  s_waitcnt lgkmcnt(2)
  v_mfma_f32_16x16x32_bf16 v[228:231], a[152:155], a[64:67], v[228:231]
  ds_read_b128 a[136:139], v10 offset:1024
  v_mfma_f32_16x16x32_bf16 v[228:231], a[156:159], a[80:83], v[228:231]
  v_mfma_f32_16x16x32_bf16 v[236:239], a[152:155], a[68:71], v[236:239]
  buffer_load_dwordx4 a[60:63], v3, s[8:11], s59 offen offset:3072 sc1
  s_add_u32 s59, s59, 0x20000
  v_mfma_f32_16x16x32_bf16 v[236:239], a[156:159], a[84:87], v[236:239]
  buffer_load_dword v9, v0, s[4:7], s3 offen
  v_mfma_f32_16x16x32_bf16 v[244:247], a[152:155], a[72:75], v[244:247]
  ds_read_b128 a[140:143], v10 offset:9216
  v_mfma_f32_16x16x32_bf16 v[244:247], a[156:159], a[88:91], v[244:247]
  s_sub_u32 s57, s57, 1
  v_mfma_f32_16x16x32_bf16 v[252:255], a[152:155], a[76:79], v[252:255]
  s_cmp_eq_u32 s57, 0
  v_mfma_f32_16x16x32_bf16 v[252:255], a[156:159], a[92:95], v[252:255]
  s_cbranch_scc1 L_gb_tail
  v_cmp_ne_u64 vcc, v[22:23], v[12:13]
  s_nop 0
  s_cmp_lg_u64 vcc, 0
  s_cbranch_scc1 L_gb_late1
L_gb_cont1:
  s_waitcnt lgkmcnt(2)
  v_mfma_f32_16x16x32_bf16 v[128:131], a[128:131], a[0:3], v[128:131]
  ds_read_b128 a[144:147], v10 offset:2048
  v_mfma_f32_16x16x32_bf16 v[128:131], a[132:135], a[16:19], v[128:131]
  v_mfma_f32_16x16x32_bf16 v[136:139], a[128:131], a[4:7], v[136:139]
  buffer_load_dwordx4 a[64:67], v3, s[8:11], s59 offen offset:0 sc1
  v_mfma_f32_16x16x32_bf16 v[136:139], a[132:135], a[20:23], v[136:139]
  v_mfma_f32_16x16x32_bf16 v[144:147], a[128:131], a[8:11], v[144:147]
  ds_read_b128 a[148:151], v10 offset:10240
  v_mfma_f32_16x16x32_bf16 v[144:147], a[132:135], a[24:27], v[144:147]
  s_add_u32 m0, s12, 16384
  v_mfma_f32_16x16x32_bf16 v[152:155], a[128:131], a[12:15], v[152:155]
  buffer_load_dwordx4 v2, s[60:63], s58 offen offset:0 sc1 lds
  v_mfma_f32_16x16x32_bf16 v[152:155], a[132:135], a[28:31], v[152:155]
  s_waitcnt lgkmcnt(2)
  v_mfma_f32_16x16x32_bf16 v[132:135], a[136:139], a[0:3], v[132:135]
  ds_read_b128 a[152:155], v10 offset:3072
  v_mfma_f32_16x16x32_bf16 v[132:135], a[140:143], a[16:19], v[132:135]
  v_mfma_f32_16x16x32_bf16 v[140:143], a[136:139], a[4:7], v[140:143]
  buffer_load_dwordx4 a[68:71], v3, s[8:11], s59 offen offset:1024 sc1
  v_mfma_f32_16x16x32_bf16 v[140:143], a[140:143], a[20:23], v[140:143]
  v_mfma_f32_16x16x32_bf16 v[148:151], a[136:139], a[8:11], v[148:151]
  ds_read_b128 a[156:159], v10 offset:11264
  v_mfma_f32_16x16x32_bf16 v[148:151], a[140:143], a[24:27], v[148:151]
  v_mfma_f32_16x16x32_bf16 v[156:159], a[136:139], a[12:15], v[156:159]
  buffer_load_dwordx4 v2, s[60:63], s58 offen offset:1024 sc1 lds
  v_mfma_f32_16x16x32_bf16 v[156:159], a[140:143], a[28:31], v[156:159]
  s_waitcnt lgkmcnt(2)
  v_mfma_f32_16x16x32_bf16 v[160:163], a[144:147], a[0:3], v[160:163]
  ds_read_b128 a[128:131], v10 offset:4096
  v_mfma_f32_16x16x32_bf16 v[160:163], a[148:151], a[16:19], v[160:163]
  v_mfma_f32_16x16x32_bf16 v[168:171], a[144:147], a[4:7], v[168:171]
  buffer_load_dwordx4 a[72:75], v3, s[8:11], s59 offen offset:2048 sc1
  v_mfma_f32_16x16x32_bf16 v[168:171], a[148:151], a[20:23], v[168:171]
  v_mfma_f32_16x16x32_bf16 v[176:179], a[144:147], a[8:11], v[176:179]
  ds_read_b128 a[132:135], v10 offset:12288
  v_mfma_f32_16x16x32_bf16 v[176:179], a[148:151], a[24:27], v[176:179]
  v_mfma_f32_16x16x32_bf16 v[184:187], a[144:147], a[12:15], v[184:187]
  buffer_load_dwordx4 v8, s[60:63], s58 offen offset:2048 sc1 lds
  v_mfma_f32_16x16x32_bf16 v[184:187], a[148:151], a[28:31], v[184:187]
  s_waitcnt lgkmcnt(2)
  v_mfma_f32_16x16x32_bf16 v[164:167], a[152:155], a[0:3], v[164:167]
  ds_read_b128 a[136:139], v10 offset:5120
  v_mfma_f32_16x16x32_bf16 v[164:167], a[156:159], a[16:19], v[164:167]
  v_mfma_f32_16x16x32_bf16 v[172:175], a[152:155], a[4:7], v[172:175]
  buffer_load_dwordx4 a[76:79], v3, s[8:11], s59 offen offset:3072 sc1
  s_add_u32 s59, s59, 0x20000
  v_mfma_f32_16x16x32_bf16 v[172:175], a[156:159], a[20:23], v[172:175]
  v_mfma_f32_16x16x32_bf16 v[180:183], a[152:155], a[8:11], v[180:183]
  ds_read_b128 a[140:143], v10 offset:13312
  v_mfma_f32_16x16x32_bf16 v[180:183], a[156:159], a[24:27], v[180:183]
  v_mfma_f32_16x16x32_bf16 v[188:191], a[152:155], a[12:15], v[188:191]
  buffer_load_dwordx4 v8, s[60:63], s58 offen offset:3072 sc1 lds
  s_add_u32 s58, s58, 0x20000
  v_mfma_f32_16x16x32_bf16 v[188:191], a[156:159], a[28:31], v[188:191]
  s_waitcnt lgkmcnt(2)
  v_mfma_f32_16x16x32_bf16 v[192:195], a[128:131], a[0:3], v[192:195]
  ds_read_b128 a[144:147], v10 offset:6144
  v_mfma_f32_16x16x32_bf16 v[192:195], a[132:135], a[16:19], v[192:195]
  v_mfma_f32_16x16x32_bf16 v[200:203], a[128:131], a[4:7], v[200:203]
  buffer_load_dwordx4 a[80:83], v3, s[8:11], s59 offen offset:0 sc1
  v_mfma_f32_16x16x32_bf16 v[200:203], a[132:135], a[20:23], v[200:203]
  v_mfma_f32_16x16x32_bf16 v[208:211], a[128:131], a[8:11], v[208:211]
  ds_read_b128 a[148:151], v10 offset:14336
  v_mfma_f32_16x16x32_bf16 v[208:211], a[132:135], a[24:27], v[208:211]
  v_mfma_f32_16x16x32_bf16 v[216:219], a[128:131], a[12:15], v[216:219]
  v_mfma_f32_16x16x32_bf16 v[216:219], a[132:135], a[28:31], v[216:219]
  s_waitcnt lgkmcnt(2)
  v_mfma_f32_16x16x32_bf16 v[196:199], a[136:139], a[0:3], v[196:199]
  ds_read_b128 a[152:155], v10 offset:7168
  v_mfma_f32_16x16x32_bf16 v[196:199], a[140:143], a[16:19], v[196:199]
  v_mfma_f32_16x16x32_bf16 v[204:207], a[136:139], a[4:7], v[204:207]
  buffer_load_dwordx4 a[84:87], v3, s[8:11], s59 offen offset:1024 sc1
  v_mfma_f32_16x16x32_bf16 v[204:207], a[140:143], a[20:23], v[204:207]
  v_mfma_f32_16x16x32_bf16 v[212:215], a[136:139], a[8:11], v[212:215]
  ds_read_b128 a[156:159], v10 offset:15360
  v_mfma_f32_16x16x32_bf16 v[212:215], a[140:143], a[24:27], v[212:215]
  v_mfma_f32_16x16x32_bf16 v[220:223], a[136:139], a[12:15], v[220:223]
  v_mfma_f32_16x16x32_bf16 v[220:223], a[140:143], a[28:31], v[220:223]
  s_waitcnt vmcnt(11)
  s_barrier
  s_waitcnt lgkmcnt(2)
  v_mfma_f32_16x16x32_bf16 v[224:227], a[144:147], a[0:3], v[224:227]
  ds_read_b128 a[128:131], v10 offset:16384
  v_mfma_f32_16x16x32_bf16 v[224:227], a[148:151], a[16:19], v[224:227]
  v_mfma_f32_16x16x32_bf16 v[232:235], a[144:147], a[4:7], v[232:235]
  buffer_load_dwordx4 a[88:91], v3, s[8:11], s59 offen offset:2048 sc1
  v_mfma_f32_16x16x32_bf16 v[232:235], a[148:151], a[20:23], v[232:235]
  v_mfma_f32_16x16x32_bf16 v[240:243], a[144:147], a[8:11], v[240:243]
  ds_read_b128 a[132:135], v10 offset:24576
  v_mfma_f32_16x16x32_bf16 v[240:243], a[148:151], a[24:27], v[240:243]
  v_mfma_f32_16x16x32_bf16 v[248:251], a[144:147], a[12:15], v[248:251]
  v_mfma_f32_16x16x32_bf16 v[248:251], a[148:151], a[28:31], v[248:251]
  s_waitcnt lgkmcnt(2)
  v_mfma_f32_16x16x32_bf16 v[228:231], a[152:155], a[0:3], v[228:231]
  ds_read_b128 a[136:139], v10 offset:17408
  v_mfma_f32_16x16x32_bf16 v[228:231], a[156:159], a[16:19], v[228:231]
  v_mfma_f32_16x16x32_bf16 v[236:239], a[152:155], a[4:7], v[236:239]
  buffer_load_dwordx4 a[92:95], v3, s[8:11], s59 offen offset:3072 sc1
  s_add_u32 s59, s59, 0x20000
  v_mfma_f32_16x16x32_bf16 v[236:239], a[156:159], a[20:23], v[236:239]
  v_mfma_f32_16x16x32_bf16 v[244:247], a[152:155], a[8:11], v[244:247]
  ds_read_b128 a[140:143], v10 offset:25600
  v_mfma_f32_16x16x32_bf16 v[244:247], a[156:159], a[24:27], v[244:247]
  v_mfma_f32_16x16x32_bf16 v[252:255], a[152:155], a[12:15], v[252:255]
  v_mfma_f32_16x16x32_bf16 v[252:255], a[156:159], a[28:31], v[252:255]
L_gb_in4:
  s_waitcnt lgkmcnt(2)
  v_mfma_f32_16x16x32_bf16 v[128:131], a[128:131], a[32:35], v[128:131]
  ds_read_b128 a[144:147], v10 offset:18432
  v_mfma_f32_16x16x32_bf16 v[128:131], a[132:135], a[48:51], v[128:131]
  v_mfma_f32_16x16x32_bf16 v[136:139], a[128:131], a[36:39], v[136:139]
  buffer_load_dwordx4 a[0:3], v3, s[8:11], s59 offen offset:0 sc1
  v_mfma_f32_16x16x32_bf16 v[136:139], a[132:135], a[52:55], v[136:139]
  v_mfma_f32_16x16x32_bf16 v[144:147], a[128:131], a[40:43], v[144:147]
  ds_read_b128 a[148:151], v10 offset:26624
  v_mfma_f32_16x16x32_bf16 v[144:147], a[132:135], a[56:59], v[144:147]
  s_add_u32 m0, s12, 32768
  v_mfma_f32_16x16x32_bf16 v[152:155], a[128:131], a[44:47], v[152:155]
  buffer_load_dwordx4 v2, s[60:63], s58 offen offset:0 sc1 lds
  v_mfma_f32_16x16x32_bf16 v[152:155], a[132:135], a[60:63], v[152:155]
  s_waitcnt lgkmcnt(2)
  v_mfma_f32_16x16x32_bf16 v[132:135], a[136:139], a[32:35], v[132:135]
  ds_read_b128 a[152:155], v10 offset:19456
  v_mfma_f32_16x16x32_bf16 v[132:135], a[140:143], a[48:51], v[132:135]
  v_mfma_f32_16x16x32_bf16 v[140:143], a[136:139], a[36:39], v[140:143]
  buffer_load_dwordx4 a[4:7], v3, s[8:11], s59 offen offset:1024 sc1
  v_mfma_f32_16x16x32_bf16 v[140:143], a[140:143], a[52:55], v[140:143]
  v_mfma_f32_16x16x32_bf16 v[148:151], a[136:139], a[40:43], v[148:151]
  ds_read_b128 a[156:159], v10 offset:27648
  v_mfma_f32_16x16x32_bf16 v[148:151], a[140:143], a[56:59], v[148:151]
  v_mfma_f32_16x16x32_bf16 v[156:159], a[136:139], a[44:47], v[156:159]
  buffer_load_dwordx4 v2, s[60:63], s58 offen offset:1024 sc1 lds
  v_mfma_f32_16x16x32_bf16 v[156:159], a[140:143], a[60:63], v[156:159]
  s_waitcnt lgkmcnt(2)
  v_mfma_f32_16x16x32_bf16 v[160:163], a[144:147], a[32:35], v[160:163]
  ds_read_b128 a[128:131], v10 offset:20480
  v_mfma_f32_16x16x32_bf16 v[160:163], a[148:151], a[48:51], v[160:163]
  v_mfma_f32_16x16x32_bf16 v[168:171], a[144:147], a[36:39], v[168:171]
  buffer_load_dwordx4 a[8:11], v3, s[8:11], s59 offen offset:2048 sc1
  v_mfma_f32_16x16x32_bf16 v[168:171], a[148:151], a[52:55], v[168:171]
  v_mfma_f32_16x16x32_bf16 v[176:179], a[144:147], a[40:43], v[176:179]
  ds_read_b128 a[132:135], v10 offset:28672
  v_mfma_f32_16x16x32_bf16 v[176:179], a[148:151], a[56:59], v[176:179]
  v_mfma_f32_16x16x32_bf16 v[184:187], a[144:147], a[44:47], v[184:187]
  buffer_load_dwordx4 v8, s[60:63], s58 offen offset:2048 sc1 lds
  v_mfma_f32_16x16x32_bf16 v[184:187], a[148:151], a[60:63], v[184:187]
  s_waitcnt lgkmcnt(2)
  v_mfma_f32_16x16x32_bf16 v[164:167], a[152:155], a[32:35], v[164:167]
  ds_read_b128 a[136:139], v10 offset:21504
  v_mfma_f32_16x16x32_bf16 v[164:167], a[156:159], a[48:51], v[164:167]
  v_mfma_f32_16x16x32_bf16 v[172:175], a[152:155], a[36:39], v[172:175]
  buffer_load_dwordx4 a[12:15], v3, s[8:11], s59 offen offset:3072 sc1
  s_add_u32 s59, s59, 0x20000
  v_mfma_f32_16x16x32_bf16 v[172:175], a[156:159], a[52:55], v[172:175]
  v_mfma_f32_16x16x32_bf16 v[180:183], a[152:155], a[40:43], v[180:183]
  ds_read_b128 a[140:143], v10 offset:29696
  v_mfma_f32_16x16x32_bf16 v[180:183], a[156:159], a[56:59], v[180:183]
  v_mfma_f32_16x16x32_bf16 v[188:191], a[152:155], a[44:47], v[188:191]
  buffer_load_dwordx4 v8, s[60:63], s58 offen offset:3072 sc1 lds
  s_add_u32 s58, s58, 0x20000
  v_mfma_f32_16x16x32_bf16 v[188:191], a[156:159], a[60:63], v[188:191]
  s_waitcnt lgkmcnt(2)
  v_mfma_f32_16x16x32_bf16 v[192:195], a[128:131], a[32:35], v[192:195]
  ds_read_b128 a[144:147], v10 offset:22528
  v_mfma_f32_16x16x32_bf16 v[192:195], a[132:135], a[48:51], v[192:195]
  v_mfma_f32_16x16x32_bf16 v[200:203], a[128:131], a[36:39], v[200:203]
  buffer_load_dwordx4 a[16:19], v3, s[8:11], s59 offen offset:0 sc1
  v_mfma_f32_16x16x32_bf16 v[200:203], a[132:135], a[52:55], v[200:203]
  v_mfma_f32_16x16x32_bf16 v[208:211], a[128:131], a[40:43], v[208:211]
  ds_read_b128 a[148:151], v10 offset:30720
  v_mfma_f32_16x16x32_bf16 v[208:211], a[132:135], a[56:59], v[208:211]
  v_mfma_f32_16x16x32_bf16 v[216:219], a[128:131], a[44:47], v[216:219]
  v_mfma_f32_16x16x32_bf16 v[216:219], a[132:135], a[60:63], v[216:219]
  s_waitcnt lgkmcnt(2)
  v_mfma_f32_16x16x32_bf16 v[196:199], a[136:139], a[32:35], v[196:199]
  ds_read_b128 a[152:155], v10 offset:23552
  v_mfma_f32_16x16x32_bf16 v[196:199], a[140:143], a[48:51], v[196:199]
  v_mfma_f32_16x16x32_bf16 v[204:207], a[136:139], a[36:39], v[204:207]
  buffer_load_dwordx4 a[20:23], v3, s[8:11], s59 offen offset:1024 sc1
  v_mfma_f32_16x16x32_bf16 v[204:207], a[140:143], a[52:55], v[204:207]
  v_mfma_f32_16x16x32_bf16 v[212:215], a[136:139], a[40:43], v[212:215]
  ds_read_b128 a[156:159], v10 offset:31744
  v_mfma_f32_16x16x32_bf16 v[212:215], a[140:143], a[56:59], v[212:215]
  v_mfma_f32_16x16x32_bf16 v[220:223], a[136:139], a[44:47], v[220:223]
  v_mfma_f32_16x16x32_bf16 v[220:223], a[140:143], a[60:63], v[220:223]
  s_waitcnt vmcnt(10)
  s_barrier
  s_waitcnt lgkmcnt(2)
  v_mfma_f32_16x16x32_bf16 v[224:227], a[144:147], a[32:35], v[224:227]
  ds_read_b128 a[128:131], v10 offset:32768
  v_mfma_f32_16x16x32_bf16 v[224:227], a[148:151], a[48:51], v[224:227]
  v_mfma_f32_16x16x32_bf16 v[232:235], a[144:147], a[36:39], v[232:235]
  buffer_load_dwordx4 a[24:27], v3, s[8:11], s59 offen offset:2048 sc1
  v_mfma_f32_16x16x32_bf16 v[232:235], a[148:151], a[52:55], v[232:235]
  v_mfma_f32_16x16x32_bf16 v[240:243], a[144:147], a[40:43], v[240:243]
  ds_read_b128 a[132:135], v10 offset:40960
  v_mfma_f32_16x16x32_bf16 v[240:243], a[148:151], a[56:59], v[240:243]
  v_mfma_f32_16x16x32_bf16 v[248:251], a[144:147], a[44:47], v[248:251]
  v_mfma_f32_16x16x32_bf16 v[248:251], a[148:151], a[60:63], v[248:251]
  s_waitcnt lgkmcnt(2)
  v_mfma_f32_16x16x32_bf16 v[228:231], a[152:155], a[32:35], v[228:231]
  ds_read_b128 a[136:139], v10 offset:33792
  v_mfma_f32_16x16x32_bf16 v[228:231], a[156:159], a[48:51], v[228:231]
  buffer_load_dwordx2 v[22:23], v11, s[24:27], s28 offen sc1
  v_mfma_f32_16x16x32_bf16 v[236:239], a[152:155], a[36:39], v[236:239]
  buffer_load_dwordx4 a[28:31], v3, s[8:11], s59 offen offset:3072 sc1
  s_add_u32 s59, s59, 0x20000
  v_mfma_f32_16x16x32_bf16 v[236:239], a[156:159], a[52:55], v[236:239]
  v_mfma_f32_16x16x32_bf16 v[244:247], a[152:155], a[40:43], v[244:247]
  ds_read_b128 a[140:143], v10 offset:41984
  v_mfma_f32_16x16x32_bf16 v[244:247], a[156:159], a[56:59], v[244:247]
  v_mfma_f32_16x16x32_bf16 v[252:255], a[152:155], a[44:47], v[252:255]
  v_mfma_f32_16x16x32_bf16 v[252:255], a[156:159], a[60:63], v[252:255]
  s_waitcnt lgkmcnt(2)
  v_mfma_f32_16x16x32_bf16 v[128:131], a[128:131], a[64:67], v[128:131]
  ds_read_b128 a[144:147], v10 offset:34816
  v_mfma_f32_16x16x32_bf16 v[128:131], a[132:135], a[80:83], v[128:131]
  v_mfma_f32_16x16x32_bf16 v[136:139], a[128:131], a[68:71], v[136:139]
  buffer_load_dwordx4 a[32:35], v3, s[8:11], s59 offen offset:0 sc1
  v_mfma_f32_16x16x32_bf16 v[136:139], a[132:135], a[84:87], v[136:139]
  v_mfma_f32_16x16x32_bf16 v[144:147], a[128:131], a[72:75], v[144:147]
  ds_read_b128 a[148:151], v10 offset:43008
  v_mfma_f32_16x16x32_bf16 v[144:147], a[132:135], a[88:91], v[144:147]
  s_add_u32 m0, s13, 0
  v_mfma_f32_16x16x32_bf16 v[152:155], a[128:131], a[76:79], v[152:155]
  buffer_load_dwordx4 v2, s[60:63], s58 offen offset:0 sc1 lds
  v_mfma_f32_16x16x32_bf16 v[152:155], a[132:135], a[92:95], v[152:155]
  s_waitcnt lgkmcnt(2)
  v_mfma_f32_16x16x32_bf16 v[132:135], a[136:139], a[64:67], v[132:135]
  ds_read_b128 a[152:155], v10 offset:35840
  v_mfma_f32_16x16x32_bf16 v[132:135], a[140:143], a[80:83], v[132:135]
  v_mfma_f32_16x16x32_bf16 v[140:143], a[136:139], a[68:71], v[140:143]
  buffer_load_dwordx4 a[36:39], v3, s[8:11], s59 offen offset:1024 sc1
  v_mfma_f32_16x16x32_bf16 v[140:143], a[140:143], a[84:87], v[140:143]
  v_mfma_f32_16x16x32_bf16 v[148:151], a[136:139], a[72:75], v[148:151]
  ds_read_b128 a[156:159], v10 offset:44032
  v_mfma_f32_16x16x32_bf16 v[148:151], a[140:143], a[88:91], v[148:151]
  v_mfma_f32_16x16x32_bf16 v[156:159], a[136:139], a[76:79], v[156:159]
  buffer_load_dwordx4 v2, s[60:63], s58 offen offset:1024 sc1 lds
  v_mfma_f32_16x16x32_bf16 v[156:159], a[140:143], a[92:95], v[156:159]
  s_waitcnt lgkmcnt(2)
  v_mfma_f32_16x16x32_bf16 v[160:163], a[144:147], a[64:67], v[160:163]
  ds_read_b128 a[128:131], v10 offset:36864
  v_mfma_f32_16x16x32_bf16 v[160:163], a[148:151], a[80:83], v[160:163]
  v_mfma_f32_16x16x32_bf16 v[168:171], a[144:147], a[68:71], v[168:171]
  buffer_load_dwordx4 a[40:43], v3, s[8:11], s59 offen offset:2048 sc1
  v_mfma_f32_16x16x32_bf16 v[168:171], a[148:151], a[84:87], v[168:171]
  v_mfma_f32_16x16x32_bf16 v[176:179], a[144:147], a[72:75], v[176:179]
  ds_read_b128 a[132:135], v10 offset:45056
  v_mfma_f32_16x16x32_bf16 v[176:179], a[148:151], a[88:91], v[176:179]
  v_mfma_f32_16x16x32_bf16 v[184:187], a[144:147], a[76:79], v[184:187]
  buffer_load_dwordx4 v8, s[60:63], s58 offen offset:2048 sc1 lds
  v_mfma_f32_16x16x32_bf16 v[184:187], a[148:151], a[92:95], v[184:187]
  s_waitcnt lgkmcnt(2)
  v_mfma_f32_16x16x32_bf16 v[164:167], a[152:155], a[64:67], v[164:167]
  ds_read_b128 a[136:139], v10 offset:37888
  v_mfma_f32_16x16x32_bf16 v[164:167], a[156:159], a[80:83], v[164:167]
  v_mfma_f32_16x16x32_bf16 v[172:175], a[152:155], a[68:71], v[172:175]
  buffer_load_dwordx4 a[44:47], v3, s[8:11], s59 offen offset:3072 sc1
  s_add_u32 s59, s59, 0x20000
  v_mfma_f32_16x16x32_bf16 v[172:175], a[156:159], a[84:87], v[172:175]
  v_mfma_f32_16x16x32_bf16 v[180:183], a[152:155], a[72:75], v[180:183]
  ds_read_b128 a[140:143], v10 offset:46080
  v_mfma_f32_16x16x32_bf16 v[180:183], a[156:159], a[88:91], v[180:183]
  v_mfma_f32_16x16x32_bf16 v[188:191], a[152:155], a[76:79], v[188:191]
  buffer_load_dwordx4 v8, s[60:63], s58 offen offset:3072 sc1 lds
  s_add_u32 s58, s58, 0x20000
  v_mfma_f32_16x16x32_bf16 v[188:191], a[156:159], a[92:95], v[188:191]
  s_waitcnt lgkmcnt(2)
  v_mfma_f32_16x16x32_bf16 v[192:195], a[128:131], a[64:67], v[192:195]
  ds_read_b128 a[144:147], v10 offset:38912
  v_mfma_f32_16x16x32_bf16 v[192:195], a[132:135], a[80:83], v[192:195]
  v_mfma_f32_16x16x32_bf16 v[200:203], a[128:131], a[68:71], v[200:203]
  buffer_load_dwordx4 a[48:51], v3, s[8:11], s59 offen offset:0 sc1
  v_mfma_f32_16x16x32_bf16 v[200:203], a[132:135], a[84:87], v[200:203]
  v_mfma_f32_16x16x32_bf16 v[208:211], a[128:131], a[72:75], v[208:211]
  ds_read_b128 a[148:151], v10 offset:47104
  v_mfma_f32_16x16x32_bf16 v[208:211], a[132:135], a[88:91], v[208:211]
  v_mfma_f32_16x16x32_bf16 v[216:219], a[128:131], a[76:79], v[216:219]
  v_mfma_f32_16x16x32_bf16 v[216:219], a[132:135], a[92:95], v[216:219]
  s_waitcnt lgkmcnt(2)
  v_mfma_f32_16x16x32_bf16 v[196:199], a[136:139], a[64:67], v[196:199]
  ds_read_b128 a[152:155], v10 offset:39936
  v_mfma_f32_16x16x32_bf16 v[196:199], a[140:143], a[80:83], v[196:199]
  v_mfma_f32_16x16x32_bf16 v[204:207], a[136:139], a[68:71], v[204:207]
  buffer_load_dwordx4 a[52:55], v3, s[8:11], s59 offen offset:1024 sc1
  v_mfma_f32_16x16x32_bf16 v[204:207], a[140:143], a[84:87], v[204:207]
  v_mfma_f32_16x16x32_bf16 v[212:215], a[136:139], a[72:75], v[212:215]
  ds_read_b128 a[156:159], v10 offset:48128
  v_mfma_f32_16x16x32_bf16 v[212:215], a[140:143], a[88:91], v[212:215]
  v_mfma_f32_16x16x32_bf16 v[220:223], a[136:139], a[76:79], v[220:223]
  v_mfma_f32_16x16x32_bf16 v[220:223], a[140:143], a[92:95], v[220:223]
  s_waitcnt vmcnt(10)
  s_barrier
  s_waitcnt lgkmcnt(2)
  v_mfma_f32_16x16x32_bf16 v[224:227], a[144:147], a[64:67], v[224:227]
  ds_read_b128 a[128:131], v5 offset:0
  v_mfma_f32_16x16x32_bf16 v[224:227], a[148:151], a[80:83], v[224:227]
  v_mfma_f32_16x16x32_bf16 v[232:235], a[144:147], a[68:71], v[232:235]
  buffer_load_dwordx4 a[56:59], v3, s[8:11], s59 offen offset:2048 sc1
  v_mfma_f32_16x16x32_bf16 v[232:235], a[148:151], a[84:87], v[232:235]
  v_mfma_f32_16x16x32_bf16 v[240:243], a[144:147], a[72:75], v[240:243]
  ds_read_b128 a[132:135], v5 offset:8192
  v_mfma_f32_16x16x32_bf16 v[240:243], a[148:151], a[88:91], v[240:243]
  v_mfma_f32_16x16x32_bf16 v[248:251], a[144:147], a[76:79], v[248:251]
  v_mfma_f32_16x16x32_bf16 v[248:251], a[148:151], a[92:95], v[248:251]
  s_waitcnt lgkmcnt(2)
  v_mfma_f32_16x16x32_bf16 v[228:231], a[152:155], a[64:67], v[228:231]
  ds_read_b128 a[136:139], v5 offset:1024
  v_mfma_f32_16x16x32_bf16 v[228:231], a[156:159], a[80:83], v[228:231]
  v_mfma_f32_16x16x32_bf16 v[236:239], a[152:155], a[68:71], v[236:239]
  buffer_load_dwordx4 a[60:63], v3, s[8:11], s59 offen offset:3072 sc1
  s_add_u32 s59, s59, 0x20000
  v_mfma_f32_16x16x32_bf16 v[236:239], a[156:159], a[84:87], v[236:239]
  buffer_load_dword v9, v0, s[4:7], s3 offen
  v_mfma_f32_16x16x32_bf16 v[244:247], a[152:155], a[72:75], v[244:247]
  ds_read_b128 a[140:143], v5 offset:9216
  v_mfma_f32_16x16x32_bf16 v[244:247], a[156:159], a[88:91], v[244:247]
  v_mfma_f32_16x16x32_bf16 v[252:255], a[152:155], a[76:79], v[252:255]
  v_mfma_f32_16x16x32_bf16 v[252:255], a[156:159], a[92:95], v[252:255]
  s_branch L_gb_loop
L_gb_late0:
  s_mov_b32 s37, 0
L_gb_lp0:
  buffer_load_dwordx2 v[22:23], v11, s[24:27], s28 offen sc1
  s_waitcnt vmcnt(0)
  v_cmp_ne_u64 vcc, v[22:23], v[12:13]
  s_add_u32 s37, s37, 1
  s_cmp_eq_u64 vcc, 0
  s_cbranch_scc1 L_gb_cont0
  s_sleep 4
  s_cmp_lt_u32 s37, 0x200000
  s_cbranch_scc1 L_gb_lp0
  s_branch L_gb_cont0
L_gb_late1:
  s_mov_b32 s37, 0
L_gb_lp1:
  buffer_load_dwordx2 v[22:23], v11, s[24:27], s31 offen sc1
  s_waitcnt vmcnt(0)
  v_cmp_ne_u64 vcc, v[22:23], v[12:13]
  s_add_u32 s37, s37, 1
  s_cmp_eq_u64 vcc, 0
  s_cbranch_scc1 L_gb_cont1
  s_sleep 4
  s_cmp_lt_u32 s37, 0x200000
  s_cbranch_scc1 L_gb_lp1
  s_branch L_gb_cont1
L_gb_tail:
  s_waitcnt lgkmcnt(2)
  v_mfma_f32_16x16x32_bf16 v[128:131], a[128:131], a[0:3], v[128:131]
  ds_read_b128 a[144:147], v10 offset:16384
  s_mov_b32 s16, s52
  s_and_b32 s17, s53, 0xffff
  s_mov_b32 s18, 0x400000
  v_mfma_f32_16x16x32_bf16 v[128:131], a[132:135], a[16:19], v[128:131]
  buffer_load_dwordx4 a[64:67], v3, s[8:11], s59 offen offset:0 sc1
  s_mov_b32 s19, 0x20000
  s_mov_b32 s68, 0
  s_mov_b32 s69, 0x8000
  v_mfma_f32_16x16x32_bf16 v[136:139], a[128:131], a[4:7], v[136:139]
  s_mov_b32 s70, 0x10000
  s_mov_b32 s71, 0x18000
  v_mfma_f32_16x16x32_bf16 v[136:139], a[132:135], a[20:23], v[136:139]
  buffer_load_dwordx4 a[68:71], v3, s[8:11], s59 offen offset:1024 sc1
  s_lshl_b32 s37, s34, 3
  s_add_u32 s37, s37, s33
  s_mul_i32 s39, s32, 384
  v_mfma_f32_16x16x32_bf16 v[144:147], a[128:131], a[8:11], v[144:147]
  ds_read_b128 a[148:151], v10 offset:24576
  s_lshl_b32 s44, s30, 6
  s_add_u32 s44, s44, s37
  s_mul_i32 s43, s44, 1536
  v_mfma_f32_16x16x32_bf16 v[144:147], a[132:135], a[24:27], v[144:147]
  s_add_u32 s43, s43, s39
  s_add_u32 s43, s43, 0x1820000
  v_mfma_f32_16x16x32_bf16 v[152:155], a[128:131], a[12:15], v[152:155]
  buffer_load_dwordx4 a[72:75], v3, s[8:11], s59 offen offset:2048 sc1
  s_mul_i32 s44, s44, 49152
  s_add_u32 s44, s44, s56
  s_add_u32 s44, s44, 0x1a00000
  v_mfma_f32_16x16x32_bf16 v[152:155], a[132:135], a[28:31], v[152:155]
  s_cmp_eq_u32 s30, 3
  s_cselect_b32 s45, 0, s30
  s_waitcnt lgkmcnt(2)
  v_mfma_f32_16x16x32_bf16 v[132:135], a[136:139], a[0:3], v[132:135]
  ds_read_b128 a[152:155], v10 offset:17408
  s_cmp_eq_u32 s45, 0
  s_cselect_b32 s46, 1, 0
  v_mfma_f32_16x16x32_bf16 v[132:135], a[140:143], a[16:19], v[132:135]
  buffer_load_dwordx4 a[76:79], v3, s[8:11], s59 offen offset:3072 sc1
  s_add_u32 s59, s59, 0x20000
  s_cmp_eq_u32 s45, 2
  s_cselect_b32 s47, 1, 2
  v_mfma_f32_16x16x32_bf16 v[140:143], a[136:139], a[4:7], v[140:143]
  s_lshl_b32 s52, s45, 7
  s_add_u32 s52, s52, s43
  s_lshl_b32 s45, s45, 14
  v_mfma_f32_16x16x32_bf16 v[140:143], a[140:143], a[20:23], v[140:143]
  buffer_load_dwordx4 a[80:83], v3, s[8:11], s59 offen offset:0 sc1
  s_add_u32 s45, s45, s44
  v_mfma_f32_16x16x32_bf16 v[148:151], a[136:139], a[8:11], v[148:151]
  ds_read_b128 a[156:159], v10 offset:25600
  s_lshl_b32 s53, s46, 7
  s_add_u32 s53, s53, s43
  s_lshl_b32 s46, s46, 14
  v_mfma_f32_16x16x32_bf16 v[148:151], a[140:143], a[24:27], v[148:151]
  s_add_u32 s46, s46, s44
  v_mfma_f32_16x16x32_bf16 v[156:159], a[136:139], a[12:15], v[156:159]
  buffer_load_dwordx4 a[84:87], v3, s[8:11], s59 offen offset:1024 sc1
  s_lshl_b32 s48, s47, 7
  s_add_u32 s48, s48, s43
  s_lshl_b32 s47, s47, 14
  v_mfma_f32_16x16x32_bf16 v[156:159], a[140:143], a[28:31], v[156:159]
  s_add_u32 s47, s47, s44
  s_waitcnt vmcnt(7)
  s_waitcnt lgkmcnt(2)
  v_mfma_f32_16x16x32_bf16 v[128:131], a[144:147], a[32:35], v[128:131]
  ds_read_b128 a[128:131], v10 offset:2048
  s_add_u32 s38, s30, 1
  s_and_b32 s38, s38, 3
  s_lshl_b32 s38, s38, 6
  v_mfma_f32_16x16x32_bf16 v[128:131], a[148:151], a[48:51], v[128:131]
  buffer_load_dwordx4 a[88:91], v3, s[8:11], s59 offen offset:2048 sc1
  s_add_u32 s38, s38, s37
  s_mul_i32 s43, s38, 1536
  s_mul_i32 s38, s38, 49152
  v_mfma_f32_16x16x32_bf16 v[136:139], a[144:147], a[36:39], v[136:139]
  s_add_u32 s38, s38, s56
  s_add_u32 s40, s38, 0x1a00000
  s_add_u32 s43, s43, s39
  v_mfma_f32_16x16x32_bf16 v[136:139], a[148:151], a[52:55], v[136:139]
  buffer_load_dwordx4 a[92:95], v3, s[8:11], s59 offen offset:3072 sc1
  s_add_u32 s59, s59, 0x20000
  s_add_u32 s72, s43, 0x1820000
  v_mfma_f32_16x16x32_bf16 v[144:147], a[144:147], a[40:43], v[144:147]
  ds_read_b128 a[132:135], v10 offset:10240
  s_add_u32 s38, s30, 2
  s_and_b32 s38, s38, 3
  s_lshl_b32 s38, s38, 6
  v_mfma_f32_16x16x32_bf16 v[144:147], a[148:151], a[56:59], v[144:147]
  s_add_u32 s38, s38, s37
  s_mul_i32 s43, s38, 1536
  s_mul_i32 s38, s38, 49152
  v_mfma_f32_16x16x32_bf16 v[152:155], a[144:147], a[44:47], v[152:155]
  buffer_load_dwordx4 a[96:99], v3, s[8:11], s59 offen offset:0 sc1
  s_add_u32 s38, s38, s56
  s_add_u32 s41, s38, 0x1a04000
  s_add_u32 s43, s43, s39
  v_mfma_f32_16x16x32_bf16 v[152:155], a[148:151], a[60:63], v[152:155]
  s_add_u32 s73, s43, 0x1820080
  s_waitcnt lgkmcnt(2)
  v_mfma_f32_16x16x32_bf16 v[132:135], a[152:155], a[32:35], v[132:135]
  ds_read_b128 a[136:139], v10 offset:3072
  s_add_u32 s38, s30, 3
  s_and_b32 s38, s38, 3
  s_lshl_b32 s38, s38, 6
  v_mfma_f32_16x16x32_bf16 v[132:135], a[156:159], a[48:51], v[132:135]
  buffer_load_dwordx4 a[100:103], v3, s[8:11], s59 offen offset:1024 sc1
  s_add_u32 s38, s38, s37
  s_mul_i32 s43, s38, 1536
  s_mul_i32 s38, s38, 49152
  v_mfma_f32_16x16x32_bf16 v[140:143], a[152:155], a[36:39], v[140:143]
  s_add_u32 s38, s38, s56
  s_add_u32 s42, s38, 0x1a08000
  s_add_u32 s43, s43, s39
  v_mfma_f32_16x16x32_bf16 v[140:143], a[156:159], a[52:55], v[140:143]
  buffer_load_dwordx4 a[104:107], v3, s[8:11], s59 offen offset:2048 sc1
  s_add_u32 s74, s43, 0x1820100
  v_mfma_f32_16x16x32_bf16 v[148:151], a[152:155], a[40:43], v[148:151]
  ds_read_b128 a[140:143], v10 offset:11264
  s_mov_b32 s49, 0
  v_mfma_f32_16x16x32_bf16 v[148:151], a[156:159], a[56:59], v[148:151]
  v_mov_b32 v19, 0x40000000
  v_mfma_f32_16x16x32_bf16 v[156:159], a[152:155], a[44:47], v[156:159]
  buffer_load_dwordx4 a[108:111], v3, s[8:11], s59 offen offset:3072 sc1
  s_add_u32 s59, s59, 0x20000
  v_writelane_b32 v19, s52, 0
  v_mfma_f32_16x16x32_bf16 v[156:159], a[156:159], a[60:63], v[156:159]
  v_writelane_b32 v19, s53, 1
  s_waitcnt lgkmcnt(2)
  v_mfma_f32_16x16x32_bf16 v[160:163], a[128:131], a[0:3], v[160:163]
  ds_read_b128 a[144:147], v10 offset:18432
  v_writelane_b32 v19, s48, 2
  v_mfma_f32_16x16x32_bf16 v[160:163], a[132:135], a[16:19], v[160:163]
  buffer_load_dwordx4 a[112:115], v3, s[8:11], s59 offen offset:0 sc1
  v_mfma_f32_16x16x32_bf16 v[168:171], a[128:131], a[4:7], v[168:171]
  v_mfma_f32_16x16x32_bf16 v[168:171], a[132:135], a[20:23], v[168:171]
  buffer_load_dwordx4 a[116:119], v3, s[8:11], s59 offen offset:1024 sc1
  v_mfma_f32_16x16x32_bf16 v[176:179], a[128:131], a[8:11], v[176:179]
  ds_read_b128 a[148:151], v10 offset:26624
  v_mfma_f32_16x16x32_bf16 v[176:179], a[132:135], a[24:27], v[176:179]
  v_mfma_f32_16x16x32_bf16 v[184:187], a[128:131], a[12:15], v[184:187]
  buffer_load_dwordx4 a[120:123], v3, s[8:11], s59 offen offset:2048 sc1
  v_mfma_f32_16x16x32_bf16 v[184:187], a[132:135], a[28:31], v[184:187]
  s_waitcnt lgkmcnt(2)
  v_mfma_f32_16x16x32_bf16 v[164:167], a[136:139], a[0:3], v[164:167]
  ds_read_b128 a[152:155], v10 offset:19456
  v_mfma_f32_16x16x32_bf16 v[164:167], a[140:143], a[16:19], v[164:167]
  buffer_load_dwordx4 a[124:127], v3, s[8:11], s59 offen offset:3072 sc1
  s_add_u32 s59, s59, 0x20000
  v_mfma_f32_16x16x32_bf16 v[172:175], a[136:139], a[4:7], v[172:175]
  v_mfma_f32_16x16x32_bf16 v[172:175], a[140:143], a[20:23], v[172:175]
  v_mfma_f32_16x16x32_bf16 v[180:183], a[136:139], a[8:11], v[180:183]
  ds_read_b128 a[156:159], v10 offset:27648
  v_mfma_f32_16x16x32_bf16 v[180:183], a[140:143], a[24:27], v[180:183]
  v_mfma_f32_16x16x32_bf16 v[188:191], a[136:139], a[12:15], v[188:191]
  v_mfma_f32_16x16x32_bf16 v[188:191], a[140:143], a[28:31], v[188:191]
  s_waitcnt lgkmcnt(2)
  v_mfma_f32_16x16x32_bf16 v[160:163], a[144:147], a[32:35], v[160:163]
  ds_read_b128 a[128:131], v10 offset:32768
  v_mfma_f32_16x16x32_bf16 v[160:163], a[148:151], a[48:51], v[160:163]
  v_mfma_f32_16x16x32_bf16 v[168:171], a[144:147], a[36:39], v[168:171]
  v_mfma_f32_16x16x32_bf16 v[168:171], a[148:151], a[52:55], v[168:171]
  v_mfma_f32_16x16x32_bf16 v[176:179], a[144:147], a[40:43], v[176:179]
  ds_read_b128 a[132:135], v10 offset:40960
  v_mfma_f32_16x16x32_bf16 v[176:179], a[148:151], a[56:59], v[176:179]
  v_mfma_f32_16x16x32_bf16 v[184:187], a[144:147], a[44:47], v[184:187]
  v_mfma_f32_16x16x32_bf16 v[184:187], a[148:151], a[60:63], v[184:187]
  s_waitcnt lgkmcnt(2)
  v_mfma_f32_16x16x32_bf16 v[164:167], a[152:155], a[32:35], v[164:167]
  ds_read_b128 a[136:139], v10 offset:33792
  v_mfma_f32_16x16x32_bf16 v[164:167], a[156:159], a[48:51], v[164:167]
  v_mfma_f32_16x16x32_bf16 v[172:175], a[152:155], a[36:39], v[172:175]
  v_mfma_f32_16x16x32_bf16 v[172:175], a[156:159], a[52:55], v[172:175]
  v_mfma_f32_16x16x32_bf16 v[180:183], a[152:155], a[40:43], v[180:183]
  ds_read_b128 a[140:143], v10 offset:41984
  v_mfma_f32_16x16x32_bf16 v[180:183], a[156:159], a[56:59], v[180:183]
  v_mfma_f32_16x16x32_bf16 v[188:191], a[152:155], a[44:47], v[188:191]
  v_mfma_f32_16x16x32_bf16 v[188:191], a[156:159], a[60:63], v[188:191]
  s_barrier
  s_waitcnt vmcnt(8)
  s_waitcnt lgkmcnt(2)
  v_mfma_f32_16x16x32_bf16 v[128:131], a[128:131], a[64:67], v[128:131]
  ds_read_b128 a[144:147], v5 offset:0
  v_mfma_f32_16x16x32_bf16 v[128:131], a[132:135], a[80:83], v[128:131]
  buffer_load_dwordx2 v[22:23], v19, s[24:27], 0 offen sc1
  v_mfma_f32_16x16x32_bf16 v[136:139], a[128:131], a[68:71], v[136:139]
  v_mfma_f32_16x16x32_bf16 v[136:139], a[132:135], a[84:87], v[136:139]
  v_mfma_f32_16x16x32_bf16 v[144:147], a[128:131], a[72:75], v[144:147]
  ds_read_b128 a[148:151], v5 offset:8192
  v_mfma_f32_16x16x32_bf16 v[144:147], a[132:135], a[88:91], v[144:147]
  v_mfma_f32_16x16x32_bf16 v[152:155], a[128:131], a[76:79], v[152:155]
  v_mfma_f32_16x16x32_bf16 v[152:155], a[132:135], a[92:95], v[152:155]
  s_waitcnt lgkmcnt(2)
  v_mfma_f32_16x16x32_bf16 v[132:135], a[136:139], a[64:67], v[132:135]
  ds_read_b128 a[152:155], v5 offset:1024
  v_mfma_f32_16x16x32_bf16 v[132:135], a[140:143], a[80:83], v[132:135]
  v_mfma_f32_16x16x32_bf16 v[140:143], a[136:139], a[68:71], v[140:143]
  v_mfma_f32_16x16x32_bf16 v[140:143], a[140:143], a[84:87], v[140:143]
  v_mfma_f32_16x16x32_bf16 v[148:151], a[136:139], a[72:75], v[148:151]
  ds_read_b128 a[156:159], v5 offset:9216
  v_mfma_f32_16x16x32_bf16 v[148:151], a[140:143], a[88:91], v[148:151]
  v_mfma_f32_16x16x32_bf16 v[156:159], a[136:139], a[76:79], v[156:159]
  v_mfma_f32_16x16x32_bf16 v[156:159], a[140:143], a[92:95], v[156:159]
  s_waitcnt vmcnt(1)
  s_waitcnt lgkmcnt(2)
  v_mfma_f32_16x16x32_bf16 v[128:131], a[144:147], a[96:99], v[128:131]
  ds_read_b128 a[128:131], v10 offset:34816
  v_mfma_f32_16x16x32_bf16 v[128:131], a[148:151], a[112:115], v[128:131]
  v_mfma_f32_16x16x32_bf16 v[136:139], a[144:147], a[100:103], v[136:139]
  v_mfma_f32_16x16x32_bf16 v[136:139], a[148:151], a[116:119], v[136:139]
  v_mfma_f32_16x16x32_bf16 v[144:147], a[144:147], a[104:107], v[144:147]
  ds_read_b128 a[132:135], v10 offset:43008
  v_mfma_f32_16x16x32_bf16 v[144:147], a[148:151], a[120:123], v[144:147]
  v_mfma_f32_16x16x32_bf16 v[152:155], a[144:147], a[108:111], v[152:155]
  v_mfma_f32_16x16x32_bf16 v[152:155], a[148:151], a[124:127], v[152:155]
  s_waitcnt lgkmcnt(2)
  v_mfma_f32_16x16x32_bf16 v[132:135], a[152:155], a[96:99], v[132:135]
  ds_read_b128 a[136:139], v10 offset:35840
  v_mfma_f32_16x16x32_bf16 v[132:135], a[156:159], a[112:115], v[132:135]
  v_mfma_f32_16x16x32_bf16 v[140:143], a[152:155], a[100:103], v[140:143]
  v_mfma_f32_16x16x32_bf16 v[140:143], a[156:159], a[116:119], v[140:143]
  v_mfma_f32_16x16x32_bf16 v[148:151], a[152:155], a[104:107], v[148:151]
  ds_read_b128 a[140:143], v10 offset:44032
  v_mfma_f32_16x16x32_bf16 v[148:151], a[156:159], a[120:123], v[148:151]
  v_mfma_f32_16x16x32_bf16 v[156:159], a[152:155], a[108:111], v[156:159]
  v_mfma_f32_16x16x32_bf16 v[156:159], a[156:159], a[124:127], v[156:159]
  s_waitcnt lgkmcnt(2)
  v_mfma_f32_16x16x32_bf16 v[160:163], a[128:131], a[64:67], v[160:163]
  ds_read_b128 a[144:147], v5 offset:2048
  v_cvt_pk_bf16_f32 v128, v128, v129
  v_mfma_f32_16x16x32_bf16 v[160:163], a[132:135], a[80:83], v[160:163]
  v_cvt_pk_bf16_f32 v129, v130, v131
  v_cvt_pk_bf16_f32 v130, v132, v133
  v_mfma_f32_16x16x32_bf16 v[168:171], a[128:131], a[68:71], v[168:171]
  v_cvt_pk_bf16_f32 v131, v134, v135
  buffer_store_dwordx4 v[128:131], v21, s[24:27], s40 offen offset:0 sc1
  v_mfma_f32_16x16x32_bf16 v[168:171], a[132:135], a[84:87], v[168:171]
  v_cvt_pk_bf16_f32 v136, v136, v137
  v_cvt_pk_bf16_f32 v137, v138, v139
  v_mfma_f32_16x16x32_bf16 v[176:179], a[128:131], a[72:75], v[176:179]
  ds_read_b128 a[148:151], v5 offset:10240
  v_cvt_pk_bf16_f32 v138, v140, v141
  v_mfma_f32_16x16x32_bf16 v[176:179], a[132:135], a[88:91], v[176:179]
  v_cvt_pk_bf16_f32 v139, v142, v143
  buffer_store_dwordx4 v[136:139], v21, s[24:27], s40 offen offset:1024 sc1
  v_mfma_f32_16x16x32_bf16 v[184:187], a[128:131], a[76:79], v[184:187]
  v_cvt_pk_bf16_f32 v144, v144, v145
  v_cvt_pk_bf16_f32 v145, v146, v147
  v_mfma_f32_16x16x32_bf16 v[184:187], a[132:135], a[92:95], v[184:187]
  v_cvt_pk_bf16_f32 v146, v148, v149
  v_cvt_pk_bf16_f32 v147, v150, v151
  s_waitcnt lgkmcnt(2)
  v_mfma_f32_16x16x32_bf16 v[164:167], a[136:139], a[64:67], v[164:167]
  ds_read_b128 a[152:155], v5 offset:3072
  buffer_store_dwordx4 v[144:147], v21, s[24:27], s40 offen offset:2048 sc1
  v_mfma_f32_16x16x32_bf16 v[164:167], a[140:143], a[80:83], v[164:167]
  v_cvt_pk_bf16_f32 v152, v152, v153
  v_cvt_pk_bf16_f32 v153, v154, v155
  v_mfma_f32_16x16x32_bf16 v[172:175], a[136:139], a[68:71], v[172:175]
  v_cvt_pk_bf16_f32 v154, v156, v157
  v_cvt_pk_bf16_f32 v155, v158, v159
  v_mfma_f32_16x16x32_bf16 v[172:175], a[140:143], a[84:87], v[172:175]
  buffer_store_dwordx4 v[152:155], v21, s[24:27], s40 offen offset:3072 sc1
  v_mfma_f32_16x16x32_bf16 v[180:183], a[136:139], a[72:75], v[180:183]
  ds_read_b128 a[156:159], v5 offset:11264
  v_mfma_f32_16x16x32_bf16 v[180:183], a[140:143], a[88:91], v[180:183]
  v_mfma_f32_16x16x32_bf16 v[188:191], a[136:139], a[76:79], v[188:191]
  v_mfma_f32_16x16x32_bf16 v[188:191], a[140:143], a[92:95], v[188:191]
  s_waitcnt lgkmcnt(2)
  v_mfma_f32_16x16x32_bf16 v[160:163], a[144:147], a[96:99], v[160:163]
  ds_read_b128 a[128:131], v10 offset:4096
  v_mfma_f32_16x16x32_bf16 v[160:163], a[148:151], a[112:115], v[160:163]
  v_mfma_f32_16x16x32_bf16 v[168:171], a[144:147], a[100:103], v[168:171]
  v_mfma_f32_16x16x32_bf16 v[168:171], a[148:151], a[116:119], v[168:171]
  v_mfma_f32_16x16x32_bf16 v[176:179], a[144:147], a[104:107], v[176:179]
  ds_read_b128 a[132:135], v10 offset:12288
  v_mfma_f32_16x16x32_bf16 v[176:179], a[148:151], a[120:123], v[176:179]
  v_mfma_f32_16x16x32_bf16 v[184:187], a[144:147], a[108:111], v[184:187]
  v_mfma_f32_16x16x32_bf16 v[184:187], a[148:151], a[124:127], v[184:187]
  s_waitcnt lgkmcnt(2)
  v_mfma_f32_16x16x32_bf16 v[164:167], a[152:155], a[96:99], v[164:167]
  ds_read_b128 a[136:139], v10 offset:5120
  v_mfma_f32_16x16x32_bf16 v[164:167], a[156:159], a[112:115], v[164:167]
  s_waitcnt vmcnt(4)
  v_cmp_eq_u64 vcc, v[22:23], v[12:13]
  s_nop 0
  s_andn2_b32 s39, vcc_lo, s49
  s_or_b32 s49, s49, s39
  s_bitcmp0_b32 s39, 0
  s_cbranch_scc1 L_gb_no00
  buffer_load_dwordx4 v[32:35], v21, s[24:27], s45 offen offset:0 sc1
  buffer_load_dwordx4 v[36:39], v21, s[24:27], s45 offen offset:1024 sc1
  buffer_load_dwordx4 v[40:43], v21, s[24:27], s45 offen offset:2048 sc1
  buffer_load_dwordx4 v[44:47], v21, s[24:27], s45 offen offset:3072 sc1
L_gb_no00:
  s_bitcmp0_b32 s39, 1
  s_cbranch_scc1 L_gb_no01
  buffer_load_dwordx4 v[48:51], v21, s[24:27], s46 offen offset:0 sc1
  buffer_load_dwordx4 v[52:55], v21, s[24:27], s46 offen offset:1024 sc1
  buffer_load_dwordx4 v[56:59], v21, s[24:27], s46 offen offset:2048 sc1
  buffer_load_dwordx4 v[60:63], v21, s[24:27], s46 offen offset:3072 sc1
L_gb_no01:
  s_bitcmp0_b32 s39, 2
  s_cbranch_scc1 L_gb_no02
  buffer_load_dwordx4 v[64:67], v21, s[24:27], s47 offen offset:0 sc1
  buffer_load_dwordx4 v[68:71], v21, s[24:27], s47 offen offset:1024 sc1
  buffer_load_dwordx4 v[72:75], v21, s[24:27], s47 offen offset:2048 sc1
  buffer_load_dwordx4 v[76:79], v21, s[24:27], s47 offen offset:3072 sc1
L_gb_no02:
  v_mfma_f32_16x16x32_bf16 v[172:175], a[152:155], a[100:103], v[172:175]
  v_mfma_f32_16x16x32_bf16 v[172:175], a[156:159], a[116:119], v[172:175]
  v_mfma_f32_16x16x32_bf16 v[180:183], a[152:155], a[104:107], v[180:183]
  ds_read_b128 a[140:143], v10 offset:13312
  v_mfma_f32_16x16x32_bf16 v[180:183], a[156:159], a[120:123], v[180:183]
  v_mfma_f32_16x16x32_bf16 v[188:191], a[152:155], a[108:111], v[188:191]
  v_mfma_f32_16x16x32_bf16 v[188:191], a[156:159], a[124:127], v[188:191]
  s_waitcnt lgkmcnt(2)
  v_mfma_f32_16x16x32_bf16 v[192:195], a[128:131], a[0:3], v[192:195]
  ds_read_b128 a[144:147], v10 offset:20480
  v_cvt_pk_bf16_f32 v160, v160, v161
  v_mfma_f32_16x16x32_bf16 v[192:195], a[132:135], a[16:19], v[192:195]
  v_cvt_pk_bf16_f32 v161, v162, v163
  v_cvt_pk_bf16_f32 v162, v164, v165
  v_mfma_f32_16x16x32_bf16 v[200:203], a[128:131], a[4:7], v[200:203]
  v_cvt_pk_bf16_f32 v163, v166, v167
  buffer_store_dwordx4 v[160:163], v21, s[24:27], s41 offen offset:0 sc1
  v_mfma_f32_16x16x32_bf16 v[200:203], a[132:135], a[20:23], v[200:203]
  v_cvt_pk_bf16_f32 v168, v168, v169
  v_cvt_pk_bf16_f32 v169, v170, v171
  v_mfma_f32_16x16x32_bf16 v[208:211], a[128:131], a[8:11], v[208:211]
  ds_read_b128 a[148:151], v10 offset:28672
  v_cvt_pk_bf16_f32 v170, v172, v173
  v_mfma_f32_16x16x32_bf16 v[208:211], a[132:135], a[24:27], v[208:211]
  v_cvt_pk_bf16_f32 v171, v174, v175
  buffer_store_dwordx4 v[168:171], v21, s[24:27], s41 offen offset:1024 sc1
  v_mfma_f32_16x16x32_bf16 v[216:219], a[128:131], a[12:15], v[216:219]
  v_cvt_pk_bf16_f32 v176, v176, v177
  v_cvt_pk_bf16_f32 v177, v178, v179
  v_mfma_f32_16x16x32_bf16 v[216:219], a[132:135], a[28:31], v[216:219]
  v_cvt_pk_bf16_f32 v178, v180, v181
  v_cvt_pk_bf16_f32 v179, v182, v183
  s_waitcnt lgkmcnt(2)
  v_mfma_f32_16x16x32_bf16 v[196:199], a[136:139], a[0:3], v[196:199]
  ds_read_b128 a[152:155], v10 offset:21504
  buffer_store_dwordx4 v[176:179], v21, s[24:27], s41 offen offset:2048 sc1
  v_mfma_f32_16x16x32_bf16 v[196:199], a[140:143], a[16:19], v[196:199]
  v_cvt_pk_bf16_f32 v184, v184, v185
  v_cvt_pk_bf16_f32 v185, v186, v187
  v_mfma_f32_16x16x32_bf16 v[204:207], a[136:139], a[4:7], v[204:207]
  v_cvt_pk_bf16_f32 v186, v188, v189
  v_cvt_pk_bf16_f32 v187, v190, v191
  v_mfma_f32_16x16x32_bf16 v[204:207], a[140:143], a[20:23], v[204:207]
  buffer_store_dwordx4 v[184:187], v21, s[24:27], s41 offen offset:3072 sc1
  v_mfma_f32_16x16x32_bf16 v[212:215], a[136:139], a[8:11], v[212:215]
  ds_read_b128 a[156:159], v10 offset:29696
  v_mfma_f32_16x16x32_bf16 v[212:215], a[140:143], a[24:27], v[212:215]
  v_mfma_f32_16x16x32_bf16 v[220:223], a[136:139], a[12:15], v[220:223]
  v_mfma_f32_16x16x32_bf16 v[220:223], a[140:143], a[28:31], v[220:223]
  s_waitcnt lgkmcnt(2)
  v_mfma_f32_16x16x32_bf16 v[192:195], a[144:147], a[32:35], v[192:195]
  ds_read_b128 a[128:131], v10 offset:36864
  v_mfma_f32_16x16x32_bf16 v[192:195], a[148:151], a[48:51], v[192:195]
  v_accvgpr_read_b32 v96, a192
  v_mfma_f32_16x16x32_bf16 v[200:203], a[144:147], a[36:39], v[200:203]
  v_accvgpr_read_b32 v97, a193
  v_mfma_f32_16x16x32_bf16 v[200:203], a[148:151], a[52:55], v[200:203]
  v_accvgpr_read_b32 v98, a194
  v_mfma_f32_16x16x32_bf16 v[208:211], a[144:147], a[40:43], v[208:211]
  ds_read_b128 a[132:135], v10 offset:45056
  v_mfma_f32_16x16x32_bf16 v[208:211], a[148:151], a[56:59], v[208:211]
  v_accvgpr_read_b32 v99, a195
  v_mfma_f32_16x16x32_bf16 v[216:219], a[144:147], a[44:47], v[216:219]
  v_accvgpr_read_b32 v100, a196
  v_mfma_f32_16x16x32_bf16 v[216:219], a[148:151], a[60:63], v[216:219]
  v_accvgpr_read_b32 v101, a197
  s_waitcnt lgkmcnt(2)
  v_mfma_f32_16x16x32_bf16 v[196:199], a[152:155], a[32:35], v[196:199]
  ds_read_b128 a[136:139], v10 offset:37888
  v_mfma_f32_16x16x32_bf16 v[196:199], a[156:159], a[48:51], v[196:199]
  v_accvgpr_read_b32 v102, a198
  v_mfma_f32_16x16x32_bf16 v[204:207], a[152:155], a[36:39], v[204:207]
  v_accvgpr_read_b32 v103, a199
  v_mfma_f32_16x16x32_bf16 v[204:207], a[156:159], a[52:55], v[204:207]
  v_accvgpr_read_b32 v104, a200
  v_mfma_f32_16x16x32_bf16 v[212:215], a[152:155], a[40:43], v[212:215]
  ds_read_b128 a[140:143], v10 offset:46080
  v_mfma_f32_16x16x32_bf16 v[212:215], a[156:159], a[56:59], v[212:215]
  v_accvgpr_read_b32 v105, a201
  v_mfma_f32_16x16x32_bf16 v[220:223], a[152:155], a[44:47], v[220:223]
  v_accvgpr_read_b32 v106, a202
  v_mfma_f32_16x16x32_bf16 v[220:223], a[156:159], a[60:63], v[220:223]
  v_accvgpr_read_b32 v107, a203
  s_waitcnt lgkmcnt(2)
  v_mfma_f32_16x16x32_bf16 v[192:195], a[128:131], a[64:67], v[192:195]
  ds_read_b128 a[144:147], v5 offset:4096
  v_mfma_f32_16x16x32_bf16 v[192:195], a[132:135], a[80:83], v[192:195]
  v_accvgpr_read_b32 v108, a204
  v_mfma_f32_16x16x32_bf16 v[200:203], a[128:131], a[68:71], v[200:203]
  v_accvgpr_read_b32 v109, a205
  v_mfma_f32_16x16x32_bf16 v[200:203], a[132:135], a[84:87], v[200:203]
  v_accvgpr_read_b32 v110, a206
  v_mfma_f32_16x16x32_bf16 v[208:211], a[128:131], a[72:75], v[208:211]
  ds_read_b128 a[148:151], v5 offset:12288
  v_mfma_f32_16x16x32_bf16 v[208:211], a[132:135], a[88:91], v[208:211]
  v_accvgpr_read_b32 v111, a207
  v_mfma_f32_16x16x32_bf16 v[216:219], a[128:131], a[76:79], v[216:219]
  v_permlane16_swap_b32 v96, v98
  v_mfma_f32_16x16x32_bf16 v[216:219], a[132:135], a[92:95], v[216:219]
  v_permlane16_swap_b32 v97, v99
  s_waitcnt lgkmcnt(2)
  v_mfma_f32_16x16x32_bf16 v[196:199], a[136:139], a[64:67], v[196:199]
  ds_read_b128 a[152:155], v5 offset:5120
  v_mfma_f32_16x16x32_bf16 v[196:199], a[140:143], a[80:83], v[196:199]
  v_permlane16_swap_b32 v100, v102
  v_mfma_f32_16x16x32_bf16 v[204:207], a[136:139], a[68:71], v[204:207]
  v_permlane16_swap_b32 v101, v103
  v_mfma_f32_16x16x32_bf16 v[204:207], a[140:143], a[84:87], v[204:207]
  v_permlane16_swap_b32 v104, v106
  v_mfma_f32_16x16x32_bf16 v[212:215], a[136:139], a[72:75], v[212:215]
  ds_read_b128 a[156:159], v5 offset:13312
  v_mfma_f32_16x16x32_bf16 v[212:215], a[140:143], a[88:91], v[212:215]
  v_permlane16_swap_b32 v105, v107
  v_mfma_f32_16x16x32_bf16 v[220:223], a[136:139], a[76:79], v[220:223]
  v_permlane16_swap_b32 v108, v110
  v_mfma_f32_16x16x32_bf16 v[220:223], a[140:143], a[92:95], v[220:223]
  v_permlane16_swap_b32 v109, v111
  s_waitcnt lgkmcnt(2)
  v_mfma_f32_16x16x32_bf16 v[192:195], a[144:147], a[96:99], v[192:195]
  ds_read_b128 a[128:131], v10 offset:6144
  v_mfma_f32_16x16x32_bf16 v[192:195], a[148:151], a[112:115], v[192:195]
  v_mfma_f32_16x16x32_bf16 v[200:203], a[144:147], a[100:103], v[200:203]
  v_mfma_f32_16x16x32_bf16 v[200:203], a[148:151], a[116:119], v[200:203]
  v_mfma_f32_16x16x32_bf16 v[208:211], a[144:147], a[104:107], v[208:211]
  ds_read_b128 a[132:135], v10 offset:14336
  v_mfma_f32_16x16x32_bf16 v[208:211], a[148:151], a[120:123], v[208:211]
  v_mfma_f32_16x16x32_bf16 v[216:219], a[144:147], a[108:111], v[216:219]
  v_mfma_f32_16x16x32_bf16 v[216:219], a[148:151], a[124:127], v[216:219]
  s_waitcnt lgkmcnt(2)
  v_mfma_f32_16x16x32_bf16 v[196:199], a[152:155], a[96:99], v[196:199]
  ds_read_b128 a[136:139], v10 offset:7168
  v_mfma_f32_16x16x32_bf16 v[196:199], a[156:159], a[112:115], v[196:199]
  s_waitcnt vmcnt(4)
  buffer_store_dwordx2 v[12:13], v20, s[24:27], s72 offen sc1
  v_mfma_f32_16x16x32_bf16 v[204:207], a[152:155], a[100:103], v[204:207]
  v_mfma_f32_16x16x32_bf16 v[204:207], a[156:159], a[116:119], v[204:207]
  v_mfma_f32_16x16x32_bf16 v[212:215], a[152:155], a[104:107], v[212:215]
  ds_read_b128 a[140:143], v10 offset:15360
  v_mfma_f32_16x16x32_bf16 v[212:215], a[156:159], a[120:123], v[212:215]
  v_mfma_f32_16x16x32_bf16 v[220:223], a[152:155], a[108:111], v[220:223]
  v_mfma_f32_16x16x32_bf16 v[220:223], a[156:159], a[124:127], v[220:223]
  s_waitcnt lgkmcnt(2)
  v_mfma_f32_16x16x32_bf16 v[224:227], a[128:131], a[0:3], v[224:227]
  ds_read_b128 a[144:147], v10 offset:22528
  v_cvt_pk_bf16_f32 v192, v192, v193
  v_mfma_f32_16x16x32_bf16 v[224:227], a[132:135], a[16:19], v[224:227]
  v_cvt_pk_bf16_f32 v193, v194, v195
  v_cvt_pk_bf16_f32 v194, v196, v197
  v_mfma_f32_16x16x32_bf16 v[232:235], a[128:131], a[4:7], v[232:235]
  v_cvt_pk_bf16_f32 v195, v198, v199
  buffer_store_dwordx4 v[192:195], v21, s[24:27], s42 offen offset:0 sc1
  v_mfma_f32_16x16x32_bf16 v[232:235], a[132:135], a[20:23], v[232:235]
  v_cvt_pk_bf16_f32 v200, v200, v201
  v_cvt_pk_bf16_f32 v201, v202, v203
  v_mfma_f32_16x16x32_bf16 v[240:243], a[128:131], a[8:11], v[240:243]
  ds_read_b128 a[148:151], v10 offset:30720
  v_cvt_pk_bf16_f32 v202, v204, v205
  v_mfma_f32_16x16x32_bf16 v[240:243], a[132:135], a[24:27], v[240:243]
  v_cvt_pk_bf16_f32 v203, v206, v207
  buffer_store_dwordx4 v[200:203], v21, s[24:27], s42 offen offset:1024 sc1
  v_mfma_f32_16x16x32_bf16 v[248:251], a[128:131], a[12:15], v[248:251]
  v_cvt_pk_bf16_f32 v208, v208, v209
  v_cvt_pk_bf16_f32 v209, v210, v211
  v_mfma_f32_16x16x32_bf16 v[248:251], a[132:135], a[28:31], v[248:251]
  v_cvt_pk_bf16_f32 v210, v212, v213
  v_cvt_pk_bf16_f32 v211, v214, v215
  s_waitcnt lgkmcnt(2)
  v_mfma_f32_16x16x32_bf16 v[228:231], a[136:139], a[0:3], v[228:231]
  ds_read_b128 a[152:155], v10 offset:23552
  buffer_store_dwordx4 v[208:211], v21, s[24:27], s42 offen offset:2048 sc1
  v_mfma_f32_16x16x32_bf16 v[228:231], a[140:143], a[16:19], v[228:231]
  v_cvt_pk_bf16_f32 v216, v216, v217
  v_cvt_pk_bf16_f32 v217, v218, v219
  v_mfma_f32_16x16x32_bf16 v[236:239], a[136:139], a[4:7], v[236:239]
  v_cvt_pk_bf16_f32 v218, v220, v221
  v_cvt_pk_bf16_f32 v219, v222, v223
  v_mfma_f32_16x16x32_bf16 v[236:239], a[140:143], a[20:23], v[236:239]
  buffer_store_dwordx4 v[216:219], v21, s[24:27], s42 offen offset:3072 sc1
  v_mfma_f32_16x16x32_bf16 v[244:247], a[136:139], a[8:11], v[244:247]
  ds_read_b128 a[156:159], v10 offset:31744
  v_mfma_f32_16x16x32_bf16 v[244:247], a[140:143], a[24:27], v[244:247]
  v_mfma_f32_16x16x32_bf16 v[252:255], a[136:139], a[12:15], v[252:255]
  v_mfma_f32_16x16x32_bf16 v[252:255], a[140:143], a[28:31], v[252:255]
  s_waitcnt lgkmcnt(2)
  v_mfma_f32_16x16x32_bf16 v[224:227], a[144:147], a[32:35], v[224:227]
  ds_read_b128 a[128:131], v10 offset:38912
  v_mfma_f32_16x16x32_bf16 v[224:227], a[148:151], a[48:51], v[224:227]
  v_mfma_f32_16x16x32_bf16 v[232:235], a[144:147], a[36:39], v[232:235]
  v_mfma_f32_16x16x32_bf16 v[232:235], a[148:151], a[52:55], v[232:235]
  v_mfma_f32_16x16x32_bf16 v[240:243], a[144:147], a[40:43], v[240:243]
  ds_read_b128 a[132:135], v10 offset:47104
  v_mfma_f32_16x16x32_bf16 v[240:243], a[148:151], a[56:59], v[240:243]
  v_mfma_f32_16x16x32_bf16 v[248:251], a[144:147], a[44:47], v[248:251]
  v_mfma_f32_16x16x32_bf16 v[248:251], a[148:151], a[60:63], v[248:251]
  s_waitcnt lgkmcnt(2)
  v_mfma_f32_16x16x32_bf16 v[228:231], a[152:155], a[32:35], v[228:231]
  ds_read_b128 a[136:139], v10 offset:39936
  v_mfma_f32_16x16x32_bf16 v[228:231], a[156:159], a[48:51], v[228:231]
  v_mfma_f32_16x16x32_bf16 v[236:239], a[152:155], a[36:39], v[236:239]
  v_mfma_f32_16x16x32_bf16 v[236:239], a[156:159], a[52:55], v[236:239]
  v_mfma_f32_16x16x32_bf16 v[244:247], a[152:155], a[40:43], v[244:247]
  ds_read_b128 a[140:143], v10 offset:48128
  v_mfma_f32_16x16x32_bf16 v[244:247], a[156:159], a[56:59], v[244:247]
  v_mfma_f32_16x16x32_bf16 v[252:255], a[152:155], a[44:47], v[252:255]
  v_mfma_f32_16x16x32_bf16 v[252:255], a[156:159], a[60:63], v[252:255]
  s_waitcnt lgkmcnt(2)
  v_mfma_f32_16x16x32_bf16 v[224:227], a[128:131], a[64:67], v[224:227]
  ds_read_b128 a[144:147], v5 offset:6144
  v_mfma_f32_16x16x32_bf16 v[224:227], a[132:135], a[80:83], v[224:227]
  v_mfma_f32_16x16x32_bf16 v[232:235], a[128:131], a[68:71], v[232:235]
  v_mfma_f32_16x16x32_bf16 v[232:235], a[132:135], a[84:87], v[232:235]
  v_mfma_f32_16x16x32_bf16 v[240:243], a[128:131], a[72:75], v[240:243]
  ds_read_b128 a[148:151], v5 offset:14336
  v_mfma_f32_16x16x32_bf16 v[240:243], a[132:135], a[88:91], v[240:243]
  v_mfma_f32_16x16x32_bf16 v[248:251], a[128:131], a[76:79], v[248:251]
  v_mfma_f32_16x16x32_bf16 v[248:251], a[132:135], a[92:95], v[248:251]
  s_waitcnt lgkmcnt(2)
  v_mfma_f32_16x16x32_bf16 v[228:231], a[136:139], a[64:67], v[228:231]
  ds_read_b128 a[152:155], v5 offset:7168
  v_mfma_f32_16x16x32_bf16 v[228:231], a[140:143], a[80:83], v[228:231]
  v_mfma_f32_16x16x32_bf16 v[236:239], a[136:139], a[68:71], v[236:239]
  v_mfma_f32_16x16x32_bf16 v[236:239], a[140:143], a[84:87], v[236:239]
  v_mfma_f32_16x16x32_bf16 v[244:247], a[136:139], a[72:75], v[244:247]
  ds_read_b128 a[156:159], v5 offset:15360
  v_mfma_f32_16x16x32_bf16 v[244:247], a[140:143], a[88:91], v[244:247]
  v_mfma_f32_16x16x32_bf16 v[252:255], a[136:139], a[76:79], v[252:255]
  v_mfma_f32_16x16x32_bf16 v[252:255], a[140:143], a[92:95], v[252:255]
  s_waitcnt lgkmcnt(2)
  v_mfma_f32_16x16x32_bf16 v[224:227], a[144:147], a[96:99], v[224:227]
  v_mfma_f32_16x16x32_bf16 v[224:227], a[148:151], a[112:115], v[224:227]
  buffer_load_dwordx2 v[22:23], v19, s[24:27], 0 offen sc1
  v_mfma_f32_16x16x32_bf16 v[232:235], a[144:147], a[100:103], v[232:235]
  v_mfma_f32_16x16x32_bf16 v[232:235], a[148:151], a[116:119], v[232:235]
  v_mfma_f32_16x16x32_bf16 v[240:243], a[144:147], a[104:107], v[240:243]
  v_mfma_f32_16x16x32_bf16 v[240:243], a[148:151], a[120:123], v[240:243]
  v_mfma_f32_16x16x32_bf16 v[248:251], a[144:147], a[108:111], v[248:251]
  v_mfma_f32_16x16x32_bf16 v[248:251], a[148:151], a[124:127], v[248:251]
  s_waitcnt lgkmcnt(0)
  v_mfma_f32_16x16x32_bf16 v[228:231], a[152:155], a[96:99], v[228:231]
  v_mfma_f32_16x16x32_bf16 v[228:231], a[156:159], a[112:115], v[228:231]
  s_waitcnt vmcnt(6)
  buffer_store_dwordx2 v[12:13], v20, s[24:27], s73 offen sc1
  v_mfma_f32_16x16x32_bf16 v[236:239], a[152:155], a[100:103], v[236:239]
  v_mfma_f32_16x16x32_bf16 v[236:239], a[156:159], a[116:119], v[236:239]
  v_mfma_f32_16x16x32_bf16 v[244:247], a[152:155], a[104:107], v[244:247]
  v_mfma_f32_16x16x32_bf16 v[244:247], a[156:159], a[120:123], v[244:247]
  v_mfma_f32_16x16x32_bf16 v[252:255], a[152:155], a[108:111], v[252:255]
  v_mfma_f32_16x16x32_bf16 v[252:255], a[156:159], a[124:127], v[252:255]
  v_mov_b64 v[192:193], 0
  v_mov_b64 v[194:195], 0
  v_mov_b64 v[196:197], 0
  v_mov_b64 v[198:199], 0
  v_mov_b64 v[200:201], 0
  v_mov_b64 v[202:203], 0
  v_mov_b64 v[204:205], 0
  v_mov_b64 v[206:207], 0
  v_mov_b64 v[208:209], 0
  v_mov_b64 v[210:211], 0
  v_mov_b64 v[212:213], 0
  v_mov_b64 v[214:215], 0
  v_mov_b64 v[216:217], 0
  v_mov_b64 v[218:219], 0
  v_mov_b64 v[220:221], 0
  v_mov_b64 v[222:223], 0
  s_waitcnt vmcnt(2)
  buffer_store_dwordx2 v[12:13], v20, s[24:27], s74 offen sc1
  s_mov_b32 s38, s49
  s_waitcnt vmcnt(1)
  v_cmp_eq_u64 vcc, v[22:23], v[12:13]
  s_nop 0
  s_andn2_b32 s39, vcc_lo, s49
  s_or_b32 s49, s49, s39
  s_bitcmp0_b32 s39, 0
  s_cbranch_scc1 L_gb_no10
  buffer_load_dwordx4 v[32:35], v21, s[24:27], s45 offen offset:0 sc1
  buffer_load_dwordx4 v[36:39], v21, s[24:27], s45 offen offset:1024 sc1
  buffer_load_dwordx4 v[40:43], v21, s[24:27], s45 offen offset:2048 sc1
  buffer_load_dwordx4 v[44:47], v21, s[24:27], s45 offen offset:3072 sc1
L_gb_no10:
  s_bitcmp0_b32 s39, 1
  s_cbranch_scc1 L_gb_no11
  buffer_load_dwordx4 v[48:51], v21, s[24:27], s46 offen offset:0 sc1
  buffer_load_dwordx4 v[52:55], v21, s[24:27], s46 offen offset:1024 sc1
  buffer_load_dwordx4 v[56:59], v21, s[24:27], s46 offen offset:2048 sc1
  buffer_load_dwordx4 v[60:63], v21, s[24:27], s46 offen offset:3072 sc1
L_gb_no11:
  s_bitcmp0_b32 s39, 2
  s_cbranch_scc1 L_gb_no12
  buffer_load_dwordx4 v[64:67], v21, s[24:27], s47 offen offset:0 sc1
  buffer_load_dwordx4 v[68:71], v21, s[24:27], s47 offen offset:1024 sc1
  buffer_load_dwordx4 v[72:75], v21, s[24:27], s47 offen offset:2048 sc1
  buffer_load_dwordx4 v[76:79], v21, s[24:27], s47 offen offset:3072 sc1
L_gb_no12:
  v_lshlrev_b32 v160, 16, v96
  v_and_b32 v161, 0xffff0000, v96
  v_lshlrev_b32 v162, 16, v97
  v_and_b32 v163, 0xffff0000, v97
  v_lshlrev_b32 v164, 16, v98
  v_and_b32 v165, 0xffff0000, v98
  v_lshlrev_b32 v166, 16, v99
  v_and_b32 v167, 0xffff0000, v99
  v_lshlrev_b32 v168, 16, v100
  v_and_b32 v169, 0xffff0000, v100
  v_lshlrev_b32 v170, 16, v101
  v_and_b32 v171, 0xffff0000, v101
  v_lshlrev_b32 v172, 16, v102
  v_and_b32 v173, 0xffff0000, v102
  v_lshlrev_b32 v174, 16, v103
  v_and_b32 v175, 0xffff0000, v103
  v_lshlrev_b32 v176, 16, v104
  v_and_b32 v177, 0xffff0000, v104
  v_lshlrev_b32 v178, 16, v105
  v_and_b32 v179, 0xffff0000, v105
  v_lshlrev_b32 v180, 16, v106
  v_and_b32 v181, 0xffff0000, v106
  v_lshlrev_b32 v182, 16, v107
  v_and_b32 v183, 0xffff0000, v107
  v_lshlrev_b32 v184, 16, v108
  v_and_b32 v185, 0xffff0000, v108
  v_lshlrev_b32 v186, 16, v109
  v_and_b32 v187, 0xffff0000, v109
  v_lshlrev_b32 v188, 16, v110
  v_and_b32 v189, 0xffff0000, v110
  v_lshlrev_b32 v190, 16, v111
  v_and_b32 v191, 0xffff0000, v111
  s_cmp_lg_u32 s30, 3
  s_cbranch_scc1 L_gb_nos
  v_mov_b64 v[128:129], v[224:225]
  v_mov_b64 v[130:131], v[226:227]
  v_mov_b64 v[132:133], v[228:229]
  v_mov_b64 v[134:135], v[230:231]
  v_mov_b64 v[136:137], v[232:233]
  v_mov_b64 v[138:139], v[234:235]
  v_mov_b64 v[140:141], v[236:237]
  v_mov_b64 v[142:143], v[238:239]
  v_mov_b64 v[144:145], v[240:241]
  v_mov_b64 v[146:147], v[242:243]
  v_mov_b64 v[148:149], v[244:245]
  v_mov_b64 v[150:151], v[246:247]
  v_mov_b64 v[152:153], v[248:249]
  v_mov_b64 v[154:155], v[250:251]
  v_mov_b64 v[156:157], v[252:253]
  v_mov_b64 v[158:159], v[254:255]
L_gb_nos:
  s_bitcmp0_b32 s38, 0
  s_cbranch_scc1 L_gb_u00
  s_cmp_eq_u32 s30, 3
  s_cbranch_scc1 L_gb_ua0
  v_lshlrev_b32 v128, 16, v32
  v_and_b32 v129, 0xffff0000, v32
  v_lshlrev_b32 v130, 16, v33
  v_and_b32 v131, 0xffff0000, v33
  v_lshlrev_b32 v132, 16, v34
  v_and_b32 v133, 0xffff0000, v34
  v_lshlrev_b32 v134, 16, v35
  v_and_b32 v135, 0xffff0000, v35
  v_lshlrev_b32 v136, 16, v36
  v_and_b32 v137, 0xffff0000, v36
  v_lshlrev_b32 v138, 16, v37
  v_and_b32 v139, 0xffff0000, v37
  v_lshlrev_b32 v140, 16, v38
  v_and_b32 v141, 0xffff0000, v38
  v_lshlrev_b32 v142, 16, v39
  v_and_b32 v143, 0xffff0000, v39
  v_lshlrev_b32 v144, 16, v40
  v_and_b32 v145, 0xffff0000, v40
  v_lshlrev_b32 v146, 16, v41
  v_and_b32 v147, 0xffff0000, v41
  v_lshlrev_b32 v148, 16, v42
  v_and_b32 v149, 0xffff0000, v42
  v_lshlrev_b32 v150, 16, v43
  v_and_b32 v151, 0xffff0000, v43
  v_lshlrev_b32 v152, 16, v44
  v_and_b32 v153, 0xffff0000, v44
  v_lshlrev_b32 v154, 16, v45
  v_and_b32 v155, 0xffff0000, v45
  v_lshlrev_b32 v156, 16, v46
  v_and_b32 v157, 0xffff0000, v46
  v_lshlrev_b32 v158, 16, v47
  v_and_b32 v159, 0xffff0000, v47
  s_branch L_gb_u00
L_gb_ua0:
  v_lshlrev_b32 v224, 16, v32
  v_and_b32 v225, 0xffff0000, v32
  v_lshlrev_b32 v226, 16, v33
  v_and_b32 v227, 0xffff0000, v33
  v_lshlrev_b32 v228, 16, v34
  v_and_b32 v229, 0xffff0000, v34
  v_lshlrev_b32 v230, 16, v35
  v_and_b32 v231, 0xffff0000, v35
  v_lshlrev_b32 v232, 16, v36
  v_and_b32 v233, 0xffff0000, v36
  v_lshlrev_b32 v234, 16, v37
  v_and_b32 v235, 0xffff0000, v37
  v_lshlrev_b32 v236, 16, v38
  v_and_b32 v237, 0xffff0000, v38
  v_lshlrev_b32 v238, 16, v39
  v_and_b32 v239, 0xffff0000, v39
  v_lshlrev_b32 v240, 16, v40
  v_and_b32 v241, 0xffff0000, v40
  v_lshlrev_b32 v242, 16, v41
  v_and_b32 v243, 0xffff0000, v41
  v_lshlrev_b32 v244, 16, v42
  v_and_b32 v245, 0xffff0000, v42
  v_lshlrev_b32 v246, 16, v43
  v_and_b32 v247, 0xffff0000, v43
  v_lshlrev_b32 v248, 16, v44
  v_and_b32 v249, 0xffff0000, v44
  v_lshlrev_b32 v250, 16, v45
  v_and_b32 v251, 0xffff0000, v45
  v_lshlrev_b32 v252, 16, v46
  v_and_b32 v253, 0xffff0000, v46
  v_lshlrev_b32 v254, 16, v47
  v_and_b32 v255, 0xffff0000, v47
L_gb_u00:
  s_bitcmp0_b32 s38, 1
  s_cbranch_scc1 L_gb_u01
  v_lshlrev_b32 v80, 16, v48
  v_and_b32 v81, 0xffff0000, v48
  v_lshlrev_b32 v82, 16, v49
  v_and_b32 v83, 0xffff0000, v49
  v_lshlrev_b32 v84, 16, v50
  v_and_b32 v85, 0xffff0000, v50
  v_lshlrev_b32 v86, 16, v51
  v_and_b32 v87, 0xffff0000, v51
  v_lshlrev_b32 v88, 16, v52
  v_and_b32 v89, 0xffff0000, v52
  v_lshlrev_b32 v90, 16, v53
  v_and_b32 v91, 0xffff0000, v53
  v_lshlrev_b32 v92, 16, v54
  v_and_b32 v93, 0xffff0000, v54
  v_lshlrev_b32 v94, 16, v55
  v_and_b32 v95, 0xffff0000, v55
  v_pk_add_f32 v[192:193], v[192:193], v[80:81]
  v_pk_add_f32 v[194:195], v[194:195], v[82:83]
  v_pk_add_f32 v[196:197], v[196:197], v[84:85]
  v_pk_add_f32 v[198:199], v[198:199], v[86:87]
  v_pk_add_f32 v[200:201], v[200:201], v[88:89]
  v_pk_add_f32 v[202:203], v[202:203], v[90:91]
  v_pk_add_f32 v[204:205], v[204:205], v[92:93]
  v_pk_add_f32 v[206:207], v[206:207], v[94:95]
  v_lshlrev_b32 v80, 16, v56
  v_and_b32 v81, 0xffff0000, v56
  v_lshlrev_b32 v82, 16, v57
  v_and_b32 v83, 0xffff0000, v57
  v_lshlrev_b32 v84, 16, v58
  v_and_b32 v85, 0xffff0000, v58
  v_lshlrev_b32 v86, 16, v59
  v_and_b32 v87, 0xffff0000, v59
  v_lshlrev_b32 v88, 16, v60
  v_and_b32 v89, 0xffff0000, v60
  v_lshlrev_b32 v90, 16, v61
  v_and_b32 v91, 0xffff0000, v61
  v_lshlrev_b32 v92, 16, v62
  v_and_b32 v93, 0xffff0000, v62
  v_lshlrev_b32 v94, 16, v63
  v_and_b32 v95, 0xffff0000, v63
  v_pk_add_f32 v[208:209], v[208:209], v[80:81]
  v_pk_add_f32 v[210:211], v[210:211], v[82:83]
  v_pk_add_f32 v[212:213], v[212:213], v[84:85]
  v_pk_add_f32 v[214:215], v[214:215], v[86:87]
  v_pk_add_f32 v[216:217], v[216:217], v[88:89]
  v_pk_add_f32 v[218:219], v[218:219], v[90:91]
  v_pk_add_f32 v[220:221], v[220:221], v[92:93]
  v_pk_add_f32 v[222:223], v[222:223], v[94:95]
L_gb_u01:
  s_bitcmp0_b32 s38, 2
  s_cbranch_scc1 L_gb_u02
  v_lshlrev_b32 v80, 16, v64
  v_and_b32 v81, 0xffff0000, v64
  v_lshlrev_b32 v82, 16, v65
  v_and_b32 v83, 0xffff0000, v65
  v_lshlrev_b32 v84, 16, v66
  v_and_b32 v85, 0xffff0000, v66
  v_lshlrev_b32 v86, 16, v67
  v_and_b32 v87, 0xffff0000, v67
  v_lshlrev_b32 v88, 16, v68
  v_and_b32 v89, 0xffff0000, v68
  v_lshlrev_b32 v90, 16, v69
  v_and_b32 v91, 0xffff0000, v69
  v_lshlrev_b32 v92, 16, v70
  v_and_b32 v93, 0xffff0000, v70
  v_lshlrev_b32 v94, 16, v71
  v_and_b32 v95, 0xffff0000, v71
  v_pk_add_f32 v[192:193], v[192:193], v[80:81]
  v_pk_add_f32 v[194:195], v[194:195], v[82:83]
  v_pk_add_f32 v[196:197], v[196:197], v[84:85]
  v_pk_add_f32 v[198:199], v[198:199], v[86:87]
  v_pk_add_f32 v[200:201], v[200:201], v[88:89]
  v_pk_add_f32 v[202:203], v[202:203], v[90:91]
  v_pk_add_f32 v[204:205], v[204:205], v[92:93]
  v_pk_add_f32 v[206:207], v[206:207], v[94:95]
  v_lshlrev_b32 v80, 16, v72
  v_and_b32 v81, 0xffff0000, v72
  v_lshlrev_b32 v82, 16, v73
  v_and_b32 v83, 0xffff0000, v73
  v_lshlrev_b32 v84, 16, v74
  v_and_b32 v85, 0xffff0000, v74
  v_lshlrev_b32 v86, 16, v75
  v_and_b32 v87, 0xffff0000, v75
  v_lshlrev_b32 v88, 16, v76
  v_and_b32 v89, 0xffff0000, v76
  v_lshlrev_b32 v90, 16, v77
  v_and_b32 v91, 0xffff0000, v77
  v_lshlrev_b32 v92, 16, v78
  v_and_b32 v93, 0xffff0000, v78
  v_lshlrev_b32 v94, 16, v79
  v_and_b32 v95, 0xffff0000, v79
  v_pk_add_f32 v[208:209], v[208:209], v[80:81]
  v_pk_add_f32 v[210:211], v[210:211], v[82:83]
  v_pk_add_f32 v[212:213], v[212:213], v[84:85]
  v_pk_add_f32 v[214:215], v[214:215], v[86:87]
  v_pk_add_f32 v[216:217], v[216:217], v[88:89]
  v_pk_add_f32 v[218:219], v[218:219], v[90:91]
  v_pk_add_f32 v[220:221], v[220:221], v[92:93]
  v_pk_add_f32 v[222:223], v[222:223], v[94:95]
L_gb_u02:
  s_bitcmp1_b32 s49, 0
  s_cbranch_scc1 L_gb_had0
  s_mov_b32 s37, 0
L_gb_sp0:
  buffer_load_dwordx2 v[22:23], v28, s[24:27], s52 offen sc1
  s_waitcnt vmcnt(0)
  v_cmp_ne_u64 vcc, v[22:23], v[12:13]
  s_add_u32 s37, s37, 1
  s_cmp_eq_u64 vcc, 0
  s_cbranch_scc1 L_gb_ok0
  s_sleep 2
  s_cmp_lt_u32 s37, 0x200000
  s_cbranch_scc1 L_gb_sp0
L_gb_ok0:
  buffer_load_dwordx4 v[32:35], v21, s[24:27], s45 offen offset:0 sc1
  buffer_load_dwordx4 v[36:39], v21, s[24:27], s45 offen offset:1024 sc1
  buffer_load_dwordx4 v[40:43], v21, s[24:27], s45 offen offset:2048 sc1
  buffer_load_dwordx4 v[44:47], v21, s[24:27], s45 offen offset:3072 sc1
L_gb_had0:
  s_bitcmp1_b32 s49, 1
  s_cbranch_scc1 L_gb_had1
  s_mov_b32 s37, 0
L_gb_sp1:
  buffer_load_dwordx2 v[22:23], v28, s[24:27], s53 offen sc1
  s_waitcnt vmcnt(0)
  v_cmp_ne_u64 vcc, v[22:23], v[12:13]
  s_add_u32 s37, s37, 1
  s_cmp_eq_u64 vcc, 0
  s_cbranch_scc1 L_gb_ok1
  s_sleep 2
  s_cmp_lt_u32 s37, 0x200000
  s_cbranch_scc1 L_gb_sp1
L_gb_ok1:
  buffer_load_dwordx4 v[48:51], v21, s[24:27], s46 offen offset:0 sc1
  buffer_load_dwordx4 v[52:55], v21, s[24:27], s46 offen offset:1024 sc1
  buffer_load_dwordx4 v[56:59], v21, s[24:27], s46 offen offset:2048 sc1
  buffer_load_dwordx4 v[60:63], v21, s[24:27], s46 offen offset:3072 sc1
L_gb_had1:
  s_bitcmp1_b32 s49, 2
  s_cbranch_scc1 L_gb_had2
  s_mov_b32 s37, 0
L_gb_sp2:
  buffer_load_dwordx2 v[22:23], v28, s[24:27], s48 offen sc1
  s_waitcnt vmcnt(0)
  v_cmp_ne_u64 vcc, v[22:23], v[12:13]
  s_add_u32 s37, s37, 1
  s_cmp_eq_u64 vcc, 0
  s_cbranch_scc1 L_gb_ok2
  s_sleep 2
  s_cmp_lt_u32 s37, 0x200000
  s_cbranch_scc1 L_gb_sp2
L_gb_ok2:
  buffer_load_dwordx4 v[64:67], v21, s[24:27], s47 offen offset:0 sc1
  buffer_load_dwordx4 v[68:71], v21, s[24:27], s47 offen offset:1024 sc1
  buffer_load_dwordx4 v[72:75], v21, s[24:27], s47 offen offset:2048 sc1
  buffer_load_dwordx4 v[76:79], v21, s[24:27], s47 offen offset:3072 sc1
L_gb_had2:
  s_xor_b32 s38, s49, 7
  s_cbranch_scc1 L_gb_lnd
  s_waitcnt vmcnt(0)
L_gb_lnd:
  s_bitcmp0_b32 s39, 0
  s_cbranch_scc1 L_gb_u10
  s_cmp_eq_u32 s30, 3
  s_cbranch_scc1 L_gb_ua1
  v_lshlrev_b32 v128, 16, v32
  v_and_b32 v129, 0xffff0000, v32
  v_lshlrev_b32 v130, 16, v33
  v_and_b32 v131, 0xffff0000, v33
  v_lshlrev_b32 v132, 16, v34
  v_and_b32 v133, 0xffff0000, v34
  v_lshlrev_b32 v134, 16, v35
  v_and_b32 v135, 0xffff0000, v35
  v_lshlrev_b32 v136, 16, v36
  v_and_b32 v137, 0xffff0000, v36
  v_lshlrev_b32 v138, 16, v37
  v_and_b32 v139, 0xffff0000, v37
  v_lshlrev_b32 v140, 16, v38
  v_and_b32 v141, 0xffff0000, v38
  v_lshlrev_b32 v142, 16, v39
  v_and_b32 v143, 0xffff0000, v39
  v_lshlrev_b32 v144, 16, v40
  v_and_b32 v145, 0xffff0000, v40
  v_lshlrev_b32 v146, 16, v41
  v_and_b32 v147, 0xffff0000, v41
  v_lshlrev_b32 v148, 16, v42
  v_and_b32 v149, 0xffff0000, v42
  v_lshlrev_b32 v150, 16, v43
  v_and_b32 v151, 0xffff0000, v43
  v_lshlrev_b32 v152, 16, v44
  v_and_b32 v153, 0xffff0000, v44
  v_lshlrev_b32 v154, 16, v45
  v_and_b32 v155, 0xffff0000, v45
  v_lshlrev_b32 v156, 16, v46
  v_and_b32 v157, 0xffff0000, v46
  v_lshlrev_b32 v158, 16, v47
  v_and_b32 v159, 0xffff0000, v47
  s_branch L_gb_u10
L_gb_ua1:
  v_lshlrev_b32 v224, 16, v32
  v_and_b32 v225, 0xffff0000, v32
  v_lshlrev_b32 v226, 16, v33
  v_and_b32 v227, 0xffff0000, v33
  v_lshlrev_b32 v228, 16, v34
  v_and_b32 v229, 0xffff0000, v34
  v_lshlrev_b32 v230, 16, v35
  v_and_b32 v231, 0xffff0000, v35
  v_lshlrev_b32 v232, 16, v36
  v_and_b32 v233, 0xffff0000, v36
  v_lshlrev_b32 v234, 16, v37
  v_and_b32 v235, 0xffff0000, v37
  v_lshlrev_b32 v236, 16, v38
  v_and_b32 v237, 0xffff0000, v38
  v_lshlrev_b32 v238, 16, v39
  v_and_b32 v239, 0xffff0000, v39
  v_lshlrev_b32 v240, 16, v40
  v_and_b32 v241, 0xffff0000, v40
  v_lshlrev_b32 v242, 16, v41
  v_and_b32 v243, 0xffff0000, v41
  v_lshlrev_b32 v244, 16, v42
  v_and_b32 v245, 0xffff0000, v42
  v_lshlrev_b32 v246, 16, v43
  v_and_b32 v247, 0xffff0000, v43
  v_lshlrev_b32 v248, 16, v44
  v_and_b32 v249, 0xffff0000, v44
  v_lshlrev_b32 v250, 16, v45
  v_and_b32 v251, 0xffff0000, v45
  v_lshlrev_b32 v252, 16, v46
  v_and_b32 v253, 0xffff0000, v46
  v_lshlrev_b32 v254, 16, v47
  v_and_b32 v255, 0xffff0000, v47
L_gb_u10:
  s_bitcmp0_b32 s39, 1
  s_cbranch_scc1 L_gb_u11
  v_lshlrev_b32 v80, 16, v48
  v_and_b32 v81, 0xffff0000, v48
  v_lshlrev_b32 v82, 16, v49
  v_and_b32 v83, 0xffff0000, v49
  v_lshlrev_b32 v84, 16, v50
  v_and_b32 v85, 0xffff0000, v50
  v_lshlrev_b32 v86, 16, v51
  v_and_b32 v87, 0xffff0000, v51
  v_lshlrev_b32 v88, 16, v52
  v_and_b32 v89, 0xffff0000, v52
  v_lshlrev_b32 v90, 16, v53
  v_and_b32 v91, 0xffff0000, v53
  v_lshlrev_b32 v92, 16, v54
  v_and_b32 v93, 0xffff0000, v54
  v_lshlrev_b32 v94, 16, v55
  v_and_b32 v95, 0xffff0000, v55
  v_pk_add_f32 v[192:193], v[192:193], v[80:81]
  v_pk_add_f32 v[194:195], v[194:195], v[82:83]
  v_pk_add_f32 v[196:197], v[196:197], v[84:85]
  v_pk_add_f32 v[198:199], v[198:199], v[86:87]
  v_pk_add_f32 v[200:201], v[200:201], v[88:89]
  v_pk_add_f32 v[202:203], v[202:203], v[90:91]
  v_pk_add_f32 v[204:205], v[204:205], v[92:93]
  v_pk_add_f32 v[206:207], v[206:207], v[94:95]
  v_lshlrev_b32 v80, 16, v56
  v_and_b32 v81, 0xffff0000, v56
  v_lshlrev_b32 v82, 16, v57
  v_and_b32 v83, 0xffff0000, v57
  v_lshlrev_b32 v84, 16, v58
  v_and_b32 v85, 0xffff0000, v58
  v_lshlrev_b32 v86, 16, v59
  v_and_b32 v87, 0xffff0000, v59
  v_lshlrev_b32 v88, 16, v60
  v_and_b32 v89, 0xffff0000, v60
  v_lshlrev_b32 v90, 16, v61
  v_and_b32 v91, 0xffff0000, v61
  v_lshlrev_b32 v92, 16, v62
  v_and_b32 v93, 0xffff0000, v62
  v_lshlrev_b32 v94, 16, v63
  v_and_b32 v95, 0xffff0000, v63
  v_pk_add_f32 v[208:209], v[208:209], v[80:81]
  v_pk_add_f32 v[210:211], v[210:211], v[82:83]
  v_pk_add_f32 v[212:213], v[212:213], v[84:85]
  v_pk_add_f32 v[214:215], v[214:215], v[86:87]
  v_pk_add_f32 v[216:217], v[216:217], v[88:89]
  v_pk_add_f32 v[218:219], v[218:219], v[90:91]
  v_pk_add_f32 v[220:221], v[220:221], v[92:93]
  v_pk_add_f32 v[222:223], v[222:223], v[94:95]
L_gb_u11:
  s_bitcmp0_b32 s39, 2
  s_cbranch_scc1 L_gb_u12
  v_lshlrev_b32 v80, 16, v64
  v_and_b32 v81, 0xffff0000, v64
  v_lshlrev_b32 v82, 16, v65
  v_and_b32 v83, 0xffff0000, v65
  v_lshlrev_b32 v84, 16, v66
  v_and_b32 v85, 0xffff0000, v66
  v_lshlrev_b32 v86, 16, v67
  v_and_b32 v87, 0xffff0000, v67
  v_lshlrev_b32 v88, 16, v68
  v_and_b32 v89, 0xffff0000, v68
  v_lshlrev_b32 v90, 16, v69
  v_and_b32 v91, 0xffff0000, v69
  v_lshlrev_b32 v92, 16, v70
  v_and_b32 v93, 0xffff0000, v70
  v_lshlrev_b32 v94, 16, v71
  v_and_b32 v95, 0xffff0000, v71
  v_pk_add_f32 v[192:193], v[192:193], v[80:81]
  v_pk_add_f32 v[194:195], v[194:195], v[82:83]
  v_pk_add_f32 v[196:197], v[196:197], v[84:85]
  v_pk_add_f32 v[198:199], v[198:199], v[86:87]
  v_pk_add_f32 v[200:201], v[200:201], v[88:89]
  v_pk_add_f32 v[202:203], v[202:203], v[90:91]
  v_pk_add_f32 v[204:205], v[204:205], v[92:93]
  v_pk_add_f32 v[206:207], v[206:207], v[94:95]
  v_lshlrev_b32 v80, 16, v72
  v_and_b32 v81, 0xffff0000, v72
  v_lshlrev_b32 v82, 16, v73
  v_and_b32 v83, 0xffff0000, v73
  v_lshlrev_b32 v84, 16, v74
  v_and_b32 v85, 0xffff0000, v74
  v_lshlrev_b32 v86, 16, v75
  v_and_b32 v87, 0xffff0000, v75
  v_lshlrev_b32 v88, 16, v76
  v_and_b32 v89, 0xffff0000, v76
  v_lshlrev_b32 v90, 16, v77
  v_and_b32 v91, 0xffff0000, v77
  v_lshlrev_b32 v92, 16, v78
  v_and_b32 v93, 0xffff0000, v78
  v_lshlrev_b32 v94, 16, v79
  v_and_b32 v95, 0xffff0000, v79
  v_pk_add_f32 v[208:209], v[208:209], v[80:81]
  v_pk_add_f32 v[210:211], v[210:211], v[82:83]
  v_pk_add_f32 v[212:213], v[212:213], v[84:85]
  v_pk_add_f32 v[214:215], v[214:215], v[86:87]
  v_pk_add_f32 v[216:217], v[216:217], v[88:89]
  v_pk_add_f32 v[218:219], v[218:219], v[90:91]
  v_pk_add_f32 v[220:221], v[220:221], v[92:93]
  v_pk_add_f32 v[222:223], v[222:223], v[94:95]
L_gb_u12:
  s_waitcnt vmcnt(0)
  s_bitcmp0_b32 s38, 0
  s_cbranch_scc1 L_gb_u20
  s_cmp_eq_u32 s30, 3
  s_cbranch_scc1 L_gb_ua2
  v_lshlrev_b32 v128, 16, v32
  v_and_b32 v129, 0xffff0000, v32
  v_lshlrev_b32 v130, 16, v33
  v_and_b32 v131, 0xffff0000, v33
  v_lshlrev_b32 v132, 16, v34
  v_and_b32 v133, 0xffff0000, v34
  v_lshlrev_b32 v134, 16, v35
  v_and_b32 v135, 0xffff0000, v35
  v_lshlrev_b32 v136, 16, v36
  v_and_b32 v137, 0xffff0000, v36
  v_lshlrev_b32 v138, 16, v37
  v_and_b32 v139, 0xffff0000, v37
  v_lshlrev_b32 v140, 16, v38
  v_and_b32 v141, 0xffff0000, v38
  v_lshlrev_b32 v142, 16, v39
  v_and_b32 v143, 0xffff0000, v39
  v_lshlrev_b32 v144, 16, v40
  v_and_b32 v145, 0xffff0000, v40
  v_lshlrev_b32 v146, 16, v41
  v_and_b32 v147, 0xffff0000, v41
  v_lshlrev_b32 v148, 16, v42
  v_and_b32 v149, 0xffff0000, v42
  v_lshlrev_b32 v150, 16, v43
  v_and_b32 v151, 0xffff0000, v43
  v_lshlrev_b32 v152, 16, v44
  v_and_b32 v153, 0xffff0000, v44
  v_lshlrev_b32 v154, 16, v45
  v_and_b32 v155, 0xffff0000, v45
  v_lshlrev_b32 v156, 16, v46
  v_and_b32 v157, 0xffff0000, v46
  v_lshlrev_b32 v158, 16, v47
  v_and_b32 v159, 0xffff0000, v47
  s_branch L_gb_u20
L_gb_ua2:
  v_lshlrev_b32 v224, 16, v32
  v_and_b32 v225, 0xffff0000, v32
  v_lshlrev_b32 v226, 16, v33
  v_and_b32 v227, 0xffff0000, v33
  v_lshlrev_b32 v228, 16, v34
  v_and_b32 v229, 0xffff0000, v34
  v_lshlrev_b32 v230, 16, v35
  v_and_b32 v231, 0xffff0000, v35
  v_lshlrev_b32 v232, 16, v36
  v_and_b32 v233, 0xffff0000, v36
  v_lshlrev_b32 v234, 16, v37
  v_and_b32 v235, 0xffff0000, v37
  v_lshlrev_b32 v236, 16, v38
  v_and_b32 v237, 0xffff0000, v38
  v_lshlrev_b32 v238, 16, v39
  v_and_b32 v239, 0xffff0000, v39
  v_lshlrev_b32 v240, 16, v40
  v_and_b32 v241, 0xffff0000, v40
  v_lshlrev_b32 v242, 16, v41
  v_and_b32 v243, 0xffff0000, v41
  v_lshlrev_b32 v244, 16, v42
  v_and_b32 v245, 0xffff0000, v42
  v_lshlrev_b32 v246, 16, v43
  v_and_b32 v247, 0xffff0000, v43
  v_lshlrev_b32 v248, 16, v44
  v_and_b32 v249, 0xffff0000, v44
  v_lshlrev_b32 v250, 16, v45
  v_and_b32 v251, 0xffff0000, v45
  v_lshlrev_b32 v252, 16, v46
  v_and_b32 v253, 0xffff0000, v46
  v_lshlrev_b32 v254, 16, v47
  v_and_b32 v255, 0xffff0000, v47
L_gb_u20:
  s_bitcmp0_b32 s38, 1
  s_cbranch_scc1 L_gb_u21
  v_lshlrev_b32 v80, 16, v48
  v_and_b32 v81, 0xffff0000, v48
  v_lshlrev_b32 v82, 16, v49
  v_and_b32 v83, 0xffff0000, v49
  v_lshlrev_b32 v84, 16, v50
  v_and_b32 v85, 0xffff0000, v50
  v_lshlrev_b32 v86, 16, v51
  v_and_b32 v87, 0xffff0000, v51
  v_lshlrev_b32 v88, 16, v52
  v_and_b32 v89, 0xffff0000, v52
  v_lshlrev_b32 v90, 16, v53
  v_and_b32 v91, 0xffff0000, v53
  v_lshlrev_b32 v92, 16, v54
  v_and_b32 v93, 0xffff0000, v54
  v_lshlrev_b32 v94, 16, v55
  v_and_b32 v95, 0xffff0000, v55
  v_pk_add_f32 v[192:193], v[192:193], v[80:81]
  v_pk_add_f32 v[194:195], v[194:195], v[82:83]
  v_pk_add_f32 v[196:197], v[196:197], v[84:85]
  v_pk_add_f32 v[198:199], v[198:199], v[86:87]
  v_pk_add_f32 v[200:201], v[200:201], v[88:89]
  v_pk_add_f32 v[202:203], v[202:203], v[90:91]
  v_pk_add_f32 v[204:205], v[204:205], v[92:93]
  v_pk_add_f32 v[206:207], v[206:207], v[94:95]
  v_lshlrev_b32 v80, 16, v56
  v_and_b32 v81, 0xffff0000, v56
  v_lshlrev_b32 v82, 16, v57
  v_and_b32 v83, 0xffff0000, v57
  v_lshlrev_b32 v84, 16, v58
  v_and_b32 v85, 0xffff0000, v58
  v_lshlrev_b32 v86, 16, v59
  v_and_b32 v87, 0xffff0000, v59
  v_lshlrev_b32 v88, 16, v60
  v_and_b32 v89, 0xffff0000, v60
  v_lshlrev_b32 v90, 16, v61
  v_and_b32 v91, 0xffff0000, v61
  v_lshlrev_b32 v92, 16, v62
  v_and_b32 v93, 0xffff0000, v62
  v_lshlrev_b32 v94, 16, v63
  v_and_b32 v95, 0xffff0000, v63
  v_pk_add_f32 v[208:209], v[208:209], v[80:81]
  v_pk_add_f32 v[210:211], v[210:211], v[82:83]
  v_pk_add_f32 v[212:213], v[212:213], v[84:85]
  v_pk_add_f32 v[214:215], v[214:215], v[86:87]
  v_pk_add_f32 v[216:217], v[216:217], v[88:89]
  v_pk_add_f32 v[218:219], v[218:219], v[90:91]
  v_pk_add_f32 v[220:221], v[220:221], v[92:93]
  v_pk_add_f32 v[222:223], v[222:223], v[94:95]
L_gb_u21:
  s_bitcmp0_b32 s38, 2
  s_cbranch_scc1 L_gb_u22
  v_lshlrev_b32 v80, 16, v64
  v_and_b32 v81, 0xffff0000, v64
  v_lshlrev_b32 v82, 16, v65
  v_and_b32 v83, 0xffff0000, v65
  v_lshlrev_b32 v84, 16, v66
  v_and_b32 v85, 0xffff0000, v66
  v_lshlrev_b32 v86, 16, v67
  v_and_b32 v87, 0xffff0000, v67
  v_lshlrev_b32 v88, 16, v68
  v_and_b32 v89, 0xffff0000, v68
  v_lshlrev_b32 v90, 16, v69
  v_and_b32 v91, 0xffff0000, v69
  v_lshlrev_b32 v92, 16, v70
  v_and_b32 v93, 0xffff0000, v70
  v_lshlrev_b32 v94, 16, v71
  v_and_b32 v95, 0xffff0000, v71
  v_pk_add_f32 v[192:193], v[192:193], v[80:81]
  v_pk_add_f32 v[194:195], v[194:195], v[82:83]
  v_pk_add_f32 v[196:197], v[196:197], v[84:85]
  v_pk_add_f32 v[198:199], v[198:199], v[86:87]
  v_pk_add_f32 v[200:201], v[200:201], v[88:89]
  v_pk_add_f32 v[202:203], v[202:203], v[90:91]
  v_pk_add_f32 v[204:205], v[204:205], v[92:93]
  v_pk_add_f32 v[206:207], v[206:207], v[94:95]
  v_lshlrev_b32 v80, 16, v72
  v_and_b32 v81, 0xffff0000, v72
  v_lshlrev_b32 v82, 16, v73
  v_and_b32 v83, 0xffff0000, v73
  v_lshlrev_b32 v84, 16, v74
  v_and_b32 v85, 0xffff0000, v74
  v_lshlrev_b32 v86, 16, v75
  v_and_b32 v87, 0xffff0000, v75
  v_lshlrev_b32 v88, 16, v76
  v_and_b32 v89, 0xffff0000, v76
  v_lshlrev_b32 v90, 16, v77
  v_and_b32 v91, 0xffff0000, v77
  v_lshlrev_b32 v92, 16, v78
  v_and_b32 v93, 0xffff0000, v78
  v_lshlrev_b32 v94, 16, v79
  v_and_b32 v95, 0xffff0000, v79
  v_pk_add_f32 v[208:209], v[208:209], v[80:81]
  v_pk_add_f32 v[210:211], v[210:211], v[82:83]
  v_pk_add_f32 v[212:213], v[212:213], v[84:85]
  v_pk_add_f32 v[214:215], v[214:215], v[86:87]
  v_pk_add_f32 v[216:217], v[216:217], v[88:89]
  v_pk_add_f32 v[218:219], v[218:219], v[90:91]
  v_pk_add_f32 v[220:221], v[220:221], v[92:93]
  v_pk_add_f32 v[222:223], v[222:223], v[94:95]
L_gb_u22:
  v_pk_add_f32 v[224:225], v[224:225], v[192:193]
  v_pk_add_f32 v[226:227], v[226:227], v[194:195]
  v_pk_add_f32 v[228:229], v[228:229], v[196:197]
  v_pk_add_f32 v[230:231], v[230:231], v[198:199]
  v_pk_add_f32 v[232:233], v[232:233], v[200:201]
  v_pk_add_f32 v[234:235], v[234:235], v[202:203]
  v_pk_add_f32 v[236:237], v[236:237], v[204:205]
  v_pk_add_f32 v[238:239], v[238:239], v[206:207]
  v_pk_add_f32 v[240:241], v[240:241], v[208:209]
  v_pk_add_f32 v[242:243], v[242:243], v[210:211]
  v_pk_add_f32 v[244:245], v[244:245], v[212:213]
  v_pk_add_f32 v[246:247], v[246:247], v[214:215]
  v_pk_add_f32 v[248:249], v[248:249], v[216:217]
  v_pk_add_f32 v[250:251], v[250:251], v[218:219]
  v_pk_add_f32 v[252:253], v[252:253], v[220:221]
  v_pk_add_f32 v[254:255], v[254:255], v[222:223]
  v_pk_mul_f32 v[192:193], v[224:225], s[50:51] neg_lo:[1,0] neg_hi:[1,0]
  v_pk_mul_f32 v[194:195], v[226:227], s[50:51] neg_lo:[1,0] neg_hi:[1,0]
  v_pk_mul_f32 v[196:197], v[228:229], s[50:51] neg_lo:[1,0] neg_hi:[1,0]
  v_pk_mul_f32 v[198:199], v[230:231], s[50:51] neg_lo:[1,0] neg_hi:[1,0]
  v_exp_f32 v192, v192
  v_exp_f32 v193, v193
  v_exp_f32 v194, v194
  v_exp_f32 v195, v195
  v_exp_f32 v196, v196
  v_exp_f32 v197, v197
  v_exp_f32 v198, v198
  v_exp_f32 v199, v199
  v_pk_mul_f32 v[224:225], v[224:225], v[128:129]
  v_pk_mul_f32 v[226:227], v[226:227], v[130:131]
  v_pk_mul_f32 v[228:229], v[228:229], v[132:133]
  v_pk_mul_f32 v[230:231], v[230:231], v[134:135]
  v_pk_add_f32 v[192:193], v[192:193], 1.0 op_sel_hi:[1,0]
  v_pk_add_f32 v[194:195], v[194:195], 1.0 op_sel_hi:[1,0]
  v_pk_add_f32 v[196:197], v[196:197], 1.0 op_sel_hi:[1,0]
  v_pk_add_f32 v[198:199], v[198:199], 1.0 op_sel_hi:[1,0]
  v_rcp_f32 v192, v192
  v_rcp_f32 v193, v193
  v_rcp_f32 v194, v194
  v_rcp_f32 v195, v195
  v_rcp_f32 v196, v196
  v_rcp_f32 v197, v197
  v_rcp_f32 v198, v198
  v_rcp_f32 v199, v199
  v_pk_fma_f32 v[224:225], v[224:225], v[192:193], v[160:161]
  v_pk_fma_f32 v[226:227], v[226:227], v[194:195], v[162:163]
  v_pk_fma_f32 v[228:229], v[228:229], v[196:197], v[164:165]
  v_pk_fma_f32 v[230:231], v[230:231], v[198:199], v[166:167]
  v_cvt_pk_bf16_f32 v96, v224, v225
  v_cvt_pk_bf16_f32 v97, v226, v227
  v_cvt_pk_bf16_f32 v98, v228, v229
  v_cvt_pk_bf16_f32 v99, v230, v231
  s_nop 0
  v_permlane16_swap_b32 v96, v98
  v_permlane16_swap_b32 v97, v99
  buffer_store_dwordx4 v[96:99], v7, s[16:19], s68 offen sc1
  v_pk_mul_f32 v[200:201], v[232:233], s[50:51] neg_lo:[1,0] neg_hi:[1,0]
  v_pk_mul_f32 v[202:203], v[234:235], s[50:51] neg_lo:[1,0] neg_hi:[1,0]
  v_pk_mul_f32 v[204:205], v[236:237], s[50:51] neg_lo:[1,0] neg_hi:[1,0]
  v_pk_mul_f32 v[206:207], v[238:239], s[50:51] neg_lo:[1,0] neg_hi:[1,0]
  v_exp_f32 v200, v200
  v_exp_f32 v201, v201
  v_exp_f32 v202, v202
  v_exp_f32 v203, v203
  v_exp_f32 v204, v204
  v_exp_f32 v205, v205
  v_exp_f32 v206, v206
  v_exp_f32 v207, v207
  v_pk_mul_f32 v[232:233], v[232:233], v[136:137]
  v_pk_mul_f32 v[234:235], v[234:235], v[138:139]
  v_pk_mul_f32 v[236:237], v[236:237], v[140:141]
  v_pk_mul_f32 v[238:239], v[238:239], v[142:143]
  v_pk_add_f32 v[200:201], v[200:201], 1.0 op_sel_hi:[1,0]
  v_pk_add_f32 v[202:203], v[202:203], 1.0 op_sel_hi:[1,0]
  v_pk_add_f32 v[204:205], v[204:205], 1.0 op_sel_hi:[1,0]
  v_pk_add_f32 v[206:207], v[206:207], 1.0 op_sel_hi:[1,0]
  v_rcp_f32 v200, v200
  v_rcp_f32 v201, v201
  v_rcp_f32 v202, v202
  v_rcp_f32 v203, v203
  v_rcp_f32 v204, v204
  v_rcp_f32 v205, v205
  v_rcp_f32 v206, v206
  v_rcp_f32 v207, v207
  v_pk_fma_f32 v[232:233], v[232:233], v[200:201], v[168:169]
  v_pk_fma_f32 v[234:235], v[234:235], v[202:203], v[170:171]
  v_pk_fma_f32 v[236:237], v[236:237], v[204:205], v[172:173]
  v_pk_fma_f32 v[238:239], v[238:239], v[206:207], v[174:175]
  v_cvt_pk_bf16_f32 v100, v232, v233
  v_cvt_pk_bf16_f32 v101, v234, v235
  v_cvt_pk_bf16_f32 v102, v236, v237
  v_cvt_pk_bf16_f32 v103, v238, v239
  s_nop 0
  v_permlane16_swap_b32 v100, v102
  v_permlane16_swap_b32 v101, v103
  buffer_store_dwordx4 v[100:103], v7, s[16:19], s69 offen sc1
  v_pk_mul_f32 v[208:209], v[240:241], s[50:51] neg_lo:[1,0] neg_hi:[1,0]
  v_pk_mul_f32 v[210:211], v[242:243], s[50:51] neg_lo:[1,0] neg_hi:[1,0]
  v_pk_mul_f32 v[212:213], v[244:245], s[50:51] neg_lo:[1,0] neg_hi:[1,0]
  v_pk_mul_f32 v[214:215], v[246:247], s[50:51] neg_lo:[1,0] neg_hi:[1,0]
  v_exp_f32 v208, v208
  v_exp_f32 v209, v209
  v_exp_f32 v210, v210
  v_exp_f32 v211, v211
  v_exp_f32 v212, v212
  v_exp_f32 v213, v213
  v_exp_f32 v214, v214
  v_exp_f32 v215, v215
  v_pk_mul_f32 v[240:241], v[240:241], v[144:145]
  v_pk_mul_f32 v[242:243], v[242:243], v[146:147]
  v_pk_mul_f32 v[244:245], v[244:245], v[148:149]
  v_pk_mul_f32 v[246:247], v[246:247], v[150:151]
  v_pk_add_f32 v[208:209], v[208:209], 1.0 op_sel_hi:[1,0]
  v_pk_add_f32 v[210:211], v[210:211], 1.0 op_sel_hi:[1,0]
  v_pk_add_f32 v[212:213], v[212:213], 1.0 op_sel_hi:[1,0]
  v_pk_add_f32 v[214:215], v[214:215], 1.0 op_sel_hi:[1,0]
  v_rcp_f32 v208, v208
  v_rcp_f32 v209, v209
  v_rcp_f32 v210, v210
  v_rcp_f32 v211, v211
  v_rcp_f32 v212, v212
  v_rcp_f32 v213, v213
  v_rcp_f32 v214, v214
  v_rcp_f32 v215, v215
  v_pk_fma_f32 v[240:241], v[240:241], v[208:209], v[176:177]
  v_pk_fma_f32 v[242:243], v[242:243], v[210:211], v[178:179]
  v_pk_fma_f32 v[244:245], v[244:245], v[212:213], v[180:181]
  v_pk_fma_f32 v[246:247], v[246:247], v[214:215], v[182:183]
  v_cvt_pk_bf16_f32 v104, v240, v241
  v_cvt_pk_bf16_f32 v105, v242, v243
  v_cvt_pk_bf16_f32 v106, v244, v245
  v_cvt_pk_bf16_f32 v107, v246, v247
  s_nop 0
  v_permlane16_swap_b32 v104, v106
  v_permlane16_swap_b32 v105, v107
  buffer_store_dwordx4 v[104:107], v7, s[16:19], s70 offen sc1
  v_pk_mul_f32 v[216:217], v[248:249], s[50:51] neg_lo:[1,0] neg_hi:[1,0]
  v_pk_mul_f32 v[218:219], v[250:251], s[50:51] neg_lo:[1,0] neg_hi:[1,0]
  v_pk_mul_f32 v[220:221], v[252:253], s[50:51] neg_lo:[1,0] neg_hi:[1,0]
  v_pk_mul_f32 v[222:223], v[254:255], s[50:51] neg_lo:[1,0] neg_hi:[1,0]
  v_exp_f32 v216, v216
  v_exp_f32 v217, v217
  v_exp_f32 v218, v218
  v_exp_f32 v219, v219
  v_exp_f32 v220, v220
  v_exp_f32 v221, v221
  v_exp_f32 v222, v222
  v_exp_f32 v223, v223
  v_pk_mul_f32 v[248:249], v[248:249], v[152:153]
  v_pk_mul_f32 v[250:251], v[250:251], v[154:155]
  v_pk_mul_f32 v[252:253], v[252:253], v[156:157]
  v_pk_mul_f32 v[254:255], v[254:255], v[158:159]
  v_pk_add_f32 v[216:217], v[216:217], 1.0 op_sel_hi:[1,0]
  v_pk_add_f32 v[218:219], v[218:219], 1.0 op_sel_hi:[1,0]
  v_pk_add_f32 v[220:221], v[220:221], 1.0 op_sel_hi:[1,0]
  v_pk_add_f32 v[222:223], v[222:223], 1.0 op_sel_hi:[1,0]
  v_rcp_f32 v216, v216
  v_rcp_f32 v217, v217
  v_rcp_f32 v218, v218
  v_rcp_f32 v219, v219
  v_rcp_f32 v220, v220
  v_rcp_f32 v221, v221
  v_rcp_f32 v222, v222
  v_rcp_f32 v223, v223
  v_pk_fma_f32 v[248:249], v[248:249], v[216:217], v[184:185]
  v_pk_fma_f32 v[250:251], v[250:251], v[218:219], v[186:187]
  v_pk_fma_f32 v[252:253], v[252:253], v[220:221], v[188:189]
  v_pk_fma_f32 v[254:255], v[254:255], v[222:223], v[190:191]
  v_cvt_pk_bf16_f32 v108, v248, v249
  v_cvt_pk_bf16_f32 v109, v250, v251
  v_cvt_pk_bf16_f32 v110, v252, v253
  v_cvt_pk_bf16_f32 v111, v254, v255
  s_nop 0
  v_permlane16_swap_b32 v108, v110
  v_permlane16_swap_b32 v109, v111
  buffer_store_dwordx4 v[108:111], v7, s[16:19], s71 offen sc1
L_gb_end:
  s_endpgm
L_ga_tk:
  s_cmp_eq_u32 s66, 4
  s_cbranch_scc0 L_ga_tk2
  s_load_dwordx2 s[46:47], s[0:1], 72
  v_mov_b32 v28, 64
  v_mov_b32 v29, 1
  s_waitcnt lgkmcnt(0)
  s_mov_b64 exec, 1
  global_atomic_add v30, v28, v29, s[46:47] sc0 sc1
  s_mov_b64 exec, -1
  s_branch L_ga_tkr
L_ga_tk2:
  v_and_b32 v30, 7, v30
  v_lshlrev_b32 v30, 1, v30
  v_or_b32 v30, s72, v30
  v_mov_b32 v31, s73
  s_mov_b32 s67, 99
  buffer_store_dwordx2 v[30:31], v20, s[24:27], s48 offen sc1
  s_nop 1
  s_branch L_ga_tkr
L_code_end:
.section .rodata,"a"
.p2align 6
.amdhsa_kernel recurrent_scan__linear_kernel_hedgehog__glu_gated_bilinear__prompt_kernel
  .amdhsa_next_free_vgpr 512
  .amdhsa_next_free_sgpr 76
  .amdhsa_accum_offset 256
  .amdhsa_group_segment_fixed_size 0
  .amdhsa_kernarg_size 88
  .amdhsa_user_sgpr_count 2
  .amdhsa_user_sgpr_kernarg_segment_ptr 1
  .amdhsa_system_sgpr_workgroup_id_x 1
.end_amdhsa_kernel
.text
```
